```python
import torch

def _softmax(x, axis=-1):
    return torch.softmax(x, dim=axis)
def _gelu(x):
    return torch.nn.functional.gelu(x, approximate="tanh")
def _silu(x):
    return torch.nn.functional.silu(x)
def _sigmoid(x):
    return torch.sigmoid(x)
def _layernorm(x, axis=-1, eps=1e-5):
    m = x.mean(dim=axis, keepdim=True)
    v = x.var(dim=axis, keepdim=True, unbiased=False)
    return (x - m) / torch.sqrt(v + eps)
def _scatter_add(tgt, idx, src, axis=0):
    return tgt.clone().index_add_(axis, idx, src)
def _segment_sum(src, seg, n):
    out = torch.zeros((n,) + src.shape[1:], dtype=src.dtype)
    return out.index_add_(0, seg, src)
def _pad(x, pw):
    flat = tuple(v for pair in reversed(pw) for v in pair)
    return torch.nn.functional.pad(x, flat)

kernel_name = 'parallel_sum__linear_attn_block__dense_activation_mish__prompt'

def setup_inputs():

    _w = (lambda a: (lambda t: t.to(torch.bfloat16) if t.is_floating_point() else t)(torch.as_tensor(a)))
    def _A_setup():
        B, S, D = 1, 2048, 640
        return {
            "x": _w((lambda *s: torch.randn(*s, dtype=torch.bfloat16) * 0.05)(B, S, D)),
            "wqkv": _w((lambda *s: torch.randn(*s, dtype=torch.bfloat16) * 0.1)(D, 3 * D)),
            "wo": _w((lambda *s: torch.randn(*s, dtype=torch.bfloat16) * 0.05)(D, D)),
        }
    _A_in = _A_setup()

    def _B_setup():
        B, S, D, F = 1, 2048, 640, 1536
        return {
            "x": _w((lambda *s: torch.randn(*s, dtype=torch.bfloat16) * 0.05)(B, S, D)),
            "w1": _w((lambda *s: torch.randn(*s, dtype=torch.bfloat16) * 0.8)(D, F) * (D ** -0.5)),
            "b1": _w((lambda *s: torch.randn(*s, dtype=torch.bfloat16) * 0.4)(F)),
            "w2": _w((lambda *s: torch.randn(*s, dtype=torch.bfloat16) * 0.1)(F, D) * (F ** -0.5)),
        }
    _B_in = _B_setup()

    return {
        "A_x": _A_in["x"],
        "A_wqkv": _A_in["wqkv"],
        "A_wo": _A_in["wo"],
        "B_x": _B_in["x"],
        "B_w1": _B_in["w1"],
        "B_b1": _B_in["b1"],
        "B_w2": _B_in["w2"],
    }

def reference(A_x, A_wqkv, A_wo, B_x, B_w1, B_b1, B_w2):
    def _A_ref(x, wqkv, wo):
        B, S, D = x.shape
        H = 32; Dh = D // H
        qkv = (lambda x, *d: x.permute(*d))((x @ wqkv).reshape(B, S, 3, H, Dh), 2, 0, 3, 1, 4)
        q, k, v = qkv[0], qkv[1], qkv[2]
        phi = lambda t: torch.where(t > 0, t + 1, torch.exp(t)) + 1e-6
        pq, pk = phi(q), phi(k)
        kv = torch.einsum("bhsd,bhse->bhde", pk, v)
        z = torch.einsum("bhsd->bhd", pk)
        num = torch.einsum("bhqd,bhde->bhqe", pq, kv)
        den = torch.einsum("bhqd,bhd->bhq", pq, z)[..., None] + 1e-6
        o = num / den
        return (lambda x, *d: x.permute(*d))(o, 0, 2, 1, 3).reshape(B, S, D) @ wo

    def _B_ref(x, w1, b1, w2):
        h = torch.einsum("bsd,df->bsf", x, w1) + b1
        sp = torch.log1p(torch.exp(-torch.abs(h))) + torch.where(h > 0, h, torch.zeros_like(h))
        act = h * torch.tanh(sp)
        return torch.einsum("bsf,fd->bsd", act, w2)

    x = A_x
    xn = _layernorm(x, axis=-1)
    return x + _A_ref(xn, A_wqkv, A_wo) + _B_ref(xn, B_w1, B_b1, B_w2)
```

```asm
; @launch grid=(256,1,1) block=(512,1,1) lds=163840
.amdgcn_target "amdgcn-amd-amdhsa--gfx950"
.text
.globl parallel_sum__linear_attn_block__dense_activation_mish__prompt_kernel
.p2align 8
.type parallel_sum__linear_attn_block__dense_activation_mish__prompt_kernel,@function
parallel_sum__linear_attn_block__dense_activation_mish__prompt_kernel:
    s_cmp_ge_u32 s2, 256
    s_cbranch_scc1 L_end
    s_load_dwordx16 s[16:31], s[0:1], 0
    s_load_dwordx4 s[32:35], s[0:1], 64
    s_getpc_b64 s[64:65]
L_pc:
    v_lshrrev_b32 v1, 6, v0
    s_lshr_b32 s9, s2, 3
    v_and_b32 v0, 63, v0
    v_readfirstlane_b32 s3, v1
    s_cmp_eq_u32 s3, 4
    s_cbranch_scc0 L_nocpf
    s_mov_b32 s66, L_code_end-L_pc
    s_mov_b32 s67, 0x20000
    s_lshl_b32 s8, s9, 11
    v_lshl_add_u32 v2, v0, 7, s8
    s_mov_b64 exec, 0xffff
    buffer_load_dword v255, v2, s[64:67], 0 offen
    s_mov_b64 exec, -1
L_nocpf:
    s_and_b32 s4, s2, 1
    s_xor_b32 s4, s4, 1
    s_bfe_u32 s8, s2, 0x10001
    s_lshl_b32 s10, s8, 3
    s_and_b32 s11, s9, 7
    s_add_u32 s6, s10, s11
    s_lshr_b32 s12, s9, 3
    s_and_b32 s14, s2, 4
    s_add_u32 s5, s14, s12
    s_and_b32 s7, s3, 1
    s_mul_i32 s11, s11, 3
    s_mul_i32 s12, s12, 0
    s_add_u32 s11, s11, s12
    s_and_b32 s12, s8, 1
    s_mul_i32 s12, s12, 4
    s_add_u32 s11, s11, s12
    s_mul_i32 s12, s11, 6554
    s_lshr_b32 s12, s12, 16
    s_mul_i32 s12, s12, 10
    s_sub_u32 s69, s11, s12
    v_and_b32 v15, 15, v0
    v_lshrrev_b32 v14, 4, v0
    s_cmp_ge_u32 s3, 4
    s_cbranch_scc0 L_heavy
    s_sub_u32 s80, s3, 4
    s_cmp_eq_u32 s4, 0
    s_cbranch_scc0 L_h2b
    s_mul_i32 s88, s5, 160
    s_add_u32 s88, s88, 1280
    s_and_b32 s8, s80, 1
    s_lshl_b32 s9, s8, 2
    v_add_u32 v3, s9, v14
    v_and_b32 v4, 7, v0
    v_xor_b32 v3, v3, v4
    v_lshrrev_b32 v5, 3, v0
    v_mul_u32_u24 v6, 1280, v5
    v_lshl_add_u32 v108, v3, 4, v6
    s_mul_i32 s87, s6, 163840
    s_mul_i32 s9, s80, 10240
    s_add_u32 s87, s87, s9
    s_lshl_b32 s73, s80, 10
    v_and_b32 v3, 3, v5
    v_lshrrev_b32 v6, 2, v5
    v_lshl_add_u32 v3, v6, 3, v3
    v_mul_u32_u24 v3, 3072, v3
    v_lshrrev_b32 v6, 1, v4
    v_xor_b32 v6, v6, v14
    v_lshl_add_u32 v3, v6, 5, v3
    v_and_b32 v6, 1, v0
    v_lshl_add_u32 v112, v6, 4, v3
    s_lshr_b32 s9, s80, 1
    s_lshl_b32 s9, s9, 4
    s_lshl_b32 s8, s8, 2
    s_add_u32 s9, s9, s8
    s_mul_i32 s9, s9, 3072
    s_mul_i32 s89, s5, 384
    s_add_u32 s89, s89, s9
    s_lshl_b32 s8, s69, 7
    s_add_u32 s70, s87, s8
    s_mul_i32 s8, s69, 245760
    s_add_u32 s71, s88, s8
    s_mul_i32 s8, s69, 196608
    s_add_u32 s72, s89, s8
    s_add_u32 s69, s69, 1
    s_cmp_eq_u32 s69, 10
    s_cselect_b32 s69, 0, s69
    s_waitcnt lgkmcnt(0)
    s_mov_b32 s36, s16
    s_mov_b32 s37, s17
    s_mov_b32 s38, 2621440
    s_mov_b32 s39, 0x20000
    s_add_u32 m0, s73, 0
    s_nop 0
    buffer_load_dwordx4 v108, s[36:39], s70 offen lds
    s_add_u32 m0, s73, 4096
    s_add_u32 s76, s70, 40960
    buffer_load_dwordx4 v108, s[36:39], s76 offen lds
    s_add_u32 m0, s73, 8192
    s_add_u32 s76, s70, 81920
    buffer_load_dwordx4 v108, s[36:39], s76 offen lds
    s_add_u32 m0, s73, 12288
    s_add_u32 s76, s70, 122880
    buffer_load_dwordx4 v108, s[36:39], s76 offen lds
    s_mov_b32 s44, s24
    s_mov_b32 s45, s25
    s_mov_b32 s46, 1966080
    s_mov_b32 s47, 0x20000
    s_add_u32 m0, s73, 38912
    s_nop 0
    buffer_load_dwordx4 v112, s[44:47], s72 offen lds
    s_add_u32 m0, s73, 43008
    s_add_u32 s76, s72, 98304
    buffer_load_dwordx4 v112, s[44:47], s76 offen lds
    s_lshl_b32 s9, s80, 6
    s_add_u32 s9, s9, 0
    v_add_u32 v3, s9, v0
    v_mul_u32_u24 v4, 2979, v3
    v_lshrrev_b32 v4, 16, v4
    v_mul_u32_u24 v5, 22, v4
    v_sub_u32 v3, v3, v5
    v_and_b32 v6, 4, v4
    v_lshlrev_b32 v6, 1, v6
    v_and_or_b32 v5, v4, 51, v6
    v_bfe_u32 v6, v4, 3, 1
    v_lshl_or_b32 v5, v6, 2, v5
    v_mul_u32_u24 v5, 3840, v5
    v_lshl_add_u32 v5, v3, 4, v5
    v_cmp_lt_u32 vcc, 10, v3
    v_add_u32 v6, 1104, v5
    s_nop 0
    v_cndmask_b32 v5, v5, v6, vcc
    v_cmp_eq_u32 vcc, 10, v3
    v_cmp_eq_u32 s[10:11], 21, v3
    s_or_b64 vcc, vcc, s[10:11]
    v_mov_b32 v6, 2147418112
    v_cndmask_b32 v109, v5, v6, vcc
    s_mov_b32 s40, s18
    s_mov_b32 s41, s19
    s_mov_b32 s42, 2457600
    s_mov_b32 s43, 0x20000
    s_add_u32 m0, s73, 16384
    s_nop 0
    buffer_load_dwordx4 v109, s[40:43], s71 offen lds
    s_add_u32 m0, s73, 27648
    s_add_u32 s76, s71, 122880
    buffer_load_dwordx4 v109, s[40:43], s76 offen lds
    s_lshl_b32 s9, s80, 6
    s_add_u32 s9, s9, 256
    v_add_u32 v3, s9, v0
    v_mul_u32_u24 v4, 2979, v3
    v_lshrrev_b32 v4, 16, v4
    v_mul_u32_u24 v5, 22, v4
    v_sub_u32 v3, v3, v5
    v_and_b32 v6, 4, v4
    v_lshlrev_b32 v6, 1, v6
    v_and_or_b32 v5, v4, 51, v6
    v_bfe_u32 v6, v4, 3, 1
    v_lshl_or_b32 v5, v6, 2, v5
    v_mul_u32_u24 v5, 3840, v5
    v_lshl_add_u32 v5, v3, 4, v5
    v_cmp_lt_u32 vcc, 10, v3
    v_add_u32 v6, 1104, v5
    s_nop 0
    v_cndmask_b32 v5, v5, v6, vcc
    v_cmp_eq_u32 vcc, 10, v3
    v_cmp_eq_u32 s[10:11], 21, v3
    s_or_b64 vcc, vcc, s[10:11]
    v_mov_b32 v6, 2147418112
    v_cndmask_b32 v110, v5, v6, vcc
    s_add_u32 m0, s73, 20480
    s_nop 0
    buffer_load_dwordx4 v110, s[40:43], s71 offen lds
    s_add_u32 m0, s73, 31744
    s_add_u32 s76, s71, 122880
    buffer_load_dwordx4 v110, s[40:43], s76 offen lds
    s_lshl_b32 s9, s80, 6
    s_add_u32 s9, s9, 512
    v_add_u32 v3, s9, v0
    v_mul_u32_u24 v4, 2979, v3
    v_lshrrev_b32 v4, 16, v4
    v_mul_u32_u24 v5, 22, v4
    v_sub_u32 v3, v3, v5
    v_and_b32 v6, 4, v4
    v_lshlrev_b32 v6, 1, v6
    v_and_or_b32 v5, v4, 51, v6
    v_bfe_u32 v6, v4, 3, 1
    v_lshl_or_b32 v5, v6, 2, v5
    v_mul_u32_u24 v5, 3840, v5
    v_lshl_add_u32 v5, v3, 4, v5
    v_cmp_lt_u32 vcc, 10, v3
    v_add_u32 v6, 1104, v5
    s_nop 0
    v_cndmask_b32 v5, v5, v6, vcc
    v_cmp_eq_u32 vcc, 10, v3
    v_cmp_eq_u32 s[10:11], 21, v3
    s_or_b64 vcc, vcc, s[10:11]
    v_mov_b32 v6, 2147418112
    v_cndmask_b32 v111, v5, v6, vcc
    s_cmp_lt_u32 s80, 3
    s_cbranch_scc0 Lcd_1
    s_add_u32 m0, s73, 24576
    s_nop 0
    buffer_load_dwordx4 v111, s[40:43], s71 offen lds
    s_add_u32 m0, s73, 35840
    s_add_u32 s76, s71, 122880
    buffer_load_dwordx4 v111, s[40:43], s76 offen lds
Lcd_1:
    s_add_u32 s73, s73, 47104
    s_lshl_b32 s8, s69, 7
    s_add_u32 s70, s87, s8
    s_mul_i32 s8, s69, 245760
    s_add_u32 s71, s88, s8
    s_mul_i32 s8, s69, 196608
    s_add_u32 s72, s89, s8
    s_add_u32 s69, s69, 1
    s_cmp_eq_u32 s69, 10
    s_cselect_b32 s69, 0, s69
    s_add_u32 m0, s73, 0
    s_nop 0
    buffer_load_dwordx4 v108, s[36:39], s70 offen lds
    s_add_u32 m0, s73, 4096
    s_add_u32 s76, s70, 40960
    buffer_load_dwordx4 v108, s[36:39], s76 offen lds
    s_add_u32 m0, s73, 8192
    s_add_u32 s76, s70, 81920
    buffer_load_dwordx4 v108, s[36:39], s76 offen lds
    s_add_u32 m0, s73, 12288
    s_add_u32 s76, s70, 122880
    buffer_load_dwordx4 v108, s[36:39], s76 offen lds
    s_add_u32 m0, s73, 38912
    s_nop 0
    buffer_load_dwordx4 v112, s[44:47], s72 offen lds
    s_add_u32 m0, s73, 43008
    s_add_u32 s76, s72, 98304
    buffer_load_dwordx4 v112, s[44:47], s76 offen lds
    s_add_u32 m0, s73, 16384
    s_nop 0
    buffer_load_dwordx4 v109, s[40:43], s71 offen lds
    s_add_u32 m0, s73, 27648
    s_add_u32 s76, s71, 122880
    buffer_load_dwordx4 v109, s[40:43], s76 offen lds
    s_add_u32 m0, s73, 20480
    s_nop 0
    buffer_load_dwordx4 v110, s[40:43], s71 offen lds
    s_add_u32 m0, s73, 31744
    s_add_u32 s76, s71, 122880
    buffer_load_dwordx4 v110, s[40:43], s76 offen lds
    s_cmp_lt_u32 s80, 3
    s_cbranch_scc0 Lcd_2
    s_add_u32 m0, s73, 24576
    s_nop 0
    buffer_load_dwordx4 v111, s[40:43], s71 offen lds
    s_add_u32 m0, s73, 35840
    s_add_u32 s76, s71, 122880
    buffer_load_dwordx4 v111, s[40:43], s76 offen lds
Lcd_2:
    s_add_u32 s73, s73, 47104
    s_lshl_b32 s8, s69, 7
    s_add_u32 s70, s87, s8
    s_mul_i32 s8, s69, 245760
    s_add_u32 s71, s88, s8
    s_mul_i32 s8, s69, 196608
    s_add_u32 s72, s89, s8
    s_add_u32 s69, s69, 1
    s_cmp_eq_u32 s69, 10
    s_cselect_b32 s69, 0, s69
    s_add_u32 m0, s73, 0
    s_nop 0
    buffer_load_dwordx4 v108, s[36:39], s70 offen lds
    s_add_u32 m0, s73, 4096
    s_add_u32 s76, s70, 40960
    buffer_load_dwordx4 v108, s[36:39], s76 offen lds
    s_add_u32 m0, s73, 8192
    s_add_u32 s76, s70, 81920
    buffer_load_dwordx4 v108, s[36:39], s76 offen lds
    s_add_u32 m0, s73, 12288
    s_add_u32 s76, s70, 122880
    buffer_load_dwordx4 v108, s[36:39], s76 offen lds
    s_mov_b32 s74, 4294873088
    s_and_b32 s8, s2, 7
    s_lshr_b32 s9, s2, 3
    s_and_b32 s10, s8, 1
    s_lshl_b32 s10, s10, 3
    s_and_b32 s14, s8, 6
    s_lshl_b32 s10, s10, 1
    s_lshl_b32 s14, s14, 1
    s_add_u32 s10, s10, s14
    s_and_b32 s11, s9, 3
    s_add_u32 s78, s10, s11
    s_lshr_b32 s79, s9, 2
    s_mov_b32 s96, 2.0
    s_mov_b32 s97, 2.0
    s_mov_b32 s98, 3216077336
    s_mov_b32 s99, 1060205080
    s_mov_b32 s100, 1069066811
    s_mov_b32 s101, 897988541
    s_mov_b32 s68, 0
    s_mov_b32 s75, 0
    v_mov_b32 v11, 0x3f803f80
    v_lshlrev_b32 v8, 4, v0
    v_add_u32 v9, 4096, v8
    v_lshrrev_b32 v3, 1, v15
    v_xor_b32 v3, v3, v14
    v_lshlrev_b32 v3, 4, v3
    v_lshl_add_u32 v3, v15, 7, v3
    s_lshl_b32 s8, s7, 13
    v_add_u32 v1, s8, v3
    v_xor_b32 v2, 64, v1
    v_lshrrev_b32 v12, 5, v0
    v_lshlrev_b32 v12, 4, v12
    v_and_b32 v3, 1, v14
    v_lshl_add_u32 v12, v3, 2, v12
    v_bfe_u32 v3, v0, 2, 2
    v_add_u32 v12, v12, v3
    v_and_b32 v13, 3, v0
    v_lshlrev_b32 v13, 3, v13
    s_mov_b32 s48, s34
    s_mov_b32 s49, s35
    s_mov_b32 s50, 268435456
    s_mov_b32 s51, 0x20000
    s_mov_b32 s60, s26
    s_mov_b32 s61, s27
    s_mov_b32 s62, 3072
    s_mov_b32 s63, 0x20000
    s_lshr_b32 s8, s80, 1
    s_lshl_b32 s8, s8, 6
    s_mul_i32 s10, s5, 384
    s_add_u32 s8, s8, s10
    v_lshlrev_b32 v3, 3, v14
    buffer_load_dwordx2 v[114:115], v3, s[60:63], s8 offen
    buffer_load_dwordx2 v[116:117], v3, s[60:63], s8 offen offset:32
    s_lshr_b32 s8, s80, 1
    s_lshl_b32 s8, s8, 1
    v_bfe_u32 v5, v12, 1, 2
    v_lshl_add_u32 v6, v12, 7, v13
    v_xor_b32 v5, s8, v5
    v_lshl_add_u32 v3, v5, 5, v6
    v_add_u32 v3, 38912, v3
    v_xor_b32 v4, 32, v3
    s_mul_i32 s91, s80, 17
    s_mul_i32 s84, s79, 3
    s_lshr_b32 s84, s84, 1
    s_mov_b32 s85, s84
    s_mul_i32 s8, s79, 68
    s_add_u32 s8, s8, s91
    s_add_u32 s8, s8, s84
    s_mul_i32 s8, s8, 5120
    s_add_u32 s83, s8, 10485760
    s_mul_i32 s8, s78, 68
    s_add_u32 s8, s8, s91
    s_add_u32 s8, s8, s85
    s_lshl_b32 s8, s8, 12
    s_add_u32 s92, s8, 1048576
    s_mul_i32 s9, s79, 5
    s_lshr_b32 s9, s9, 2
    s_lshl_b32 s9, s9, 2
    s_lshl_b32 s10, s91, 6
    s_add_u32 s9, s9, s10
    s_add_u32 s9, s9, 24576
    v_min_u32 v14, 23, v0
    v_and_b32 v15, 1, v14
    v_lshrrev_b32 v14, 1, v14
    v_lshlrev_b32 v14, 6, v14
    v_lshl_add_u32 v14, v15, 2, v14
    v_add_u32 v12, s9, v14
    v_mov_b32 v16, 0
    v_mov_b32 v17, 0
    v_mov_b32 v18, 0
    v_mov_b32 v19, 0
    v_mov_b32 v20, 0
    v_mov_b32 v21, 0
    v_mov_b32 v22, 0
    v_mov_b32 v23, 0
    v_mov_b32 v24, 0
    v_mov_b32 v25, 0
    v_mov_b32 v26, 0
    v_mov_b32 v27, 0
    v_mov_b32 v28, 0
    v_mov_b32 v29, 0
    v_mov_b32 v30, 0
    v_mov_b32 v31, 0
    v_mov_b32 v32, 0
    v_mov_b32 v33, 0
    v_mov_b32 v34, 0
    v_mov_b32 v35, 0
    v_mov_b32 v36, 0
    v_mov_b32 v37, 0
    v_mov_b32 v38, 0
    v_mov_b32 v39, 0
    v_mov_b32 v40, 0
    v_mov_b32 v41, 0
    v_mov_b32 v42, 0
    v_mov_b32 v43, 0
    v_mov_b32 v44, 0
    v_mov_b32 v45, 0
    v_mov_b32 v46, 0
    v_mov_b32 v47, 0
    v_mov_b32 v48, 0
    v_mov_b32 v49, 0
    v_mov_b32 v50, 0
    v_mov_b32 v51, 0
    v_mov_b32 v52, 0
    v_mov_b32 v53, 0
    v_mov_b32 v54, 0
    v_mov_b32 v55, 0
    v_mov_b32 v104, 0x3f803f80
    v_mov_b32 v105, 0x3f803f80
    v_mov_b32 v106, 0x3f803f80
    v_mov_b32 v107, 0x3f803f80
    s_waitcnt vmcnt(18)
    s_cmp_lt_u32 s80, 3
    s_cbranch_scc1 Lw0_3
    s_waitcnt vmcnt(16)
Lw0_3:
    s_setprio 1
    s_waitcnt lgkmcnt(0)
    s_barrier
    ds_read_b128 v[56:59], v1 offset:0
    ds_read_b64_tr_b16 v[88:89], v3 offset:0
    ds_read_b64_tr_b16 v[90:91], v3 offset:1024
    ds_read_b128 v[60:63], v1 offset:2048
    ds_read_b64_tr_b16 v[92:93], v4 offset:0
    ds_read_b64_tr_b16 v[94:95], v4 offset:1024
    ds_read_b128 v[64:67], v1 offset:4096
    ds_read_b128 v[68:71], v1 offset:6144
L_loop_h2a:
    s_waitcnt lgkmcnt(0)
    v_mfma_f32_16x16x32_bf16 v[16:19], v[88:91], v[56:59], v[16:19]
    ds_read_b128 v[72:75], v2 offset:0
    ds_read_b64_tr_b16 v[96:97], v3 offset:4096
    v_mfma_f32_16x16x32_bf16 v[20:23], v[92:95], v[56:59], v[20:23]
    ds_read_b64_tr_b16 v[98:99], v3 offset:5120
    ds_read_b128 v[76:79], v2 offset:2048
    v_mfma_f32_16x16x32_bf16 v[24:27], v[88:91], v[60:63], v[24:27]
    ds_read_b64_tr_b16 v[100:101], v4 offset:4096
    ds_read_b64_tr_b16 v[102:103], v4 offset:5120
    v_mfma_f32_16x16x32_bf16 v[28:31], v[92:95], v[60:63], v[28:31]
    ds_read_b128 v[80:83], v2 offset:4096
    ds_read_b128 v[84:87], v2 offset:6144
    s_add_u32 m0, s73, 38912
    s_nop 0
    buffer_load_dwordx4 v112, s[44:47], s72 offen lds
    v_mfma_f32_16x16x32_bf16 v[32:35], v[88:91], v[64:67], v[32:35]
    s_add_u32 m0, s73, 43008
    s_add_u32 s76, s72, 98304
    buffer_load_dwordx4 v112, s[44:47], s76 offen lds
    v_mfma_f32_16x16x32_bf16 v[36:39], v[92:95], v[64:67], v[36:39]
    s_add_u32 m0, s73, 16384
    s_nop 0
    buffer_load_dwordx4 v109, s[40:43], s71 offen lds
    v_mfma_f32_16x16x32_bf16 v[40:43], v[88:91], v[68:71], v[40:43]
    s_add_u32 m0, s73, 27648
    s_add_u32 s76, s71, 122880
    buffer_load_dwordx4 v109, s[40:43], s76 offen lds
    v_mfma_f32_16x16x32_bf16 v[44:47], v[92:95], v[68:71], v[44:47]
    s_add_u32 m0, s73, 20480
    s_nop 0
    buffer_load_dwordx4 v110, s[40:43], s71 offen lds
    s_add_u32 m0, s73, 31744
    s_add_u32 s76, s71, 122880
    buffer_load_dwordx4 v110, s[40:43], s76 offen lds
    s_cmp_lt_u32 s80, 3
    s_cbranch_scc0 Lcd_4
    s_add_u32 m0, s73, 24576
    s_nop 0
    buffer_load_dwordx4 v111, s[40:43], s71 offen lds
    s_add_u32 m0, s73, 35840
    s_add_u32 s76, s71, 122880
    buffer_load_dwordx4 v111, s[40:43], s76 offen lds
Lcd_4:
    s_add_u32 s73, s73, s74
    s_add_u32 s75, s75, 1
    s_cmp_eq_u32 s75, 3
    s_cselect_b32 s74, -2, 1
    s_cselect_b32 s75, 0, s75
    s_mul_i32 s74, s74, 47104
    v_add_u32 v1, s74, v1
    v_add_u32 v2, s74, v2
    v_add_u32 v3, s74, v3
    v_add_u32 v4, s74, v4
    s_cmp_eq_u32 s7, 0
    s_cbranch_scc0 Lcs_5
    v_mfma_f32_16x16x32_bf16 v[48:51], v[88:91], v[104:107], v[48:51]
    v_mfma_f32_16x16x32_bf16 v[52:55], v[92:95], v[104:107], v[52:55]
Lcs_5:
    s_waitcnt vmcnt(12) lgkmcnt(0)
    s_cmp_lt_u32 s80, 3
    s_cbranch_scc1 Lvm_6
    s_waitcnt vmcnt(10)
Lvm_6:
    s_barrier
    v_mfma_f32_16x16x32_bf16 v[16:19], v[96:99], v[72:75], v[16:19]
    ds_read_b128 v[56:59], v1 offset:0
    ds_read_b64_tr_b16 v[88:89], v3 offset:0
    v_mfma_f32_16x16x32_bf16 v[20:23], v[100:103], v[72:75], v[20:23]
    ds_read_b64_tr_b16 v[90:91], v3 offset:1024
    ds_read_b128 v[60:63], v1 offset:2048
    v_mfma_f32_16x16x32_bf16 v[24:27], v[96:99], v[76:79], v[24:27]
    ds_read_b64_tr_b16 v[92:93], v4 offset:0
    ds_read_b64_tr_b16 v[94:95], v4 offset:1024
    v_mfma_f32_16x16x32_bf16 v[28:31], v[100:103], v[76:79], v[28:31]
    ds_read_b128 v[64:67], v1 offset:4096
    ds_read_b128 v[68:71], v1 offset:6144
    s_lshl_b32 s8, s69, 7
    s_add_u32 s70, s87, s8
    s_mul_i32 s8, s69, 245760
    s_add_u32 s71, s88, s8
    s_mul_i32 s8, s69, 196608
    s_add_u32 s72, s89, s8
    s_add_u32 s69, s69, 1
    s_cmp_eq_u32 s69, 10
    s_cselect_b32 s69, 0, s69
    s_cmp_eq_u32 s68, 6
    s_cbranch_scc0 Lnp_7
    buffer_load_dword v13, v12, s[48:51], 0 offen sc1
Lnp_7:
    s_add_u32 m0, s73, 0
    s_nop 0
    buffer_load_dwordx4 v108, s[36:39], s70 offen lds
    v_mfma_f32_16x16x32_bf16 v[32:35], v[96:99], v[80:83], v[32:35]
    s_add_u32 m0, s73, 4096
    s_add_u32 s76, s70, 40960
    buffer_load_dwordx4 v108, s[36:39], s76 offen lds
    v_mfma_f32_16x16x32_bf16 v[36:39], v[100:103], v[80:83], v[36:39]
    s_add_u32 m0, s73, 8192
    s_add_u32 s76, s70, 81920
    buffer_load_dwordx4 v108, s[36:39], s76 offen lds
    v_mfma_f32_16x16x32_bf16 v[40:43], v[96:99], v[84:87], v[40:43]
    s_add_u32 m0, s73, 12288
    s_add_u32 s76, s70, 122880
    buffer_load_dwordx4 v108, s[36:39], s76 offen lds
    v_mfma_f32_16x16x32_bf16 v[44:47], v[100:103], v[84:87], v[44:47]
    s_cmp_eq_u32 s7, 1
    s_cbranch_scc0 Lcs_8
    v_mfma_f32_16x16x32_bf16 v[48:51], v[96:99], v[104:107], v[48:51]
    v_mfma_f32_16x16x32_bf16 v[52:55], v[100:103], v[104:107], v[52:55]
Lcs_8:
    s_add_u32 s68, s68, 1
    s_cmp_lt_u32 s68, 7
    s_cbranch_scc1 L_loop_h2a
    v_mov_b32 v14, 163376
    ds_read_b32 v14, v14
    s_waitcnt lgkmcnt(0)
    v_mfma_f32_16x16x32_bf16 v[16:19], v[88:91], v[56:59], v[16:19]
    ds_read_b128 v[72:75], v2 offset:0
    ds_read_b64_tr_b16 v[96:97], v3 offset:4096
    v_mfma_f32_16x16x32_bf16 v[20:23], v[92:95], v[56:59], v[20:23]
    ds_read_b64_tr_b16 v[98:99], v3 offset:5120
    ds_read_b128 v[76:79], v2 offset:2048
    v_mfma_f32_16x16x32_bf16 v[24:27], v[88:91], v[60:63], v[24:27]
    ds_read_b64_tr_b16 v[100:101], v4 offset:4096
    ds_read_b64_tr_b16 v[102:103], v4 offset:5120
    v_mfma_f32_16x16x32_bf16 v[28:31], v[92:95], v[60:63], v[28:31]
    ds_read_b128 v[80:83], v2 offset:4096
    ds_read_b128 v[84:87], v2 offset:6144
    s_add_u32 m0, s73, 38912
    s_nop 0
    buffer_load_dwordx4 v112, s[44:47], s72 offen lds
    v_mfma_f32_16x16x32_bf16 v[32:35], v[88:91], v[64:67], v[32:35]
    s_add_u32 m0, s73, 43008
    s_add_u32 s76, s72, 98304
    buffer_load_dwordx4 v112, s[44:47], s76 offen lds
    v_mfma_f32_16x16x32_bf16 v[36:39], v[92:95], v[64:67], v[36:39]
    s_add_u32 m0, s73, 16384
    s_nop 0
    buffer_load_dwordx4 v109, s[40:43], s71 offen lds
    v_mfma_f32_16x16x32_bf16 v[40:43], v[88:91], v[68:71], v[40:43]
    s_add_u32 m0, s73, 27648
    s_add_u32 s76, s71, 122880
    buffer_load_dwordx4 v109, s[40:43], s76 offen lds
    v_mfma_f32_16x16x32_bf16 v[44:47], v[92:95], v[68:71], v[44:47]
    s_add_u32 m0, s73, 20480
    s_nop 0
    buffer_load_dwordx4 v110, s[40:43], s71 offen lds
    s_add_u32 m0, s73, 31744
    s_add_u32 s76, s71, 122880
    buffer_load_dwordx4 v110, s[40:43], s76 offen lds
    s_cmp_lt_u32 s80, 3
    s_cbranch_scc0 Lcd_9
    s_add_u32 m0, s73, 24576
    s_nop 0
    buffer_load_dwordx4 v111, s[40:43], s71 offen lds
    s_add_u32 m0, s73, 35840
    s_add_u32 s76, s71, 122880
    buffer_load_dwordx4 v111, s[40:43], s76 offen lds
Lcd_9:
    s_mul_i32 s73, s80, 5120
    v_readfirstlane_b32 s77, v14
    s_add_u32 s75, s75, 1
    s_cmp_eq_u32 s75, 3
    s_cselect_b32 s74, -2, 1
    s_cselect_b32 s75, 0, s75
    s_mul_i32 s74, s74, 47104
    v_add_u32 v1, s74, v1
    v_add_u32 v2, s74, v2
    v_add_u32 v3, s74, v3
    v_add_u32 v4, s74, v4
    s_cmp_eq_u32 s7, 0
    s_cbranch_scc0 Lcs_10
    v_mfma_f32_16x16x32_bf16 v[48:51], v[88:91], v[104:107], v[48:51]
    v_mfma_f32_16x16x32_bf16 v[52:55], v[92:95], v[104:107], v[52:55]
Lcs_10:
    s_waitcnt vmcnt(12) lgkmcnt(0)
    s_cmp_lt_u32 s80, 3
    s_cbranch_scc1 Lvm_11
    s_waitcnt vmcnt(10)
Lvm_11:
    s_barrier
    v_mfma_f32_16x16x32_bf16 v[16:19], v[96:99], v[72:75], v[16:19]
    ds_read_b128 v[56:59], v1 offset:0
    ds_read_b64_tr_b16 v[88:89], v3 offset:0
    v_mfma_f32_16x16x32_bf16 v[20:23], v[100:103], v[72:75], v[20:23]
    ds_read_b64_tr_b16 v[90:91], v3 offset:1024
    ds_read_b128 v[60:63], v1 offset:2048
    v_mfma_f32_16x16x32_bf16 v[24:27], v[96:99], v[76:79], v[24:27]
    ds_read_b64_tr_b16 v[92:93], v4 offset:0
    ds_read_b64_tr_b16 v[94:95], v4 offset:1024
    v_mfma_f32_16x16x32_bf16 v[28:31], v[100:103], v[76:79], v[28:31]
    ds_read_b128 v[64:67], v1 offset:4096
    ds_read_b128 v[68:71], v1 offset:6144
    s_mov_b32 s8, 0
    s_branch Lchk_rp_13
Lpoll_rp_12:
    buffer_load_dword v13, v12, s[48:51], 0 offen sc1
    s_waitcnt vmcnt(0)
Lchk_rp_13:
    s_add_u32 s8, s8, 1
    s_cmp_ge_u32 s8, 100000
    s_cbranch_scc1 Ldone_rp_14
    v_cmp_ne_u32 vcc, s77, v13
    s_cbranch_vccnz Lpoll_rp_12
Ldone_rp_14:
    buffer_load_dwordx4 v[156:159], v8, s[48:51], s83 offen offset:0 sc1
    v_mfma_f32_16x16x32_bf16 v[32:35], v[96:99], v[80:83], v[32:35]
    buffer_load_dwordx4 v[160:163], v8, s[48:51], s83 offen offset:1024 sc1
    v_mfma_f32_16x16x32_bf16 v[36:39], v[100:103], v[80:83], v[36:39]
    buffer_load_dwordx4 v[164:167], v8, s[48:51], s83 offen offset:2048 sc1
    v_mfma_f32_16x16x32_bf16 v[40:43], v[96:99], v[84:87], v[40:43]
    buffer_load_dwordx4 v[168:171], v8, s[48:51], s83 offen offset:3072 sc1
    v_mfma_f32_16x16x32_bf16 v[44:47], v[100:103], v[84:87], v[44:47]
    buffer_load_dwordx4 v[172:175], v9, s[48:51], s83 offen offset:0 sc1
    s_add_u32 s83, s83, 5120
    s_add_u32 s84, s84, 1
    s_cmp_eq_u32 s84, 12
    s_cselect_b32 s8, 61440, 0
    s_cselect_b32 s84, 0, s84
    s_sub_u32 s83, s83, s8
    buffer_load_dwordx4 v[176:179], v8, s[48:51], s83 offen offset:0 sc1
    buffer_load_dwordx4 v[180:183], v8, s[48:51], s83 offen offset:1024 sc1
    s_cmp_eq_u32 s7, 1
    s_cbranch_scc0 Lcs_15
    v_mfma_f32_16x16x32_bf16 v[48:51], v[96:99], v[104:107], v[48:51]
    v_mfma_f32_16x16x32_bf16 v[52:55], v[100:103], v[104:107], v[52:55]
Lcs_15:
    s_waitcnt lgkmcnt(0)
    v_mfma_f32_16x16x32_bf16 v[16:19], v[88:91], v[56:59], v[16:19]
    ds_read_b128 v[72:75], v2 offset:0
    ds_read_b64_tr_b16 v[96:97], v3 offset:4096
    v_mfma_f32_16x16x32_bf16 v[20:23], v[92:95], v[56:59], v[20:23]
    ds_read_b64_tr_b16 v[98:99], v3 offset:5120
    ds_read_b128 v[76:79], v2 offset:2048
    v_mfma_f32_16x16x32_bf16 v[24:27], v[88:91], v[60:63], v[24:27]
    ds_read_b64_tr_b16 v[100:101], v4 offset:4096
    ds_read_b64_tr_b16 v[102:103], v4 offset:5120
    v_mfma_f32_16x16x32_bf16 v[28:31], v[92:95], v[60:63], v[28:31]
    ds_read_b128 v[80:83], v2 offset:4096
    ds_read_b128 v[84:87], v2 offset:6144
    buffer_load_dwordx4 v[184:187], v8, s[48:51], s83 offen offset:2048 sc1
    v_mfma_f32_16x16x32_bf16 v[32:35], v[88:91], v[64:67], v[32:35]
    buffer_load_dwordx4 v[188:191], v8, s[48:51], s83 offen offset:3072 sc1
    v_mfma_f32_16x16x32_bf16 v[36:39], v[92:95], v[64:67], v[36:39]
    buffer_load_dwordx4 v[192:195], v9, s[48:51], s83 offen offset:0 sc1
    s_add_u32 s83, s83, 5120
    s_add_u32 s84, s84, 1
    s_cmp_eq_u32 s84, 12
    s_cselect_b32 s8, 61440, 0
    s_cselect_b32 s84, 0, s84
    s_sub_u32 s83, s83, s8
    v_mfma_f32_16x16x32_bf16 v[40:43], v[88:91], v[68:71], v[40:43]
    buffer_load_dwordx4 v[196:199], v8, s[48:51], s83 offen offset:0 sc1
    v_mfma_f32_16x16x32_bf16 v[44:47], v[92:95], v[68:71], v[44:47]
    buffer_load_dwordx4 v[200:203], v8, s[48:51], s83 offen offset:1024 sc1
    buffer_load_dwordx4 v[204:207], v8, s[48:51], s83 offen offset:2048 sc1
    buffer_load_dwordx4 v[208:211], v8, s[48:51], s83 offen offset:3072 sc1
    s_add_u32 s75, s75, 1
    s_cmp_eq_u32 s75, 3
    s_cselect_b32 s74, -2, 1
    s_cselect_b32 s75, 0, s75
    s_mul_i32 s74, s74, 47104
    v_add_u32 v1, s74, v1
    v_add_u32 v2, s74, v2
    v_add_u32 v3, s74, v3
    v_add_u32 v4, s74, v4
    s_cmp_eq_u32 s7, 0
    s_cbranch_scc0 Lcs_16
    v_mfma_f32_16x16x32_bf16 v[48:51], v[88:91], v[104:107], v[48:51]
    v_mfma_f32_16x16x32_bf16 v[52:55], v[92:95], v[104:107], v[52:55]
Lcs_16:
    s_waitcnt vmcnt(14) lgkmcnt(0)
    s_mov_b32 s68, 8
    s_barrier
    v_mfma_f32_16x16x32_bf16 v[16:19], v[96:99], v[72:75], v[16:19]
    ds_read_b128 v[56:59], v1 offset:0
    ds_read_b64_tr_b16 v[88:89], v3 offset:0
    v_mfma_f32_16x16x32_bf16 v[20:23], v[100:103], v[72:75], v[20:23]
    ds_read_b64_tr_b16 v[90:91], v3 offset:1024
    ds_read_b128 v[60:63], v1 offset:2048
    v_mfma_f32_16x16x32_bf16 v[24:27], v[96:99], v[76:79], v[24:27]
    ds_read_b64_tr_b16 v[92:93], v4 offset:0
    ds_read_b64_tr_b16 v[94:95], v4 offset:1024
    v_mfma_f32_16x16x32_bf16 v[28:31], v[100:103], v[76:79], v[28:31]
    ds_read_b128 v[64:67], v1 offset:4096
    ds_read_b128 v[68:71], v1 offset:6144
    buffer_load_dwordx4 v[212:215], v9, s[48:51], s83 offen offset:0 sc1
    s_add_u32 s83, s83, 5120
    s_add_u32 s84, s84, 1
    s_cmp_eq_u32 s84, 12
    s_cselect_b32 s8, 61440, 0
    s_cselect_b32 s84, 0, s84
    s_sub_u32 s83, s83, s8
    v_mfma_f32_16x16x32_bf16 v[32:35], v[96:99], v[80:83], v[32:35]
    buffer_load_dwordx4 v[216:219], v8, s[48:51], s83 offen offset:0 sc1
    v_mfma_f32_16x16x32_bf16 v[36:39], v[100:103], v[80:83], v[36:39]
    buffer_load_dwordx4 v[220:223], v8, s[48:51], s83 offen offset:1024 sc1
    v_mfma_f32_16x16x32_bf16 v[40:43], v[96:99], v[84:87], v[40:43]
    buffer_load_dwordx4 v[224:227], v8, s[48:51], s83 offen offset:2048 sc1
    v_mfma_f32_16x16x32_bf16 v[44:47], v[100:103], v[84:87], v[44:47]
    buffer_load_dwordx4 v[228:231], v8, s[48:51], s83 offen offset:3072 sc1
    buffer_load_dwordx4 v[232:235], v9, s[48:51], s83 offen offset:0 sc1
    s_add_u32 s83, s83, 5120
    s_add_u32 s84, s84, 1
    s_cmp_eq_u32 s84, 12
    s_cselect_b32 s8, 61440, 0
    s_cselect_b32 s84, 0, s84
    s_sub_u32 s83, s83, s8
    buffer_load_dwordx4 v[236:239], v8, s[48:51], s83 offen offset:0 sc1
    s_cmp_eq_u32 s7, 1
    s_cbranch_scc0 Lcs_17
    v_mfma_f32_16x16x32_bf16 v[48:51], v[96:99], v[104:107], v[48:51]
    v_mfma_f32_16x16x32_bf16 v[52:55], v[100:103], v[104:107], v[52:55]
Lcs_17:
    s_waitcnt lgkmcnt(0)
    v_mfma_f32_16x16x32_bf16 v[16:19], v[88:91], v[56:59], v[16:19]
    ds_read_b128 v[72:75], v2 offset:0
    ds_read_b64_tr_b16 v[96:97], v3 offset:4096
    v_mfma_f32_16x16x32_bf16 v[20:23], v[92:95], v[56:59], v[20:23]
    ds_read_b64_tr_b16 v[98:99], v3 offset:5120
    ds_read_b128 v[76:79], v2 offset:2048
    v_mfma_f32_16x16x32_bf16 v[24:27], v[88:91], v[60:63], v[24:27]
    ds_read_b64_tr_b16 v[100:101], v4 offset:4096
    ds_read_b64_tr_b16 v[102:103], v4 offset:5120
    v_mfma_f32_16x16x32_bf16 v[28:31], v[92:95], v[60:63], v[28:31]
    ds_read_b128 v[80:83], v2 offset:4096
    ds_read_b128 v[84:87], v2 offset:6144
    buffer_load_dwordx4 v[240:243], v8, s[48:51], s83 offen offset:1024 sc1
    v_mfma_f32_16x16x32_bf16 v[32:35], v[88:91], v[64:67], v[32:35]
    buffer_load_dwordx4 v[244:247], v8, s[48:51], s83 offen offset:2048 sc1
    v_mfma_f32_16x16x32_bf16 v[36:39], v[92:95], v[64:67], v[36:39]
    buffer_load_dwordx4 v[248:251], v8, s[48:51], s83 offen offset:3072 sc1
    v_mfma_f32_16x16x32_bf16 v[40:43], v[88:91], v[68:71], v[40:43]
    buffer_load_dwordx4 v[252:255], v9, s[48:51], s83 offen offset:0 sc1
    s_add_u32 s83, s83, 5120
    s_add_u32 s84, s84, 1
    s_cmp_eq_u32 s84, 12
    s_cselect_b32 s8, 61440, 0
    s_cselect_b32 s84, 0, s84
    s_sub_u32 s83, s83, s8
    v_mfma_f32_16x16x32_bf16 v[44:47], v[92:95], v[68:71], v[44:47]
    s_add_u32 m0, s73, 61440
    s_nop 0
    buffer_load_dwordx4 v8, s[48:51], s83 offen offset:0 sc1 lds
    buffer_load_dwordx4 v8, s[48:51], s83 offen offset:1024 sc1 lds
    buffer_load_dwordx4 v8, s[48:51], s83 offen offset:2048 sc1 lds
    s_cmp_eq_u32 s7, 0
    s_cbranch_scc0 Lcs_18
    v_mfma_f32_16x16x32_bf16 v[48:51], v[88:91], v[104:107], v[48:51]
    v_mfma_f32_16x16x32_bf16 v[52:55], v[92:95], v[104:107], v[52:55]
Lcs_18:
    s_waitcnt lgkmcnt(0)
    v_mfma_f32_16x16x32_bf16 v[16:19], v[96:99], v[72:75], v[16:19]
    v_mfma_f32_16x16x32_bf16 v[20:23], v[100:103], v[72:75], v[20:23]
    v_mfma_f32_16x16x32_bf16 v[24:27], v[96:99], v[76:79], v[24:27]
    v_mfma_f32_16x16x32_bf16 v[28:31], v[100:103], v[76:79], v[28:31]
    buffer_load_dwordx4 v8, s[48:51], s83 offen offset:3072 sc1 lds
    v_mfma_f32_16x16x32_bf16 v[32:35], v[96:99], v[80:83], v[32:35]
    s_add_u32 m0, s73, 65536
    s_nop 0
    buffer_load_dwordx4 v9, s[48:51], s83 offen offset:0 sc1 lds
    s_add_u32 s83, s83, 5120
    s_add_u32 s84, s84, 1
    s_cmp_eq_u32 s84, 12
    s_cselect_b32 s8, 61440, 0
    s_cselect_b32 s84, 0, s84
    s_sub_u32 s83, s83, s8
    v_mfma_f32_16x16x32_bf16 v[36:39], v[100:103], v[80:83], v[36:39]
    s_add_u32 m0, s73, 81920
    s_nop 0
    buffer_load_dwordx4 v8, s[48:51], s83 offen offset:0 sc1 lds
    v_mfma_f32_16x16x32_bf16 v[40:43], v[96:99], v[84:87], v[40:43]
    buffer_load_dwordx4 v8, s[48:51], s83 offen offset:1024 sc1 lds
    v_mfma_f32_16x16x32_bf16 v[44:47], v[100:103], v[84:87], v[44:47]
    buffer_load_dwordx4 v8, s[48:51], s83 offen offset:2048 sc1 lds
    buffer_load_dwordx4 v8, s[48:51], s83 offen offset:3072 sc1 lds
    s_add_u32 m0, s73, 86016
    s_nop 0
    buffer_load_dwordx4 v9, s[48:51], s83 offen offset:0 sc1 lds
    s_add_u32 s83, s83, 5120
    s_add_u32 s84, s84, 1
    s_cmp_eq_u32 s84, 12
    s_cselect_b32 s8, 61440, 0
    s_cselect_b32 s84, 0, s84
    s_sub_u32 s83, s83, s8
    s_cmp_eq_u32 s7, 1
    s_cbranch_scc0 Lcs_19
    v_mfma_f32_16x16x32_bf16 v[48:51], v[96:99], v[104:107], v[48:51]
    v_mfma_f32_16x16x32_bf16 v[52:55], v[100:103], v[104:107], v[52:55]
Lcs_19:
    s_setprio 0
    s_mul_i32 s8, s3, 320
    s_add_u32 s8, s8, 160768
    v_add_u32 v14, s8, v0
    s_mov_b32 exec_lo, 0x00010001
    s_mov_b32 exec_hi, 0x00010001
    s_nop 0
    ds_write_b128 v14, v[48:51] offset:0
    ds_write_b128 v14, v[52:55] offset:64
    s_mov_b64 exec, -1
    s_waitcnt lgkmcnt(0)
    s_barrier
    s_xor_b32 s8, s3, 1
    s_mul_i32 s8, s8, 320
    s_add_u32 s8, s8, 160768
    v_and_b32 v14, 48, v0
    v_add_u32 v14, s8, v14
    ds_read_b128 v[56:59], v14 offset:0
    ds_read_b128 v[60:63], v14 offset:64
    s_lshl_b32 s8, s7, 8
    s_add_u32 s8, s8, 159744
    v_and_b32 v15, 15, v0
    v_lshl_add_u32 v15, v15, 2, s8
    ds_read2_b32 v[64:65], v15 offset0:0 offset1:128
    ds_read2_b32 v[66:67], v15 offset0:16 offset1:144
    ds_read2_b32 v[68:69], v15 offset0:32 offset1:160
    ds_read2_b32 v[70:71], v15 offset0:48 offset1:176
    s_add_u32 m0, s73, 102400
    s_nop 0
    buffer_load_dwordx4 v8, s[48:51], s83 offen offset:0 sc1 lds
    buffer_load_dwordx4 v8, s[48:51], s83 offen offset:1024 sc1 lds
    buffer_load_dwordx4 v8, s[48:51], s83 offen offset:2048 sc1 lds
    buffer_load_dwordx4 v8, s[48:51], s83 offen offset:3072 sc1 lds
    s_add_u32 m0, s73, 106496
    s_nop 0
    buffer_load_dwordx4 v9, s[48:51], s83 offen offset:0 sc1 lds
    s_add_u32 s83, s83, 5120
    s_add_u32 s84, s84, 1
    s_cmp_eq_u32 s84, 12
    s_cselect_b32 s8, 61440, 0
    s_cselect_b32 s84, 0, s84
    s_sub_u32 s83, s83, s8
    s_add_u32 m0, s73, 122880
    s_nop 0
    buffer_load_dwordx4 v8, s[48:51], s83 offen offset:0 sc1 lds
    buffer_load_dwordx4 v8, s[48:51], s83 offen offset:1024 sc1 lds
    buffer_load_dwordx4 v8, s[48:51], s83 offen offset:2048 sc1 lds
    buffer_load_dwordx4 v8, s[48:51], s83 offen offset:3072 sc1 lds
    s_add_u32 m0, s73, 126976
    s_nop 0
    buffer_load_dwordx4 v9, s[48:51], s83 offen offset:0 sc1 lds
    s_add_u32 s83, s83, 5120
    s_add_u32 s84, s84, 1
    s_cmp_eq_u32 s84, 12
    s_cselect_b32 s8, 61440, 0
    s_cselect_b32 s84, 0, s84
    s_sub_u32 s83, s83, s8
    s_mul_i32 s9, s78, 81920
    s_mul_i32 s10, s79, 160
    s_add_u32 s9, s9, s10
    s_mul_i32 s10, s80, 20480
    s_add_u32 s9, s9, s10
    v_and_b32 v106, 15, v0
    v_mul_u32_u24 v106, 1280, v106
    v_lshrrev_b32 v108, 4, v0
    v_lshl_add_u32 v107, v108, 3, v106
    v_bfe_u32 v108, v0, 4, 1
    v_lshl_add_u32 v106, v108, 5, v106
    v_lshrrev_b32 v108, 5, v0
    v_lshl_add_u32 v106, v108, 4, v106
    buffer_load_dwordx4 v[96:99], v106, s[36:39], s9 offen
    buffer_load_dwordx4 v[100:103], v106, s[36:39], s9 offen offset:64
    buffer_load_dwordx2 v[104:105], v107, s[36:39], s9 offen offset:128
    s_lshr_b32 s8, s5, 1
    s_mul_i32 s9, s8, 17
    s_and_b32 s8, s5, 1
    s_lshl_b32 s8, s8, 1
    s_add_u32 s9, s9, s8
    s_lshr_b32 s8, s80, 1
    s_add_u32 s9, s9, s8
    s_add_u32 s9, s9, 8
    s_lshl_b32 s10, s6, 1
    s_add_u32 s10, s10, s7
    s_mul_i32 s11, s10, 768
    s_lshl_b32 s12, s9, 2
    s_add_u32 s11, s11, s12
    s_add_u32 s71, s11, 655360
    s_mul_i32 s10, s10, 68
    s_add_u32 s10, s10, s9
    s_lshl_b32 s10, s10, 12
    s_add_u32 s70, s10, 1048576
    v_lshlrev_b32 v72, 16, v114
    v_and_b32 v73, 0xffff0000, v114
    v_lshlrev_b32 v74, 16, v115
    v_and_b32 v75, 0xffff0000, v115
    v_lshlrev_b32 v76, 16, v116
    v_and_b32 v77, 0xffff0000, v116
    v_lshlrev_b32 v78, 16, v117
    v_and_b32 v79, 0xffff0000, v117
    v_pk_mul_f32 v[72:73], v[72:73], s[100:101] op_sel_hi:[1,0]
    v_pk_mul_f32 v[74:75], v[74:75], s[100:101] op_sel_hi:[1,0]
    v_pk_mul_f32 v[76:77], v[76:77], s[100:101] op_sel_hi:[1,0]
    v_pk_mul_f32 v[78:79], v[78:79], s[100:101] op_sel_hi:[1,0]
    s_waitcnt lgkmcnt(0)
    v_pk_add_f32 v[48:49], v[48:49], v[56:57]
    v_pk_add_f32 v[50:51], v[50:51], v[58:59]
    v_pk_add_f32 v[52:53], v[52:53], v[60:61]
    v_pk_add_f32 v[54:55], v[54:55], v[62:63]
    v_mul_f32 v64, s100, v64
    v_mul_f32 v66, s100, v66
    v_mul_f32 v68, s100, v68
    v_mul_f32 v70, s100, v70
    v_pk_mul_f32 v[48:49], v[48:49], s[100:101] op_sel_hi:[1,0]
    v_pk_mul_f32 v[50:51], v[50:51], s[100:101] op_sel_hi:[1,0]
    v_pk_mul_f32 v[52:53], v[52:53], s[100:101] op_sel_hi:[1,0]
    v_pk_mul_f32 v[54:55], v[54:55], s[100:101] op_sel_hi:[1,0]
    v_pk_fma_f32 v[120:121], v[64:65], v[48:49], v[72:73] op_sel:[1,0,0]
    v_pk_fma_f32 v[122:123], v[64:65], v[50:51], v[74:75] op_sel:[1,0,0]
    v_pk_fma_f32 v[124:125], v[64:65], v[52:53], v[76:77] op_sel:[1,0,0]
    v_pk_fma_f32 v[126:127], v[64:65], v[54:55], v[78:79] op_sel:[1,0,0]
    v_pk_fma_f32 v[120:121], v[16:17], v[64:65], v[120:121] op_sel_hi:[1,0,1]
    v_pk_fma_f32 v[122:123], v[18:19], v[64:65], v[122:123] op_sel_hi:[1,0,1]
    v_pk_fma_f32 v[124:125], v[20:21], v[64:65], v[124:125] op_sel_hi:[1,0,1]
    v_pk_fma_f32 v[126:127], v[22:23], v[64:65], v[126:127] op_sel_hi:[1,0,1]
    v_exp_f32 v128, v120
    v_exp_f32 v129, v121
    v_exp_f32 v130, v122
    v_exp_f32 v131, v123
    v_exp_f32 v132, v124
    v_exp_f32 v133, v125
    v_exp_f32 v134, v126
    v_exp_f32 v135, v127
    v_pk_add_f32 v[136:137], v[128:129], 2.0 op_sel_hi:[1,0]
    v_pk_add_f32 v[138:139], v[130:131], 2.0 op_sel_hi:[1,0]
    v_pk_add_f32 v[140:141], v[132:133], 2.0 op_sel_hi:[1,0]
    v_pk_add_f32 v[142:143], v[134:135], 2.0 op_sel_hi:[1,0]
    v_pk_fma_f32 v[136:137], v[128:129], v[136:137], 2.0 op_sel_hi:[1,1,0]
    v_pk_fma_f32 v[138:139], v[130:131], v[138:139], 2.0 op_sel_hi:[1,1,0]
    v_pk_fma_f32 v[140:141], v[132:133], v[140:141], 2.0 op_sel_hi:[1,1,0]
    v_pk_fma_f32 v[142:143], v[134:135], v[142:143], 2.0 op_sel_hi:[1,1,0]
    v_rcp_f32 v136, v136
    v_rcp_f32 v137, v137
    v_rcp_f32 v138, v138
    v_rcp_f32 v139, v139
    v_rcp_f32 v140, v140
    v_rcp_f32 v141, v141
    v_rcp_f32 v142, v142
    v_rcp_f32 v143, v143
    v_pk_fma_f32 v[136:137], v[136:137], s[98:99], s[98:99] op_sel:[0,0,1] op_sel_hi:[1,0,1]
    v_pk_fma_f32 v[138:139], v[138:139], s[98:99], s[98:99] op_sel:[0,0,1] op_sel_hi:[1,0,1]
    v_pk_fma_f32 v[140:141], v[140:141], s[98:99], s[98:99] op_sel:[0,0,1] op_sel_hi:[1,0,1]
    v_pk_fma_f32 v[142:143], v[142:143], s[98:99], s[98:99] op_sel:[0,0,1] op_sel_hi:[1,0,1]
    v_pk_mul_f32 v[120:121], v[120:121], v[136:137]
    v_pk_mul_f32 v[122:123], v[122:123], v[138:139]
    v_pk_mul_f32 v[124:125], v[124:125], v[140:141]
    v_pk_mul_f32 v[126:127], v[126:127], v[142:143]
    v_cvt_pk_bf16_f32 v144, v120, v121
    v_cvt_pk_bf16_f32 v145, v122, v123
    v_cvt_pk_bf16_f32 v146, v124, v125
    v_cvt_pk_bf16_f32 v147, v126, v127
    buffer_store_dwordx4 v[144:147], v8, s[48:51], s70 offen offset:0 sc1
    v_pk_fma_f32 v[120:121], v[66:67], v[48:49], v[72:73] op_sel:[1,0,0]
    v_pk_fma_f32 v[122:123], v[66:67], v[50:51], v[74:75] op_sel:[1,0,0]
    v_pk_fma_f32 v[124:125], v[66:67], v[52:53], v[76:77] op_sel:[1,0,0]
    v_pk_fma_f32 v[126:127], v[66:67], v[54:55], v[78:79] op_sel:[1,0,0]
    v_pk_fma_f32 v[120:121], v[24:25], v[66:67], v[120:121] op_sel_hi:[1,0,1]
    v_pk_fma_f32 v[122:123], v[26:27], v[66:67], v[122:123] op_sel_hi:[1,0,1]
    v_pk_fma_f32 v[124:125], v[28:29], v[66:67], v[124:125] op_sel_hi:[1,0,1]
    v_pk_fma_f32 v[126:127], v[30:31], v[66:67], v[126:127] op_sel_hi:[1,0,1]
    v_exp_f32 v128, v120
    v_exp_f32 v129, v121
    v_exp_f32 v130, v122
    v_exp_f32 v131, v123
    v_exp_f32 v132, v124
    v_exp_f32 v133, v125
    v_exp_f32 v134, v126
    v_exp_f32 v135, v127
    v_pk_add_f32 v[136:137], v[128:129], 2.0 op_sel_hi:[1,0]
    v_pk_add_f32 v[138:139], v[130:131], 2.0 op_sel_hi:[1,0]
    v_pk_add_f32 v[140:141], v[132:133], 2.0 op_sel_hi:[1,0]
    v_pk_add_f32 v[142:143], v[134:135], 2.0 op_sel_hi:[1,0]
    v_pk_fma_f32 v[136:137], v[128:129], v[136:137], 2.0 op_sel_hi:[1,1,0]
    v_pk_fma_f32 v[138:139], v[130:131], v[138:139], 2.0 op_sel_hi:[1,1,0]
    v_pk_fma_f32 v[140:141], v[132:133], v[140:141], 2.0 op_sel_hi:[1,1,0]
    v_pk_fma_f32 v[142:143], v[134:135], v[142:143], 2.0 op_sel_hi:[1,1,0]
    v_rcp_f32 v136, v136
    v_rcp_f32 v137, v137
    v_rcp_f32 v138, v138
    v_rcp_f32 v139, v139
    v_rcp_f32 v140, v140
    v_rcp_f32 v141, v141
    v_rcp_f32 v142, v142
    v_rcp_f32 v143, v143
    v_pk_fma_f32 v[136:137], v[136:137], s[98:99], s[98:99] op_sel:[0,0,1] op_sel_hi:[1,0,1]
    v_pk_fma_f32 v[138:139], v[138:139], s[98:99], s[98:99] op_sel:[0,0,1] op_sel_hi:[1,0,1]
    v_pk_fma_f32 v[140:141], v[140:141], s[98:99], s[98:99] op_sel:[0,0,1] op_sel_hi:[1,0,1]
    v_pk_fma_f32 v[142:143], v[142:143], s[98:99], s[98:99] op_sel:[0,0,1] op_sel_hi:[1,0,1]
    v_pk_mul_f32 v[120:121], v[120:121], v[136:137]
    v_pk_mul_f32 v[122:123], v[122:123], v[138:139]
    v_pk_mul_f32 v[124:125], v[124:125], v[140:141]
    v_pk_mul_f32 v[126:127], v[126:127], v[142:143]
    v_cvt_pk_bf16_f32 v148, v120, v121
    v_cvt_pk_bf16_f32 v149, v122, v123
    v_cvt_pk_bf16_f32 v150, v124, v125
    v_cvt_pk_bf16_f32 v151, v126, v127
    buffer_store_dwordx4 v[148:151], v8, s[48:51], s70 offen offset:1024 sc1
    v_pk_fma_f32 v[120:121], v[68:69], v[48:49], v[72:73] op_sel:[1,0,0]
    v_pk_fma_f32 v[122:123], v[68:69], v[50:51], v[74:75] op_sel:[1,0,0]
    v_pk_fma_f32 v[124:125], v[68:69], v[52:53], v[76:77] op_sel:[1,0,0]
    v_pk_fma_f32 v[126:127], v[68:69], v[54:55], v[78:79] op_sel:[1,0,0]
    v_pk_fma_f32 v[120:121], v[32:33], v[68:69], v[120:121] op_sel_hi:[1,0,1]
    v_pk_fma_f32 v[122:123], v[34:35], v[68:69], v[122:123] op_sel_hi:[1,0,1]
    v_pk_fma_f32 v[124:125], v[36:37], v[68:69], v[124:125] op_sel_hi:[1,0,1]
    v_pk_fma_f32 v[126:127], v[38:39], v[68:69], v[126:127] op_sel_hi:[1,0,1]
    v_exp_f32 v128, v120
    v_exp_f32 v129, v121
    v_exp_f32 v130, v122
    v_exp_f32 v131, v123
    v_exp_f32 v132, v124
    v_exp_f32 v133, v125
    v_exp_f32 v134, v126
    v_exp_f32 v135, v127
    v_pk_add_f32 v[136:137], v[128:129], 2.0 op_sel_hi:[1,0]
    v_pk_add_f32 v[138:139], v[130:131], 2.0 op_sel_hi:[1,0]
    v_pk_add_f32 v[140:141], v[132:133], 2.0 op_sel_hi:[1,0]
    v_pk_add_f32 v[142:143], v[134:135], 2.0 op_sel_hi:[1,0]
    v_pk_fma_f32 v[136:137], v[128:129], v[136:137], 2.0 op_sel_hi:[1,1,0]
    v_pk_fma_f32 v[138:139], v[130:131], v[138:139], 2.0 op_sel_hi:[1,1,0]
    v_pk_fma_f32 v[140:141], v[132:133], v[140:141], 2.0 op_sel_hi:[1,1,0]
    v_pk_fma_f32 v[142:143], v[134:135], v[142:143], 2.0 op_sel_hi:[1,1,0]
    v_rcp_f32 v136, v136
    v_rcp_f32 v137, v137
    v_rcp_f32 v138, v138
    v_rcp_f32 v139, v139
    v_rcp_f32 v140, v140
    v_rcp_f32 v141, v141
    v_rcp_f32 v142, v142
    v_rcp_f32 v143, v143
    v_pk_fma_f32 v[136:137], v[136:137], s[98:99], s[98:99] op_sel:[0,0,1] op_sel_hi:[1,0,1]
    v_pk_fma_f32 v[138:139], v[138:139], s[98:99], s[98:99] op_sel:[0,0,1] op_sel_hi:[1,0,1]
    v_pk_fma_f32 v[140:141], v[140:141], s[98:99], s[98:99] op_sel:[0,0,1] op_sel_hi:[1,0,1]
    v_pk_fma_f32 v[142:143], v[142:143], s[98:99], s[98:99] op_sel:[0,0,1] op_sel_hi:[1,0,1]
    v_pk_mul_f32 v[120:121], v[120:121], v[136:137]
    v_pk_mul_f32 v[122:123], v[122:123], v[138:139]
    v_pk_mul_f32 v[124:125], v[124:125], v[140:141]
    v_pk_mul_f32 v[126:127], v[126:127], v[142:143]
    v_cvt_pk_bf16_f32 v144, v120, v121
    v_cvt_pk_bf16_f32 v145, v122, v123
    v_cvt_pk_bf16_f32 v146, v124, v125
    v_cvt_pk_bf16_f32 v147, v126, v127
    buffer_store_dwordx4 v[144:147], v8, s[48:51], s70 offen offset:2048 sc1
    v_pk_fma_f32 v[120:121], v[70:71], v[48:49], v[72:73] op_sel:[1,0,0]
    v_pk_fma_f32 v[122:123], v[70:71], v[50:51], v[74:75] op_sel:[1,0,0]
    v_pk_fma_f32 v[124:125], v[70:71], v[52:53], v[76:77] op_sel:[1,0,0]
    v_pk_fma_f32 v[126:127], v[70:71], v[54:55], v[78:79] op_sel:[1,0,0]
    v_pk_fma_f32 v[120:121], v[40:41], v[70:71], v[120:121] op_sel_hi:[1,0,1]
    v_pk_fma_f32 v[122:123], v[42:43], v[70:71], v[122:123] op_sel_hi:[1,0,1]
    v_pk_fma_f32 v[124:125], v[44:45], v[70:71], v[124:125] op_sel_hi:[1,0,1]
    v_pk_fma_f32 v[126:127], v[46:47], v[70:71], v[126:127] op_sel_hi:[1,0,1]
    v_exp_f32 v128, v120
    v_exp_f32 v129, v121
    v_exp_f32 v130, v122
    v_exp_f32 v131, v123
    v_exp_f32 v132, v124
    v_exp_f32 v133, v125
    v_exp_f32 v134, v126
    v_exp_f32 v135, v127
    v_pk_add_f32 v[136:137], v[128:129], 2.0 op_sel_hi:[1,0]
    v_pk_add_f32 v[138:139], v[130:131], 2.0 op_sel_hi:[1,0]
    v_pk_add_f32 v[140:141], v[132:133], 2.0 op_sel_hi:[1,0]
    v_pk_add_f32 v[142:143], v[134:135], 2.0 op_sel_hi:[1,0]
    v_pk_fma_f32 v[136:137], v[128:129], v[136:137], 2.0 op_sel_hi:[1,1,0]
    v_pk_fma_f32 v[138:139], v[130:131], v[138:139], 2.0 op_sel_hi:[1,1,0]
    v_pk_fma_f32 v[140:141], v[132:133], v[140:141], 2.0 op_sel_hi:[1,1,0]
    v_pk_fma_f32 v[142:143], v[134:135], v[142:143], 2.0 op_sel_hi:[1,1,0]
    v_rcp_f32 v136, v136
    v_rcp_f32 v137, v137
    v_rcp_f32 v138, v138
    v_rcp_f32 v139, v139
    v_rcp_f32 v140, v140
    v_rcp_f32 v141, v141
    v_rcp_f32 v142, v142
    v_rcp_f32 v143, v143
    v_pk_fma_f32 v[136:137], v[136:137], s[98:99], s[98:99] op_sel:[0,0,1] op_sel_hi:[1,0,1]
    v_pk_fma_f32 v[138:139], v[138:139], s[98:99], s[98:99] op_sel:[0,0,1] op_sel_hi:[1,0,1]
    v_pk_fma_f32 v[140:141], v[140:141], s[98:99], s[98:99] op_sel:[0,0,1] op_sel_hi:[1,0,1]
    v_pk_fma_f32 v[142:143], v[142:143], s[98:99], s[98:99] op_sel:[0,0,1] op_sel_hi:[1,0,1]
    v_pk_mul_f32 v[120:121], v[120:121], v[136:137]
    v_pk_mul_f32 v[122:123], v[122:123], v[138:139]
    v_pk_mul_f32 v[124:125], v[124:125], v[140:141]
    v_pk_mul_f32 v[126:127], v[126:127], v[142:143]
    v_cvt_pk_bf16_f32 v148, v120, v121
    v_cvt_pk_bf16_f32 v149, v122, v123
    v_cvt_pk_bf16_f32 v150, v124, v125
    v_cvt_pk_bf16_f32 v151, v126, v127
    buffer_store_dwordx4 v[148:151], v8, s[48:51], s70 offen offset:3072 sc1
    s_waitcnt vmcnt(0)
    v_lshlrev_b32 v14, 2, v0
    v_mov_b32 v15, s77
    s_mov_b64 exec, 1
    buffer_store_dword v15, v14, s[48:51], s71 offen offset:0 sc1
    s_mov_b64 exec, -1
    v_mov_b32 v14, 163352
    v_mov_b32 v15, 1
    s_mov_b64 exec, 1
    ds_add_u32 v14, v15
    s_mov_b64 exec, -1
    s_branch L_p2early
L_h2b:
    s_mul_i32 s88, s5, 160
    s_and_b32 s8, s80, 1
    s_lshl_b32 s9, s8, 2
    v_add_u32 v3, s9, v14
    v_and_b32 v4, 7, v0
    v_xor_b32 v3, v3, v4
    v_lshrrev_b32 v5, 3, v0
    v_mul_u32_u24 v6, 1280, v5
    v_lshl_add_u32 v108, v3, 4, v6
    s_mul_i32 s87, s6, 163840
    s_mul_i32 s9, s80, 10240
    s_add_u32 s87, s87, s9
    s_lshl_b32 s73, s80, 10
    s_lshl_b32 s9, s8, 2
    v_add_u32 v3, s9, v14
    v_lshrrev_b32 v4, 1, v15
    v_xor_b32 v3, v3, v4
    s_lshl_b32 s9, s8, 3
    v_add_u32 v4, s9, v14
    v_mul_u32_u24 v4, 3072, v4
    v_lshl_add_u32 v3, v3, 5, v4
    v_and_b32 v6, 1, v0
    v_lshl_add_u32 v112, v6, 4, v3
    s_lshr_b32 s9, s80, 1
    s_mul_i32 s9, s9, 12288
    s_mul_i32 s89, s5, 384
    s_add_u32 s89, s89, s9
    s_add_u32 s89, s89, 128
    s_lshl_b32 s8, s69, 7
    s_add_u32 s70, s87, s8
    s_mul_i32 s8, s69, 245760
    s_add_u32 s71, s88, s8
    s_mul_i32 s8, s69, 196608
    s_add_u32 s72, s89, s8
    s_add_u32 s69, s69, 1
    s_cmp_eq_u32 s69, 10
    s_cselect_b32 s69, 0, s69
    s_waitcnt lgkmcnt(0)
    s_mov_b32 s36, s16
    s_mov_b32 s37, s17
    s_mov_b32 s38, 2621440
    s_mov_b32 s39, 0x20000
    s_add_u32 m0, s73, 0
    s_nop 0
    buffer_load_dwordx4 v108, s[36:39], s70 offen lds
    s_add_u32 m0, s73, 4096
    s_add_u32 s76, s70, 40960
    buffer_load_dwordx4 v108, s[36:39], s76 offen lds
    s_add_u32 m0, s73, 8192
    s_add_u32 s76, s70, 81920
    buffer_load_dwordx4 v108, s[36:39], s76 offen lds
    s_add_u32 m0, s73, 12288
    s_add_u32 s76, s70, 122880
    buffer_load_dwordx4 v108, s[36:39], s76 offen lds
    s_mov_b32 s44, s24
    s_mov_b32 s45, s25
    s_mov_b32 s46, 1966080
    s_mov_b32 s47, 0x20000
    s_add_u32 m0, s73, 26624
    s_nop 0
    buffer_load_dwordx4 v112, s[44:47], s72 offen lds
    s_add_u32 m0, s73, 30720
    s_add_u32 s76, s72, 49152
    buffer_load_dwordx4 v112, s[44:47], s76 offen lds
    s_add_u32 m0, s73, 34816
    s_add_u32 s76, s72, 98304
    buffer_load_dwordx4 v112, s[44:47], s76 offen lds
    s_add_u32 m0, s73, 38912
    s_add_u32 s76, s72, 147456
    buffer_load_dwordx4 v112, s[44:47], s76 offen lds
    s_lshl_b32 s9, s80, 6
    s_add_u32 s9, s9, 0
    v_add_u32 v3, s9, v0
    v_mul_u32_u24 v4, 6554, v3
    v_lshrrev_b32 v4, 16, v4
    v_mul_u32_u24 v5, 10, v4
    v_sub_u32 v3, v3, v5
    v_and_b32 v6, 4, v4
    v_lshlrev_b32 v6, 1, v6
    v_and_or_b32 v5, v4, 51, v6
    v_bfe_u32 v6, v4, 3, 1
    v_lshl_or_b32 v5, v6, 2, v5
    v_mul_u32_u24 v5, 3840, v5
    v_lshl_add_u32 v109, v3, 4, v5
    s_mov_b32 s40, s18
    s_mov_b32 s41, s19
    s_mov_b32 s42, 2457600
    s_mov_b32 s43, 0x20000
    s_add_u32 m0, s73, 16384
    s_nop 0
    buffer_load_dwordx4 v109, s[40:43], s71 offen lds
    s_lshl_b32 s9, s80, 6
    s_add_u32 s9, s9, 256
    v_add_u32 v3, s9, v0
    v_mul_u32_u24 v4, 6554, v3
    v_lshrrev_b32 v4, 16, v4
    v_mul_u32_u24 v5, 10, v4
    v_sub_u32 v3, v3, v5
    v_and_b32 v6, 4, v4
    v_lshlrev_b32 v6, 1, v6
    v_and_or_b32 v5, v4, 51, v6
    v_bfe_u32 v6, v4, 3, 1
    v_lshl_or_b32 v5, v6, 2, v5
    v_mul_u32_u24 v5, 3840, v5
    v_lshl_add_u32 v110, v3, 4, v5
    s_add_u32 m0, s73, 20480
    s_nop 0
    buffer_load_dwordx4 v110, s[40:43], s71 offen lds
    s_lshl_b32 s9, s80, 6
    s_add_u32 s9, s9, 512
    v_add_u32 v3, s9, v0
    v_mul_u32_u24 v4, 6554, v3
    v_lshrrev_b32 v4, 16, v4
    v_mul_u32_u24 v5, 10, v4
    v_sub_u32 v3, v3, v5
    v_and_b32 v6, 4, v4
    v_lshlrev_b32 v6, 1, v6
    v_and_or_b32 v5, v4, 51, v6
    v_bfe_u32 v6, v4, 3, 1
    v_lshl_or_b32 v5, v6, 2, v5
    v_mul_u32_u24 v5, 3840, v5
    v_lshl_add_u32 v111, v3, 4, v5
    s_cmp_lt_u32 s80, 2
    s_cbranch_scc0 Lcd_20
    s_add_u32 m0, s73, 24576
    s_nop 0
    buffer_load_dwordx4 v111, s[40:43], s71 offen lds
Lcd_20:
    s_add_u32 s73, s73, 43008
    s_lshl_b32 s8, s69, 7
    s_add_u32 s70, s87, s8
    s_mul_i32 s8, s69, 245760
    s_add_u32 s71, s88, s8
    s_mul_i32 s8, s69, 196608
    s_add_u32 s72, s89, s8
    s_add_u32 s69, s69, 1
    s_cmp_eq_u32 s69, 10
    s_cselect_b32 s69, 0, s69
    s_add_u32 m0, s73, 0
    s_nop 0
    buffer_load_dwordx4 v108, s[36:39], s70 offen lds
    s_add_u32 m0, s73, 4096
    s_add_u32 s76, s70, 40960
    buffer_load_dwordx4 v108, s[36:39], s76 offen lds
    s_add_u32 m0, s73, 8192
    s_add_u32 s76, s70, 81920
    buffer_load_dwordx4 v108, s[36:39], s76 offen lds
    s_add_u32 m0, s73, 12288
    s_add_u32 s76, s70, 122880
    buffer_load_dwordx4 v108, s[36:39], s76 offen lds
    s_add_u32 m0, s73, 26624
    s_nop 0
    buffer_load_dwordx4 v112, s[44:47], s72 offen lds
    s_add_u32 m0, s73, 30720
    s_add_u32 s76, s72, 49152
    buffer_load_dwordx4 v112, s[44:47], s76 offen lds
    s_add_u32 m0, s73, 34816
    s_add_u32 s76, s72, 98304
    buffer_load_dwordx4 v112, s[44:47], s76 offen lds
    s_add_u32 m0, s73, 38912
    s_add_u32 s76, s72, 147456
    buffer_load_dwordx4 v112, s[44:47], s76 offen lds
    s_add_u32 m0, s73, 16384
    s_nop 0
    buffer_load_dwordx4 v109, s[40:43], s71 offen lds
    s_add_u32 m0, s73, 20480
    s_nop 0
    buffer_load_dwordx4 v110, s[40:43], s71 offen lds
    s_cmp_lt_u32 s80, 2
    s_cbranch_scc0 Lcd_21
    s_add_u32 m0, s73, 24576
    s_nop 0
    buffer_load_dwordx4 v111, s[40:43], s71 offen lds
Lcd_21:
    s_add_u32 s73, s73, 43008
    s_lshl_b32 s8, s69, 7
    s_add_u32 s70, s87, s8
    s_mul_i32 s8, s69, 245760
    s_add_u32 s71, s88, s8
    s_mul_i32 s8, s69, 196608
    s_add_u32 s72, s89, s8
    s_add_u32 s69, s69, 1
    s_cmp_eq_u32 s69, 10
    s_cselect_b32 s69, 0, s69
    s_add_u32 m0, s73, 0
    s_nop 0
    buffer_load_dwordx4 v108, s[36:39], s70 offen lds
    s_add_u32 m0, s73, 4096
    s_add_u32 s76, s70, 40960
    buffer_load_dwordx4 v108, s[36:39], s76 offen lds
    s_add_u32 m0, s73, 8192
    s_add_u32 s76, s70, 81920
    buffer_load_dwordx4 v108, s[36:39], s76 offen lds
    s_add_u32 m0, s73, 12288
    s_add_u32 s76, s70, 122880
    buffer_load_dwordx4 v108, s[36:39], s76 offen lds
    s_mov_b32 s74, 4294881280
    s_and_b32 s8, s2, 7
    s_lshr_b32 s9, s2, 3
    s_and_b32 s10, s8, 1
    s_lshl_b32 s10, s10, 3
    s_and_b32 s14, s8, 6
    s_lshl_b32 s10, s10, 1
    s_lshl_b32 s14, s14, 1
    s_add_u32 s10, s10, s14
    s_and_b32 s11, s9, 3
    s_add_u32 s78, s10, s11
    s_lshr_b32 s79, s9, 2
    s_mov_b32 s96, 2.0
    s_mov_b32 s97, 2.0
    s_mov_b32 s98, 3216077336
    s_mov_b32 s99, 1060205080
    s_mov_b32 s100, 1069066811
    s_mov_b32 s101, 897988541
    s_mov_b32 s68, 0
    s_mov_b32 s75, 0
    v_mov_b32 v11, 0x3f803f80
    v_lshlrev_b32 v8, 4, v0
    v_add_u32 v9, 4096, v8
    v_lshrrev_b32 v3, 1, v15
    v_xor_b32 v3, v3, v14
    v_lshlrev_b32 v3, 4, v3
    v_lshl_add_u32 v3, v15, 7, v3
    s_lshl_b32 s8, s7, 13
    v_add_u32 v1, s8, v3
    v_xor_b32 v2, 64, v1
    v_lshrrev_b32 v12, 5, v0
    v_lshlrev_b32 v12, 4, v12
    v_and_b32 v3, 1, v14
    v_lshl_add_u32 v12, v3, 2, v12
    v_bfe_u32 v3, v0, 2, 2
    v_add_u32 v12, v12, v3
    v_and_b32 v13, 3, v0
    v_lshlrev_b32 v13, 3, v13
    s_mov_b32 s48, s34
    s_mov_b32 s49, s35
    s_mov_b32 s50, 268435456
    s_mov_b32 s51, 0x20000
    s_mov_b32 s60, s26
    s_mov_b32 s61, s27
    s_mov_b32 s62, 3072
    s_mov_b32 s63, 0x20000
    s_lshr_b32 s8, s80, 1
    s_lshl_b32 s8, s8, 6
    s_mul_i32 s10, s5, 384
    s_add_u32 s8, s8, s10
    s_add_u32 s8, s8, 256
    v_lshlrev_b32 v3, 3, v14
    buffer_load_dwordx2 v[114:115], v3, s[60:63], s8 offen
    buffer_load_dwordx2 v[116:117], v3, s[60:63], s8 offen offset:32
    s_lshr_b32 s8, s80, 1
    s_lshl_b32 s8, s8, 1
    s_add_u32 s8, s8, 4
    v_and_b32 v5, 7, v12
    v_lshl_add_u32 v6, v12, 8, v13
    v_xor_b32 v5, s8, v5
    v_lshl_add_u32 v3, v5, 5, v6
    v_add_u32 v3, 26624, v3
    v_xor_b32 v4, 32, v3
    s_mul_i32 s91, s80, 17
    s_mul_i32 s84, s79, 3
    s_lshr_b32 s84, s84, 1
    s_mov_b32 s85, s84
    s_mul_i32 s8, s79, 68
    s_add_u32 s8, s8, s91
    s_add_u32 s8, s8, s84
    s_mul_i32 s8, s8, 5120
    s_add_u32 s83, s8, 10485760
    s_mul_i32 s8, s78, 68
    s_add_u32 s8, s8, s91
    s_add_u32 s8, s8, s85
    s_lshl_b32 s8, s8, 12
    s_add_u32 s92, s8, 1048576
    s_mul_i32 s9, s79, 5
    s_lshr_b32 s9, s9, 2
    s_lshl_b32 s9, s9, 2
    s_lshl_b32 s10, s91, 6
    s_add_u32 s9, s9, s10
    s_add_u32 s9, s9, 24576
    v_min_u32 v14, 23, v0
    v_and_b32 v15, 1, v14
    v_lshrrev_b32 v14, 1, v14
    v_lshlrev_b32 v14, 6, v14
    v_lshl_add_u32 v14, v15, 2, v14
    v_add_u32 v12, s9, v14
    v_mov_b32 v16, 0
    v_mov_b32 v17, 0
    v_mov_b32 v18, 0
    v_mov_b32 v19, 0
    v_mov_b32 v20, 0
    v_mov_b32 v21, 0
    v_mov_b32 v22, 0
    v_mov_b32 v23, 0
    v_mov_b32 v24, 0
    v_mov_b32 v25, 0
    v_mov_b32 v26, 0
    v_mov_b32 v27, 0
    v_mov_b32 v28, 0
    v_mov_b32 v29, 0
    v_mov_b32 v30, 0
    v_mov_b32 v31, 0
    v_mov_b32 v32, 0
    v_mov_b32 v33, 0
    v_mov_b32 v34, 0
    v_mov_b32 v35, 0
    v_mov_b32 v36, 0
    v_mov_b32 v37, 0
    v_mov_b32 v38, 0
    v_mov_b32 v39, 0
    v_mov_b32 v40, 0
    v_mov_b32 v41, 0
    v_mov_b32 v42, 0
    v_mov_b32 v43, 0
    v_mov_b32 v44, 0
    v_mov_b32 v45, 0
    v_mov_b32 v46, 0
    v_mov_b32 v47, 0
    v_mov_b32 v48, 0
    v_mov_b32 v49, 0
    v_mov_b32 v50, 0
    v_mov_b32 v51, 0
    v_mov_b32 v52, 0
    v_mov_b32 v53, 0
    v_mov_b32 v54, 0
    v_mov_b32 v55, 0
    v_mov_b32 v104, 0x3f803f80
    v_mov_b32 v105, 0x3f803f80
    v_mov_b32 v106, 0x3f803f80
    v_mov_b32 v107, 0x3f803f80
    s_waitcnt vmcnt(17)
    s_cmp_lt_u32 s80, 2
    s_cbranch_scc1 Lw0_22
    s_waitcnt vmcnt(16)
Lw0_22:
    s_setprio 1
    s_waitcnt lgkmcnt(0)
    s_barrier
    ds_read_b128 v[56:59], v1 offset:0
    ds_read_b64_tr_b16 v[88:89], v3 offset:0
    ds_read_b64_tr_b16 v[90:91], v3 offset:2048
    ds_read_b128 v[60:63], v1 offset:2048
    ds_read_b64_tr_b16 v[92:93], v4 offset:0
    ds_read_b64_tr_b16 v[94:95], v4 offset:2048
    ds_read_b128 v[64:67], v1 offset:4096
    ds_read_b128 v[68:71], v1 offset:6144
L_loop_h2b:
    s_waitcnt lgkmcnt(0)
    v_mfma_f32_16x16x32_bf16 v[16:19], v[88:91], v[56:59], v[16:19]
    ds_read_b128 v[72:75], v2 offset:0
    ds_read_b64_tr_b16 v[96:97], v3 offset:8192
    v_mfma_f32_16x16x32_bf16 v[20:23], v[92:95], v[56:59], v[20:23]
    ds_read_b64_tr_b16 v[98:99], v3 offset:10240
    ds_read_b128 v[76:79], v2 offset:2048
    v_mfma_f32_16x16x32_bf16 v[24:27], v[88:91], v[60:63], v[24:27]
    ds_read_b64_tr_b16 v[100:101], v4 offset:8192
    ds_read_b64_tr_b16 v[102:103], v4 offset:10240
    v_mfma_f32_16x16x32_bf16 v[28:31], v[92:95], v[60:63], v[28:31]
    ds_read_b128 v[80:83], v2 offset:4096
    ds_read_b128 v[84:87], v2 offset:6144
    s_add_u32 m0, s73, 26624
    s_nop 0
    buffer_load_dwordx4 v112, s[44:47], s72 offen lds
    v_mfma_f32_16x16x32_bf16 v[32:35], v[88:91], v[64:67], v[32:35]
    s_add_u32 m0, s73, 30720
    s_add_u32 s76, s72, 49152
    buffer_load_dwordx4 v112, s[44:47], s76 offen lds
    v_mfma_f32_16x16x32_bf16 v[36:39], v[92:95], v[64:67], v[36:39]
    s_add_u32 m0, s73, 34816
    s_add_u32 s76, s72, 98304
    buffer_load_dwordx4 v112, s[44:47], s76 offen lds
    v_mfma_f32_16x16x32_bf16 v[40:43], v[88:91], v[68:71], v[40:43]
    s_add_u32 m0, s73, 38912
    s_add_u32 s76, s72, 147456
    buffer_load_dwordx4 v112, s[44:47], s76 offen lds
    v_mfma_f32_16x16x32_bf16 v[44:47], v[92:95], v[68:71], v[44:47]
    s_add_u32 m0, s73, 16384
    s_nop 0
    buffer_load_dwordx4 v109, s[40:43], s71 offen lds
    s_add_u32 m0, s73, 20480
    s_nop 0
    buffer_load_dwordx4 v110, s[40:43], s71 offen lds
    s_cmp_lt_u32 s80, 2
    s_cbranch_scc0 Lcd_23
    s_add_u32 m0, s73, 24576
    s_nop 0
    buffer_load_dwordx4 v111, s[40:43], s71 offen lds
Lcd_23:
    s_add_u32 s73, s73, s74
    s_add_u32 s75, s75, 1
    s_cmp_eq_u32 s75, 3
    s_cselect_b32 s74, -2, 1
    s_cselect_b32 s75, 0, s75
    s_mul_i32 s74, s74, 43008
    v_add_u32 v1, s74, v1
    v_add_u32 v2, s74, v2
    v_add_u32 v3, s74, v3
    v_add_u32 v4, s74, v4
    s_cmp_eq_u32 s7, 0
    s_cbranch_scc0 Lcs_24
    v_mfma_f32_16x16x32_bf16 v[48:51], v[88:91], v[104:107], v[48:51]
    v_mfma_f32_16x16x32_bf16 v[52:55], v[92:95], v[104:107], v[52:55]
Lcs_24:
    s_waitcnt vmcnt(11) lgkmcnt(0)
    s_cmp_lt_u32 s80, 2
    s_cbranch_scc1 Lvm_25
    s_waitcnt vmcnt(10)
Lvm_25:
    s_barrier
    v_mfma_f32_16x16x32_bf16 v[16:19], v[96:99], v[72:75], v[16:19]
    ds_read_b128 v[56:59], v1 offset:0
    ds_read_b64_tr_b16 v[88:89], v3 offset:0
    v_mfma_f32_16x16x32_bf16 v[20:23], v[100:103], v[72:75], v[20:23]
    ds_read_b64_tr_b16 v[90:91], v3 offset:2048
    ds_read_b128 v[60:63], v1 offset:2048
    v_mfma_f32_16x16x32_bf16 v[24:27], v[96:99], v[76:79], v[24:27]
    ds_read_b64_tr_b16 v[92:93], v4 offset:0
    ds_read_b64_tr_b16 v[94:95], v4 offset:2048
    v_mfma_f32_16x16x32_bf16 v[28:31], v[100:103], v[76:79], v[28:31]
    ds_read_b128 v[64:67], v1 offset:4096
    ds_read_b128 v[68:71], v1 offset:6144
    s_lshl_b32 s8, s69, 7
    s_add_u32 s70, s87, s8
    s_mul_i32 s8, s69, 245760
    s_add_u32 s71, s88, s8
    s_mul_i32 s8, s69, 196608
    s_add_u32 s72, s89, s8
    s_add_u32 s69, s69, 1
    s_cmp_eq_u32 s69, 10
    s_cselect_b32 s69, 0, s69
    s_cmp_eq_u32 s68, 6
    s_cbranch_scc0 Lnp_26
    buffer_load_dword v13, v12, s[48:51], 0 offen sc1
Lnp_26:
    s_add_u32 m0, s73, 0
    s_nop 0
    buffer_load_dwordx4 v108, s[36:39], s70 offen lds
    v_mfma_f32_16x16x32_bf16 v[32:35], v[96:99], v[80:83], v[32:35]
    s_add_u32 m0, s73, 4096
    s_add_u32 s76, s70, 40960
    buffer_load_dwordx4 v108, s[36:39], s76 offen lds
    v_mfma_f32_16x16x32_bf16 v[36:39], v[100:103], v[80:83], v[36:39]
    s_add_u32 m0, s73, 8192
    s_add_u32 s76, s70, 81920
    buffer_load_dwordx4 v108, s[36:39], s76 offen lds
    v_mfma_f32_16x16x32_bf16 v[40:43], v[96:99], v[84:87], v[40:43]
    s_add_u32 m0, s73, 12288
    s_add_u32 s76, s70, 122880
    buffer_load_dwordx4 v108, s[36:39], s76 offen lds
    v_mfma_f32_16x16x32_bf16 v[44:47], v[100:103], v[84:87], v[44:47]
    s_cmp_eq_u32 s7, 1
    s_cbranch_scc0 Lcs_27
    v_mfma_f32_16x16x32_bf16 v[48:51], v[96:99], v[104:107], v[48:51]
    v_mfma_f32_16x16x32_bf16 v[52:55], v[100:103], v[104:107], v[52:55]
Lcs_27:
    s_add_u32 s68, s68, 1
    s_cmp_lt_u32 s68, 7
    s_cbranch_scc1 L_loop_h2b
    v_mov_b32 v14, 163376
    ds_read_b32 v14, v14
    s_waitcnt lgkmcnt(0)
    v_mfma_f32_16x16x32_bf16 v[16:19], v[88:91], v[56:59], v[16:19]
    ds_read_b128 v[72:75], v2 offset:0
    ds_read_b64_tr_b16 v[96:97], v3 offset:8192
    v_mfma_f32_16x16x32_bf16 v[20:23], v[92:95], v[56:59], v[20:23]
    ds_read_b64_tr_b16 v[98:99], v3 offset:10240
    ds_read_b128 v[76:79], v2 offset:2048
    v_mfma_f32_16x16x32_bf16 v[24:27], v[88:91], v[60:63], v[24:27]
    ds_read_b64_tr_b16 v[100:101], v4 offset:8192
    ds_read_b64_tr_b16 v[102:103], v4 offset:10240
    v_mfma_f32_16x16x32_bf16 v[28:31], v[92:95], v[60:63], v[28:31]
    ds_read_b128 v[80:83], v2 offset:4096
    ds_read_b128 v[84:87], v2 offset:6144
    s_add_u32 m0, s73, 26624
    s_nop 0
    buffer_load_dwordx4 v112, s[44:47], s72 offen lds
    v_mfma_f32_16x16x32_bf16 v[32:35], v[88:91], v[64:67], v[32:35]
    s_add_u32 m0, s73, 30720
    s_add_u32 s76, s72, 49152
    buffer_load_dwordx4 v112, s[44:47], s76 offen lds
    v_mfma_f32_16x16x32_bf16 v[36:39], v[92:95], v[64:67], v[36:39]
    s_add_u32 m0, s73, 34816
    s_add_u32 s76, s72, 98304
    buffer_load_dwordx4 v112, s[44:47], s76 offen lds
    v_mfma_f32_16x16x32_bf16 v[40:43], v[88:91], v[68:71], v[40:43]
    s_add_u32 m0, s73, 38912
    s_add_u32 s76, s72, 147456
    buffer_load_dwordx4 v112, s[44:47], s76 offen lds
    v_mfma_f32_16x16x32_bf16 v[44:47], v[92:95], v[68:71], v[44:47]
    s_add_u32 m0, s73, 16384
    s_nop 0
    buffer_load_dwordx4 v109, s[40:43], s71 offen lds
    s_add_u32 m0, s73, 20480
    s_nop 0
    buffer_load_dwordx4 v110, s[40:43], s71 offen lds
    s_cmp_lt_u32 s80, 2
    s_cbranch_scc0 Lcd_28
    s_add_u32 m0, s73, 24576
    s_nop 0
    buffer_load_dwordx4 v111, s[40:43], s71 offen lds
Lcd_28:
    s_mul_i32 s73, s80, 5120
    v_readfirstlane_b32 s77, v14
    s_add_u32 s75, s75, 1
    s_cmp_eq_u32 s75, 3
    s_cselect_b32 s74, -2, 1
    s_cselect_b32 s75, 0, s75
    s_mul_i32 s74, s74, 43008
    v_add_u32 v1, s74, v1
    v_add_u32 v2, s74, v2
    v_add_u32 v3, s74, v3
    v_add_u32 v4, s74, v4
    s_cmp_eq_u32 s7, 0
    s_cbranch_scc0 Lcs_29
    v_mfma_f32_16x16x32_bf16 v[48:51], v[88:91], v[104:107], v[48:51]
    v_mfma_f32_16x16x32_bf16 v[52:55], v[92:95], v[104:107], v[52:55]
Lcs_29:
    s_waitcnt vmcnt(11) lgkmcnt(0)
    s_cmp_lt_u32 s80, 2
    s_cbranch_scc1 Lvm_30
    s_waitcnt vmcnt(10)
Lvm_30:
    s_barrier
    v_mfma_f32_16x16x32_bf16 v[16:19], v[96:99], v[72:75], v[16:19]
    ds_read_b128 v[56:59], v1 offset:0
    ds_read_b64_tr_b16 v[88:89], v3 offset:0
    v_mfma_f32_16x16x32_bf16 v[20:23], v[100:103], v[72:75], v[20:23]
    ds_read_b64_tr_b16 v[90:91], v3 offset:2048
    ds_read_b128 v[60:63], v1 offset:2048
    v_mfma_f32_16x16x32_bf16 v[24:27], v[96:99], v[76:79], v[24:27]
    ds_read_b64_tr_b16 v[92:93], v4 offset:0
    ds_read_b64_tr_b16 v[94:95], v4 offset:2048
    v_mfma_f32_16x16x32_bf16 v[28:31], v[100:103], v[76:79], v[28:31]
    ds_read_b128 v[64:67], v1 offset:4096
    ds_read_b128 v[68:71], v1 offset:6144
    s_mov_b32 s8, 0
    s_branch Lchk_rp_32
Lpoll_rp_31:
    buffer_load_dword v13, v12, s[48:51], 0 offen sc1
    s_waitcnt vmcnt(0)
Lchk_rp_32:
    s_add_u32 s8, s8, 1
    s_cmp_ge_u32 s8, 100000
    s_cbranch_scc1 Ldone_rp_33
    v_cmp_ne_u32 vcc, s77, v13
    s_cbranch_vccnz Lpoll_rp_31
Ldone_rp_33:
    buffer_load_dwordx4 v[156:159], v8, s[48:51], s83 offen offset:0 sc1
    v_mfma_f32_16x16x32_bf16 v[32:35], v[96:99], v[80:83], v[32:35]
    buffer_load_dwordx4 v[160:163], v8, s[48:51], s83 offen offset:1024 sc1
    v_mfma_f32_16x16x32_bf16 v[36:39], v[100:103], v[80:83], v[36:39]
    buffer_load_dwordx4 v[164:167], v8, s[48:51], s83 offen offset:2048 sc1
    v_mfma_f32_16x16x32_bf16 v[40:43], v[96:99], v[84:87], v[40:43]
    buffer_load_dwordx4 v[168:171], v8, s[48:51], s83 offen offset:3072 sc1
    v_mfma_f32_16x16x32_bf16 v[44:47], v[100:103], v[84:87], v[44:47]
    buffer_load_dwordx4 v[172:175], v9, s[48:51], s83 offen offset:0 sc1
    s_add_u32 s83, s83, 5120
    s_add_u32 s84, s84, 1
    s_cmp_eq_u32 s84, 12
    s_cselect_b32 s8, 61440, 0
    s_cselect_b32 s84, 0, s84
    s_sub_u32 s83, s83, s8
    buffer_load_dwordx4 v[176:179], v8, s[48:51], s83 offen offset:0 sc1
    buffer_load_dwordx4 v[180:183], v8, s[48:51], s83 offen offset:1024 sc1
    s_cmp_eq_u32 s7, 1
    s_cbranch_scc0 Lcs_34
    v_mfma_f32_16x16x32_bf16 v[48:51], v[96:99], v[104:107], v[48:51]
    v_mfma_f32_16x16x32_bf16 v[52:55], v[100:103], v[104:107], v[52:55]
Lcs_34:
    s_waitcnt lgkmcnt(0)
    v_mfma_f32_16x16x32_bf16 v[16:19], v[88:91], v[56:59], v[16:19]
    ds_read_b128 v[72:75], v2 offset:0
    ds_read_b64_tr_b16 v[96:97], v3 offset:8192
    v_mfma_f32_16x16x32_bf16 v[20:23], v[92:95], v[56:59], v[20:23]
    ds_read_b64_tr_b16 v[98:99], v3 offset:10240
    ds_read_b128 v[76:79], v2 offset:2048
    v_mfma_f32_16x16x32_bf16 v[24:27], v[88:91], v[60:63], v[24:27]
    ds_read_b64_tr_b16 v[100:101], v4 offset:8192
    ds_read_b64_tr_b16 v[102:103], v4 offset:10240
    v_mfma_f32_16x16x32_bf16 v[28:31], v[92:95], v[60:63], v[28:31]
    ds_read_b128 v[80:83], v2 offset:4096
    ds_read_b128 v[84:87], v2 offset:6144
    buffer_load_dwordx4 v[184:187], v8, s[48:51], s83 offen offset:2048 sc1
    v_mfma_f32_16x16x32_bf16 v[32:35], v[88:91], v[64:67], v[32:35]
    buffer_load_dwordx4 v[188:191], v8, s[48:51], s83 offen offset:3072 sc1
    v_mfma_f32_16x16x32_bf16 v[36:39], v[92:95], v[64:67], v[36:39]
    buffer_load_dwordx4 v[192:195], v9, s[48:51], s83 offen offset:0 sc1
    s_add_u32 s83, s83, 5120
    s_add_u32 s84, s84, 1
    s_cmp_eq_u32 s84, 12
    s_cselect_b32 s8, 61440, 0
    s_cselect_b32 s84, 0, s84
    s_sub_u32 s83, s83, s8
    v_mfma_f32_16x16x32_bf16 v[40:43], v[88:91], v[68:71], v[40:43]
    buffer_load_dwordx4 v[196:199], v8, s[48:51], s83 offen offset:0 sc1
    v_mfma_f32_16x16x32_bf16 v[44:47], v[92:95], v[68:71], v[44:47]
    buffer_load_dwordx4 v[200:203], v8, s[48:51], s83 offen offset:1024 sc1
    buffer_load_dwordx4 v[204:207], v8, s[48:51], s83 offen offset:2048 sc1
    buffer_load_dwordx4 v[208:211], v8, s[48:51], s83 offen offset:3072 sc1
    s_add_u32 s75, s75, 1
    s_cmp_eq_u32 s75, 3
    s_cselect_b32 s74, -2, 1
    s_cselect_b32 s75, 0, s75
    s_mul_i32 s74, s74, 43008
    v_add_u32 v1, s74, v1
    v_add_u32 v2, s74, v2
    v_add_u32 v3, s74, v3
    v_add_u32 v4, s74, v4
    s_cmp_eq_u32 s7, 0
    s_cbranch_scc0 Lcs_35
    v_mfma_f32_16x16x32_bf16 v[48:51], v[88:91], v[104:107], v[48:51]
    v_mfma_f32_16x16x32_bf16 v[52:55], v[92:95], v[104:107], v[52:55]
Lcs_35:
    s_waitcnt vmcnt(14) lgkmcnt(0)
    s_mov_b32 s68, 8
    s_barrier
    v_mfma_f32_16x16x32_bf16 v[16:19], v[96:99], v[72:75], v[16:19]
    ds_read_b128 v[56:59], v1 offset:0
    ds_read_b64_tr_b16 v[88:89], v3 offset:0
    v_mfma_f32_16x16x32_bf16 v[20:23], v[100:103], v[72:75], v[20:23]
    ds_read_b64_tr_b16 v[90:91], v3 offset:2048
    ds_read_b128 v[60:63], v1 offset:2048
    v_mfma_f32_16x16x32_bf16 v[24:27], v[96:99], v[76:79], v[24:27]
    ds_read_b64_tr_b16 v[92:93], v4 offset:0
    ds_read_b64_tr_b16 v[94:95], v4 offset:2048
    v_mfma_f32_16x16x32_bf16 v[28:31], v[100:103], v[76:79], v[28:31]
    ds_read_b128 v[64:67], v1 offset:4096
    ds_read_b128 v[68:71], v1 offset:6144
    buffer_load_dwordx4 v[212:215], v9, s[48:51], s83 offen offset:0 sc1
    s_add_u32 s83, s83, 5120
    s_add_u32 s84, s84, 1
    s_cmp_eq_u32 s84, 12
    s_cselect_b32 s8, 61440, 0
    s_cselect_b32 s84, 0, s84
    s_sub_u32 s83, s83, s8
    v_mfma_f32_16x16x32_bf16 v[32:35], v[96:99], v[80:83], v[32:35]
    buffer_load_dwordx4 v[216:219], v8, s[48:51], s83 offen offset:0 sc1
    v_mfma_f32_16x16x32_bf16 v[36:39], v[100:103], v[80:83], v[36:39]
    buffer_load_dwordx4 v[220:223], v8, s[48:51], s83 offen offset:1024 sc1
    v_mfma_f32_16x16x32_bf16 v[40:43], v[96:99], v[84:87], v[40:43]
    buffer_load_dwordx4 v[224:227], v8, s[48:51], s83 offen offset:2048 sc1
    v_mfma_f32_16x16x32_bf16 v[44:47], v[100:103], v[84:87], v[44:47]
    buffer_load_dwordx4 v[228:231], v8, s[48:51], s83 offen offset:3072 sc1
    buffer_load_dwordx4 v[232:235], v9, s[48:51], s83 offen offset:0 sc1
    s_add_u32 s83, s83, 5120
    s_add_u32 s84, s84, 1
    s_cmp_eq_u32 s84, 12
    s_cselect_b32 s8, 61440, 0
    s_cselect_b32 s84, 0, s84
    s_sub_u32 s83, s83, s8
    buffer_load_dwordx4 v[236:239], v8, s[48:51], s83 offen offset:0 sc1
    s_cmp_eq_u32 s7, 1
    s_cbranch_scc0 Lcs_36
    v_mfma_f32_16x16x32_bf16 v[48:51], v[96:99], v[104:107], v[48:51]
    v_mfma_f32_16x16x32_bf16 v[52:55], v[100:103], v[104:107], v[52:55]
Lcs_36:
    s_waitcnt lgkmcnt(0)
    v_mfma_f32_16x16x32_bf16 v[16:19], v[88:91], v[56:59], v[16:19]
    ds_read_b128 v[72:75], v2 offset:0
    ds_read_b64_tr_b16 v[96:97], v3 offset:8192
    v_mfma_f32_16x16x32_bf16 v[20:23], v[92:95], v[56:59], v[20:23]
    ds_read_b64_tr_b16 v[98:99], v3 offset:10240
    ds_read_b128 v[76:79], v2 offset:2048
    v_mfma_f32_16x16x32_bf16 v[24:27], v[88:91], v[60:63], v[24:27]
    ds_read_b64_tr_b16 v[100:101], v4 offset:8192
    ds_read_b64_tr_b16 v[102:103], v4 offset:10240
    v_mfma_f32_16x16x32_bf16 v[28:31], v[92:95], v[60:63], v[28:31]
    ds_read_b128 v[80:83], v2 offset:4096
    ds_read_b128 v[84:87], v2 offset:6144
    buffer_load_dwordx4 v[240:243], v8, s[48:51], s83 offen offset:1024 sc1
    v_mfma_f32_16x16x32_bf16 v[32:35], v[88:91], v[64:67], v[32:35]
    buffer_load_dwordx4 v[244:247], v8, s[48:51], s83 offen offset:2048 sc1
    v_mfma_f32_16x16x32_bf16 v[36:39], v[92:95], v[64:67], v[36:39]
    buffer_load_dwordx4 v[248:251], v8, s[48:51], s83 offen offset:3072 sc1
    v_mfma_f32_16x16x32_bf16 v[40:43], v[88:91], v[68:71], v[40:43]
    buffer_load_dwordx4 v[252:255], v9, s[48:51], s83 offen offset:0 sc1
    s_add_u32 s83, s83, 5120
    s_add_u32 s84, s84, 1
    s_cmp_eq_u32 s84, 12
    s_cselect_b32 s8, 61440, 0
    s_cselect_b32 s84, 0, s84
    s_sub_u32 s83, s83, s8
    v_mfma_f32_16x16x32_bf16 v[44:47], v[92:95], v[68:71], v[44:47]
    s_add_u32 m0, s73, 61440
    s_nop 0
    buffer_load_dwordx4 v8, s[48:51], s83 offen offset:0 sc1 lds
    buffer_load_dwordx4 v8, s[48:51], s83 offen offset:1024 sc1 lds
    buffer_load_dwordx4 v8, s[48:51], s83 offen offset:2048 sc1 lds
    s_cmp_eq_u32 s7, 0
    s_cbranch_scc0 Lcs_37
    v_mfma_f32_16x16x32_bf16 v[48:51], v[88:91], v[104:107], v[48:51]
    v_mfma_f32_16x16x32_bf16 v[52:55], v[92:95], v[104:107], v[52:55]
Lcs_37:
    s_waitcnt lgkmcnt(0)
    v_mfma_f32_16x16x32_bf16 v[16:19], v[96:99], v[72:75], v[16:19]
    v_mfma_f32_16x16x32_bf16 v[20:23], v[100:103], v[72:75], v[20:23]
    v_mfma_f32_16x16x32_bf16 v[24:27], v[96:99], v[76:79], v[24:27]
    v_mfma_f32_16x16x32_bf16 v[28:31], v[100:103], v[76:79], v[28:31]
    buffer_load_dwordx4 v8, s[48:51], s83 offen offset:3072 sc1 lds
    v_mfma_f32_16x16x32_bf16 v[32:35], v[96:99], v[80:83], v[32:35]
    s_add_u32 m0, s73, 65536
    s_nop 0
    buffer_load_dwordx4 v9, s[48:51], s83 offen offset:0 sc1 lds
    s_add_u32 s83, s83, 5120
    s_add_u32 s84, s84, 1
    s_cmp_eq_u32 s84, 12
    s_cselect_b32 s8, 61440, 0
    s_cselect_b32 s84, 0, s84
    s_sub_u32 s83, s83, s8
    v_mfma_f32_16x16x32_bf16 v[36:39], v[100:103], v[80:83], v[36:39]
    s_add_u32 m0, s73, 81920
    s_nop 0
    buffer_load_dwordx4 v8, s[48:51], s83 offen offset:0 sc1 lds
    v_mfma_f32_16x16x32_bf16 v[40:43], v[96:99], v[84:87], v[40:43]
    buffer_load_dwordx4 v8, s[48:51], s83 offen offset:1024 sc1 lds
    v_mfma_f32_16x16x32_bf16 v[44:47], v[100:103], v[84:87], v[44:47]
    buffer_load_dwordx4 v8, s[48:51], s83 offen offset:2048 sc1 lds
    buffer_load_dwordx4 v8, s[48:51], s83 offen offset:3072 sc1 lds
    s_add_u32 m0, s73, 86016
    s_nop 0
    buffer_load_dwordx4 v9, s[48:51], s83 offen offset:0 sc1 lds
    s_add_u32 s83, s83, 5120
    s_add_u32 s84, s84, 1
    s_cmp_eq_u32 s84, 12
    s_cselect_b32 s8, 61440, 0
    s_cselect_b32 s84, 0, s84
    s_sub_u32 s83, s83, s8
    s_cmp_eq_u32 s7, 1
    s_cbranch_scc0 Lcs_38
    v_mfma_f32_16x16x32_bf16 v[48:51], v[96:99], v[104:107], v[48:51]
    v_mfma_f32_16x16x32_bf16 v[52:55], v[100:103], v[104:107], v[52:55]
Lcs_38:
    s_setprio 0
    s_mul_i32 s8, s3, 320
    s_add_u32 s8, s8, 160768
    v_add_u32 v14, s8, v0
    s_mov_b32 exec_lo, 0x00010001
    s_mov_b32 exec_hi, 0x00010001
    s_nop 0
    ds_write_b128 v14, v[48:51] offset:0
    ds_write_b128 v14, v[52:55] offset:64
    s_mov_b64 exec, -1
    s_waitcnt lgkmcnt(0)
    s_barrier
    s_xor_b32 s8, s3, 1
    s_mul_i32 s8, s8, 320
    s_add_u32 s8, s8, 160768
    v_and_b32 v14, 48, v0
    v_add_u32 v14, s8, v14
    ds_read_b128 v[56:59], v14 offset:0
    ds_read_b128 v[60:63], v14 offset:64
    s_lshl_b32 s8, s7, 8
    s_add_u32 s8, s8, 159744
    v_and_b32 v15, 15, v0
    v_lshl_add_u32 v15, v15, 2, s8
    ds_read2_b32 v[64:65], v15 offset0:0 offset1:128
    ds_read2_b32 v[66:67], v15 offset0:16 offset1:144
    ds_read2_b32 v[68:69], v15 offset0:32 offset1:160
    ds_read2_b32 v[70:71], v15 offset0:48 offset1:176
    s_add_u32 m0, s73, 102400
    s_nop 0
    buffer_load_dwordx4 v8, s[48:51], s83 offen offset:0 sc1 lds
    buffer_load_dwordx4 v8, s[48:51], s83 offen offset:1024 sc1 lds
    buffer_load_dwordx4 v8, s[48:51], s83 offen offset:2048 sc1 lds
    buffer_load_dwordx4 v8, s[48:51], s83 offen offset:3072 sc1 lds
    s_add_u32 m0, s73, 106496
    s_nop 0
    buffer_load_dwordx4 v9, s[48:51], s83 offen offset:0 sc1 lds
    s_add_u32 s83, s83, 5120
    s_add_u32 s84, s84, 1
    s_cmp_eq_u32 s84, 12
    s_cselect_b32 s8, 61440, 0
    s_cselect_b32 s84, 0, s84
    s_sub_u32 s83, s83, s8
    s_add_u32 m0, s73, 122880
    s_nop 0
    buffer_load_dwordx4 v8, s[48:51], s83 offen offset:0 sc1 lds
    buffer_load_dwordx4 v8, s[48:51], s83 offen offset:1024 sc1 lds
    buffer_load_dwordx4 v8, s[48:51], s83 offen offset:2048 sc1 lds
    buffer_load_dwordx4 v8, s[48:51], s83 offen offset:3072 sc1 lds
    s_add_u32 m0, s73, 126976
    s_nop 0
    buffer_load_dwordx4 v9, s[48:51], s83 offen offset:0 sc1 lds
    s_add_u32 s83, s83, 5120
    s_add_u32 s84, s84, 1
    s_cmp_eq_u32 s84, 12
    s_cselect_b32 s8, 61440, 0
    s_cselect_b32 s84, 0, s84
    s_sub_u32 s83, s83, s8
    s_mul_i32 s9, s78, 81920
    s_mul_i32 s10, s79, 160
    s_add_u32 s9, s9, s10
    s_mul_i32 s10, s80, 20480
    s_add_u32 s9, s9, s10
    v_and_b32 v106, 15, v0
    v_mul_u32_u24 v106, 1280, v106
    v_lshrrev_b32 v108, 4, v0
    v_lshl_add_u32 v107, v108, 3, v106
    v_bfe_u32 v108, v0, 4, 1
    v_lshl_add_u32 v106, v108, 5, v106
    v_lshrrev_b32 v108, 5, v0
    v_lshl_add_u32 v106, v108, 4, v106
    buffer_load_dwordx4 v[96:99], v106, s[36:39], s9 offen
    buffer_load_dwordx4 v[100:103], v106, s[36:39], s9 offen offset:64
    buffer_load_dwordx2 v[104:105], v107, s[36:39], s9 offen offset:128
    s_lshr_b32 s8, s5, 1
    s_mul_i32 s9, s8, 17
    s_and_b32 s8, s5, 1
    s_lshl_b32 s8, s8, 2
    s_add_u32 s9, s9, s8
    s_lshr_b32 s8, s80, 1
    s_add_u32 s9, s9, s8
    s_add_u32 s9, s9, 2
    s_lshl_b32 s10, s6, 1
    s_add_u32 s10, s10, s7
    s_mul_i32 s11, s10, 768
    s_lshl_b32 s12, s9, 2
    s_add_u32 s11, s11, s12
    s_add_u32 s71, s11, 655360
    s_mul_i32 s10, s10, 68
    s_add_u32 s10, s10, s9
    s_lshl_b32 s10, s10, 12
    s_add_u32 s70, s10, 1048576
    v_lshlrev_b32 v72, 16, v114
    v_and_b32 v73, 0xffff0000, v114
    v_lshlrev_b32 v74, 16, v115
    v_and_b32 v75, 0xffff0000, v115
    v_lshlrev_b32 v76, 16, v116
    v_and_b32 v77, 0xffff0000, v116
    v_lshlrev_b32 v78, 16, v117
    v_and_b32 v79, 0xffff0000, v117
    v_pk_mul_f32 v[72:73], v[72:73], s[100:101] op_sel_hi:[1,0]
    v_pk_mul_f32 v[74:75], v[74:75], s[100:101] op_sel_hi:[1,0]
    v_pk_mul_f32 v[76:77], v[76:77], s[100:101] op_sel_hi:[1,0]
    v_pk_mul_f32 v[78:79], v[78:79], s[100:101] op_sel_hi:[1,0]
    s_waitcnt lgkmcnt(0)
    v_pk_add_f32 v[48:49], v[48:49], v[56:57]
    v_pk_add_f32 v[50:51], v[50:51], v[58:59]
    v_pk_add_f32 v[52:53], v[52:53], v[60:61]
    v_pk_add_f32 v[54:55], v[54:55], v[62:63]
    v_mul_f32 v64, s100, v64
    v_mul_f32 v66, s100, v66
    v_mul_f32 v68, s100, v68
    v_mul_f32 v70, s100, v70
    v_pk_mul_f32 v[48:49], v[48:49], s[100:101] op_sel_hi:[1,0]
    v_pk_mul_f32 v[50:51], v[50:51], s[100:101] op_sel_hi:[1,0]
    v_pk_mul_f32 v[52:53], v[52:53], s[100:101] op_sel_hi:[1,0]
    v_pk_mul_f32 v[54:55], v[54:55], s[100:101] op_sel_hi:[1,0]
    v_pk_fma_f32 v[120:121], v[64:65], v[48:49], v[72:73] op_sel:[1,0,0]
    v_pk_fma_f32 v[122:123], v[64:65], v[50:51], v[74:75] op_sel:[1,0,0]
    v_pk_fma_f32 v[124:125], v[64:65], v[52:53], v[76:77] op_sel:[1,0,0]
    v_pk_fma_f32 v[126:127], v[64:65], v[54:55], v[78:79] op_sel:[1,0,0]
    v_pk_fma_f32 v[120:121], v[16:17], v[64:65], v[120:121] op_sel_hi:[1,0,1]
    v_pk_fma_f32 v[122:123], v[18:19], v[64:65], v[122:123] op_sel_hi:[1,0,1]
    v_pk_fma_f32 v[124:125], v[20:21], v[64:65], v[124:125] op_sel_hi:[1,0,1]
    v_pk_fma_f32 v[126:127], v[22:23], v[64:65], v[126:127] op_sel_hi:[1,0,1]
    v_exp_f32 v128, v120
    v_exp_f32 v129, v121
    v_exp_f32 v130, v122
    v_exp_f32 v131, v123
    v_exp_f32 v132, v124
    v_exp_f32 v133, v125
    v_exp_f32 v134, v126
    v_exp_f32 v135, v127
    v_pk_add_f32 v[136:137], v[128:129], 2.0 op_sel_hi:[1,0]
    v_pk_add_f32 v[138:139], v[130:131], 2.0 op_sel_hi:[1,0]
    v_pk_add_f32 v[140:141], v[132:133], 2.0 op_sel_hi:[1,0]
    v_pk_add_f32 v[142:143], v[134:135], 2.0 op_sel_hi:[1,0]
    v_pk_fma_f32 v[136:137], v[128:129], v[136:137], 2.0 op_sel_hi:[1,1,0]
    v_pk_fma_f32 v[138:139], v[130:131], v[138:139], 2.0 op_sel_hi:[1,1,0]
    v_pk_fma_f32 v[140:141], v[132:133], v[140:141], 2.0 op_sel_hi:[1,1,0]
    v_pk_fma_f32 v[142:143], v[134:135], v[142:143], 2.0 op_sel_hi:[1,1,0]
    v_rcp_f32 v136, v136
    v_rcp_f32 v137, v137
    v_rcp_f32 v138, v138
    v_rcp_f32 v139, v139
    v_rcp_f32 v140, v140
    v_rcp_f32 v141, v141
    v_rcp_f32 v142, v142
    v_rcp_f32 v143, v143
    v_pk_fma_f32 v[136:137], v[136:137], s[98:99], s[98:99] op_sel:[0,0,1] op_sel_hi:[1,0,1]
    v_pk_fma_f32 v[138:139], v[138:139], s[98:99], s[98:99] op_sel:[0,0,1] op_sel_hi:[1,0,1]
    v_pk_fma_f32 v[140:141], v[140:141], s[98:99], s[98:99] op_sel:[0,0,1] op_sel_hi:[1,0,1]
    v_pk_fma_f32 v[142:143], v[142:143], s[98:99], s[98:99] op_sel:[0,0,1] op_sel_hi:[1,0,1]
    v_pk_mul_f32 v[120:121], v[120:121], v[136:137]
    v_pk_mul_f32 v[122:123], v[122:123], v[138:139]
    v_pk_mul_f32 v[124:125], v[124:125], v[140:141]
    v_pk_mul_f32 v[126:127], v[126:127], v[142:143]
    v_cvt_pk_bf16_f32 v144, v120, v121
    v_cvt_pk_bf16_f32 v145, v122, v123
    v_cvt_pk_bf16_f32 v146, v124, v125
    v_cvt_pk_bf16_f32 v147, v126, v127
    buffer_store_dwordx4 v[144:147], v8, s[48:51], s70 offen offset:0 sc1
    v_pk_fma_f32 v[120:121], v[66:67], v[48:49], v[72:73] op_sel:[1,0,0]
    v_pk_fma_f32 v[122:123], v[66:67], v[50:51], v[74:75] op_sel:[1,0,0]
    v_pk_fma_f32 v[124:125], v[66:67], v[52:53], v[76:77] op_sel:[1,0,0]
    v_pk_fma_f32 v[126:127], v[66:67], v[54:55], v[78:79] op_sel:[1,0,0]
    v_pk_fma_f32 v[120:121], v[24:25], v[66:67], v[120:121] op_sel_hi:[1,0,1]
    v_pk_fma_f32 v[122:123], v[26:27], v[66:67], v[122:123] op_sel_hi:[1,0,1]
    v_pk_fma_f32 v[124:125], v[28:29], v[66:67], v[124:125] op_sel_hi:[1,0,1]
    v_pk_fma_f32 v[126:127], v[30:31], v[66:67], v[126:127] op_sel_hi:[1,0,1]
    v_exp_f32 v128, v120
    v_exp_f32 v129, v121
    v_exp_f32 v130, v122
    v_exp_f32 v131, v123
    v_exp_f32 v132, v124
    v_exp_f32 v133, v125
    v_exp_f32 v134, v126
    v_exp_f32 v135, v127
    v_pk_add_f32 v[136:137], v[128:129], 2.0 op_sel_hi:[1,0]
    v_pk_add_f32 v[138:139], v[130:131], 2.0 op_sel_hi:[1,0]
    v_pk_add_f32 v[140:141], v[132:133], 2.0 op_sel_hi:[1,0]
    v_pk_add_f32 v[142:143], v[134:135], 2.0 op_sel_hi:[1,0]
    v_pk_fma_f32 v[136:137], v[128:129], v[136:137], 2.0 op_sel_hi:[1,1,0]
    v_pk_fma_f32 v[138:139], v[130:131], v[138:139], 2.0 op_sel_hi:[1,1,0]
    v_pk_fma_f32 v[140:141], v[132:133], v[140:141], 2.0 op_sel_hi:[1,1,0]
    v_pk_fma_f32 v[142:143], v[134:135], v[142:143], 2.0 op_sel_hi:[1,1,0]
    v_rcp_f32 v136, v136
    v_rcp_f32 v137, v137
    v_rcp_f32 v138, v138
    v_rcp_f32 v139, v139
    v_rcp_f32 v140, v140
    v_rcp_f32 v141, v141
    v_rcp_f32 v142, v142
    v_rcp_f32 v143, v143
    v_pk_fma_f32 v[136:137], v[136:137], s[98:99], s[98:99] op_sel:[0,0,1] op_sel_hi:[1,0,1]
    v_pk_fma_f32 v[138:139], v[138:139], s[98:99], s[98:99] op_sel:[0,0,1] op_sel_hi:[1,0,1]
    v_pk_fma_f32 v[140:141], v[140:141], s[98:99], s[98:99] op_sel:[0,0,1] op_sel_hi:[1,0,1]
    v_pk_fma_f32 v[142:143], v[142:143], s[98:99], s[98:99] op_sel:[0,0,1] op_sel_hi:[1,0,1]
    v_pk_mul_f32 v[120:121], v[120:121], v[136:137]
    v_pk_mul_f32 v[122:123], v[122:123], v[138:139]
    v_pk_mul_f32 v[124:125], v[124:125], v[140:141]
    v_pk_mul_f32 v[126:127], v[126:127], v[142:143]
    v_cvt_pk_bf16_f32 v148, v120, v121
    v_cvt_pk_bf16_f32 v149, v122, v123
    v_cvt_pk_bf16_f32 v150, v124, v125
    v_cvt_pk_bf16_f32 v151, v126, v127
    buffer_store_dwordx4 v[148:151], v8, s[48:51], s70 offen offset:1024 sc1
    v_pk_fma_f32 v[120:121], v[68:69], v[48:49], v[72:73] op_sel:[1,0,0]
    v_pk_fma_f32 v[122:123], v[68:69], v[50:51], v[74:75] op_sel:[1,0,0]
    v_pk_fma_f32 v[124:125], v[68:69], v[52:53], v[76:77] op_sel:[1,0,0]
    v_pk_fma_f32 v[126:127], v[68:69], v[54:55], v[78:79] op_sel:[1,0,0]
    v_pk_fma_f32 v[120:121], v[32:33], v[68:69], v[120:121] op_sel_hi:[1,0,1]
    v_pk_fma_f32 v[122:123], v[34:35], v[68:69], v[122:123] op_sel_hi:[1,0,1]
    v_pk_fma_f32 v[124:125], v[36:37], v[68:69], v[124:125] op_sel_hi:[1,0,1]
    v_pk_fma_f32 v[126:127], v[38:39], v[68:69], v[126:127] op_sel_hi:[1,0,1]
    v_exp_f32 v128, v120
    v_exp_f32 v129, v121
    v_exp_f32 v130, v122
    v_exp_f32 v131, v123
    v_exp_f32 v132, v124
    v_exp_f32 v133, v125
    v_exp_f32 v134, v126
    v_exp_f32 v135, v127
    v_pk_add_f32 v[136:137], v[128:129], 2.0 op_sel_hi:[1,0]
    v_pk_add_f32 v[138:139], v[130:131], 2.0 op_sel_hi:[1,0]
    v_pk_add_f32 v[140:141], v[132:133], 2.0 op_sel_hi:[1,0]
    v_pk_add_f32 v[142:143], v[134:135], 2.0 op_sel_hi:[1,0]
    v_pk_fma_f32 v[136:137], v[128:129], v[136:137], 2.0 op_sel_hi:[1,1,0]
    v_pk_fma_f32 v[138:139], v[130:131], v[138:139], 2.0 op_sel_hi:[1,1,0]
    v_pk_fma_f32 v[140:141], v[132:133], v[140:141], 2.0 op_sel_hi:[1,1,0]
    v_pk_fma_f32 v[142:143], v[134:135], v[142:143], 2.0 op_sel_hi:[1,1,0]
    v_rcp_f32 v136, v136
    v_rcp_f32 v137, v137
    v_rcp_f32 v138, v138
    v_rcp_f32 v139, v139
    v_rcp_f32 v140, v140
    v_rcp_f32 v141, v141
    v_rcp_f32 v142, v142
    v_rcp_f32 v143, v143
    v_pk_fma_f32 v[136:137], v[136:137], s[98:99], s[98:99] op_sel:[0,0,1] op_sel_hi:[1,0,1]
    v_pk_fma_f32 v[138:139], v[138:139], s[98:99], s[98:99] op_sel:[0,0,1] op_sel_hi:[1,0,1]
    v_pk_fma_f32 v[140:141], v[140:141], s[98:99], s[98:99] op_sel:[0,0,1] op_sel_hi:[1,0,1]
    v_pk_fma_f32 v[142:143], v[142:143], s[98:99], s[98:99] op_sel:[0,0,1] op_sel_hi:[1,0,1]
    v_pk_mul_f32 v[120:121], v[120:121], v[136:137]
    v_pk_mul_f32 v[122:123], v[122:123], v[138:139]
    v_pk_mul_f32 v[124:125], v[124:125], v[140:141]
    v_pk_mul_f32 v[126:127], v[126:127], v[142:143]
    v_cvt_pk_bf16_f32 v144, v120, v121
    v_cvt_pk_bf16_f32 v145, v122, v123
    v_cvt_pk_bf16_f32 v146, v124, v125
    v_cvt_pk_bf16_f32 v147, v126, v127
    buffer_store_dwordx4 v[144:147], v8, s[48:51], s70 offen offset:2048 sc1
    v_pk_fma_f32 v[120:121], v[70:71], v[48:49], v[72:73] op_sel:[1,0,0]
    v_pk_fma_f32 v[122:123], v[70:71], v[50:51], v[74:75] op_sel:[1,0,0]
    v_pk_fma_f32 v[124:125], v[70:71], v[52:53], v[76:77] op_sel:[1,0,0]
    v_pk_fma_f32 v[126:127], v[70:71], v[54:55], v[78:79] op_sel:[1,0,0]
    v_pk_fma_f32 v[120:121], v[40:41], v[70:71], v[120:121] op_sel_hi:[1,0,1]
    v_pk_fma_f32 v[122:123], v[42:43], v[70:71], v[122:123] op_sel_hi:[1,0,1]
    v_pk_fma_f32 v[124:125], v[44:45], v[70:71], v[124:125] op_sel_hi:[1,0,1]
    v_pk_fma_f32 v[126:127], v[46:47], v[70:71], v[126:127] op_sel_hi:[1,0,1]
    v_exp_f32 v128, v120
    v_exp_f32 v129, v121
    v_exp_f32 v130, v122
    v_exp_f32 v131, v123
    v_exp_f32 v132, v124
    v_exp_f32 v133, v125
    v_exp_f32 v134, v126
    v_exp_f32 v135, v127
    v_pk_add_f32 v[136:137], v[128:129], 2.0 op_sel_hi:[1,0]
    v_pk_add_f32 v[138:139], v[130:131], 2.0 op_sel_hi:[1,0]
    v_pk_add_f32 v[140:141], v[132:133], 2.0 op_sel_hi:[1,0]
    v_pk_add_f32 v[142:143], v[134:135], 2.0 op_sel_hi:[1,0]
    v_pk_fma_f32 v[136:137], v[128:129], v[136:137], 2.0 op_sel_hi:[1,1,0]
    v_pk_fma_f32 v[138:139], v[130:131], v[138:139], 2.0 op_sel_hi:[1,1,0]
    v_pk_fma_f32 v[140:141], v[132:133], v[140:141], 2.0 op_sel_hi:[1,1,0]
    v_pk_fma_f32 v[142:143], v[134:135], v[142:143], 2.0 op_sel_hi:[1,1,0]
    v_rcp_f32 v136, v136
    v_rcp_f32 v137, v137
    v_rcp_f32 v138, v138
    v_rcp_f32 v139, v139
    v_rcp_f32 v140, v140
    v_rcp_f32 v141, v141
    v_rcp_f32 v142, v142
    v_rcp_f32 v143, v143
    v_pk_fma_f32 v[136:137], v[136:137], s[98:99], s[98:99] op_sel:[0,0,1] op_sel_hi:[1,0,1]
    v_pk_fma_f32 v[138:139], v[138:139], s[98:99], s[98:99] op_sel:[0,0,1] op_sel_hi:[1,0,1]
    v_pk_fma_f32 v[140:141], v[140:141], s[98:99], s[98:99] op_sel:[0,0,1] op_sel_hi:[1,0,1]
    v_pk_fma_f32 v[142:143], v[142:143], s[98:99], s[98:99] op_sel:[0,0,1] op_sel_hi:[1,0,1]
    v_pk_mul_f32 v[120:121], v[120:121], v[136:137]
    v_pk_mul_f32 v[122:123], v[122:123], v[138:139]
    v_pk_mul_f32 v[124:125], v[124:125], v[140:141]
    v_pk_mul_f32 v[126:127], v[126:127], v[142:143]
    v_cvt_pk_bf16_f32 v148, v120, v121
    v_cvt_pk_bf16_f32 v149, v122, v123
    v_cvt_pk_bf16_f32 v150, v124, v125
    v_cvt_pk_bf16_f32 v151, v126, v127
    buffer_store_dwordx4 v[148:151], v8, s[48:51], s70 offen offset:3072 sc1
    s_waitcnt vmcnt(0)
    v_lshlrev_b32 v14, 2, v0
    v_mov_b32 v15, s77
    s_mov_b64 exec, 1
    buffer_store_dword v15, v14, s[48:51], s71 offen offset:0 sc1
    s_mov_b64 exec, -1
    v_mov_b32 v14, 163352
    v_mov_b32 v15, 1
    s_mov_b64 exec, 1
    ds_add_u32 v14, v15
    s_mov_b64 exec, -1
L_p2early:
    s_lshl_b32 s9, s4, 1
    s_sub_u32 s9, 8, s9
    v_mov_b32 v14, 163352
    s_mov_b32 s8, 0
Ls_pub_39:
    ds_read_b32 v15, v14
    s_add_u32 s8, s8, 1
    s_cmp_ge_u32 s8, 100000
    s_cbranch_scc1 Lsd_pub_40
    s_waitcnt lgkmcnt(0)
    v_cmp_gt_u32 vcc, s9, v15
    s_cbranch_vccnz Ls_pub_39
Lsd_pub_40:
    s_waitcnt lgkmcnt(0)
    s_mul_i32 s8, s78, 768
    s_add_u32 s8, s8, 655360
    v_min_u32 v14, 47, v0
    v_mul_u32_u24 v15, 5462, v14
    v_lshrrev_b32 v15, 16, v15
    v_mad_u32_u24 v14, v15, 5, v14
    v_lshl_add_u32 v12, v14, 2, s8
    v_add_u32 v4, s73, v8
    v_mov_b32 v3, 163348
    s_cmp_eq_u32 s4, 1
    s_cbranch_scc1 Lqb_43
    s_add_u32 m0, s73, 0
    s_nop 0
    buffer_load_dwordx4 v8, s[48:51], s83 offen offset:0 sc1 lds
    buffer_load_dwordx4 v8, s[48:51], s83 offen offset:1024 sc1 lds
    buffer_load_dwordx4 v8, s[48:51], s83 offen offset:2048 sc1 lds
    buffer_load_dwordx4 v8, s[48:51], s83 offen offset:3072 sc1 lds
    s_add_u32 m0, s73, 4096
    s_nop 0
    buffer_load_dwordx4 v9, s[48:51], s83 offen offset:0 sc1 lds
    s_add_u32 s83, s83, 5120
    s_add_u32 s84, s84, 1
    s_cmp_eq_u32 s84, 12
    s_cselect_b32 s8, 61440, 0
    s_cselect_b32 s84, 0, s84
    s_sub_u32 s83, s83, s8
    s_add_u32 m0, s73, 20480
    s_nop 0
    buffer_load_dwordx4 v8, s[48:51], s83 offen offset:0 sc1 lds
    buffer_load_dwordx4 v8, s[48:51], s83 offen offset:1024 sc1 lds
    buffer_load_dwordx4 v8, s[48:51], s83 offen offset:2048 sc1 lds
    buffer_load_dwordx4 v8, s[48:51], s83 offen offset:3072 sc1 lds
    s_add_u32 m0, s73, 24576
    s_nop 0
    buffer_load_dwordx4 v9, s[48:51], s83 offen offset:0 sc1 lds
    s_add_u32 s83, s83, 5120
    s_add_u32 s84, s84, 1
    s_cmp_eq_u32 s84, 12
    s_cselect_b32 s8, 61440, 0
    s_cselect_b32 s84, 0, s84
    s_sub_u32 s83, s83, s8
    s_add_u32 m0, s73, 40960
    s_nop 0
    buffer_load_dwordx4 v8, s[48:51], s83 offen offset:0 sc1 lds
    buffer_load_dwordx4 v8, s[48:51], s83 offen offset:1024 sc1 lds
    buffer_load_dwordx4 v8, s[48:51], s83 offen offset:2048 sc1 lds
    buffer_load_dwordx4 v8, s[48:51], s83 offen offset:3072 sc1 lds
    s_add_u32 m0, s73, 45056
    s_nop 0
    buffer_load_dwordx4 v9, s[48:51], s83 offen offset:0 sc1 lds
    s_add_u32 s83, s83, 5120
    s_add_u32 s84, s84, 1
    s_cmp_eq_u32 s84, 12
    s_cselect_b32 s8, 61440, 0
    s_cselect_b32 s84, 0, s84
    s_sub_u32 s83, s83, s8
Lqb_43:
    v_mov_b32 v16, 0
    v_mov_b32 v17, 0
    v_mov_b32 v18, 0
    v_mov_b32 v19, 0
    v_mov_b32 v20, 0
    v_mov_b32 v21, 0
    v_mov_b32 v22, 0
    v_mov_b32 v23, 0
    v_mov_b32 v24, 0
    v_mov_b32 v25, 0
    v_mov_b32 v26, 0
    v_mov_b32 v27, 0
    v_mov_b32 v28, 0
    v_mov_b32 v29, 0
    v_mov_b32 v30, 0
    v_mov_b32 v31, 0
    v_mov_b32 v32, 0
    v_mov_b32 v33, 0
    v_mov_b32 v34, 0
    v_mov_b32 v35, 0
    v_mov_b32 v36, 0
    v_mov_b32 v37, 0
    v_mov_b32 v38, 0
    v_mov_b32 v39, 0
    v_mov_b32 v40, 0
    v_mov_b32 v41, 0
    v_mov_b32 v42, 0
    v_mov_b32 v43, 0
    v_mov_b32 v44, 0
    v_mov_b32 v45, 0
    v_mov_b32 v46, 0
    v_mov_b32 v47, 0
    v_mov_b32 v48, 0
    v_mov_b32 v49, 0
    v_mov_b32 v50, 0
    v_mov_b32 v51, 0
    v_mov_b32 v52, 0
    v_mov_b32 v53, 0
    v_mov_b32 v54, 0
    v_mov_b32 v55, 0
    v_mov_b32 v56, 0
    v_mov_b32 v57, 0
    v_mov_b32 v58, 0
    v_mov_b32 v59, 0
    v_mov_b32 v60, 0
    v_mov_b32 v61, 0
    v_mov_b32 v62, 0
    v_mov_b32 v63, 0
    v_mov_b32 v64, 0
    v_mov_b32 v65, 0
    v_mov_b32 v66, 0
    v_mov_b32 v67, 0
    v_mov_b32 v68, 0
    v_mov_b32 v69, 0
    v_mov_b32 v70, 0
    v_mov_b32 v71, 0
    v_mov_b32 v72, 0
    v_mov_b32 v73, 0
    v_mov_b32 v74, 0
    v_mov_b32 v75, 0
    v_mov_b32 v76, 0
    v_mov_b32 v77, 0
    v_mov_b32 v78, 0
    v_mov_b32 v79, 0
    v_mov_b32 v80, 0
    v_mov_b32 v81, 0
    v_mov_b32 v82, 0
    v_mov_b32 v83, 0
    v_mov_b32 v84, 0
    v_mov_b32 v85, 0
    v_mov_b32 v86, 0
    v_mov_b32 v87, 0
    v_mov_b32 v88, 0
    v_mov_b32 v89, 0
    v_mov_b32 v90, 0
    v_mov_b32 v91, 0
    v_mov_b32 v92, 0
    v_mov_b32 v93, 0
    v_mov_b32 v94, 0
    v_mov_b32 v95, 0
    v_permlane16_swap_b32 v96, v98
    v_permlane16_swap_b32 v97, v99
    v_permlane16_swap_b32 v100, v102
    v_permlane16_swap_b32 v101, v103
    s_cmp_eq_u32 s80, 0
    s_cbranch_scc0 Lxr_45
    v_lshlrev_b32 v16, 16, v96
    v_and_b32 v17, 0xffff0000, v96
    v_lshlrev_b32 v18, 16, v97
    v_and_b32 v19, 0xffff0000, v97
    v_lshlrev_b32 v20, 16, v98
    v_and_b32 v21, 0xffff0000, v98
    v_lshlrev_b32 v22, 16, v99
    v_and_b32 v23, 0xffff0000, v99
    v_lshlrev_b32 v24, 16, v100
    v_and_b32 v25, 0xffff0000, v100
    v_lshlrev_b32 v26, 16, v101
    v_and_b32 v27, 0xffff0000, v101
    v_lshlrev_b32 v28, 16, v102
    v_and_b32 v29, 0xffff0000, v102
    v_lshlrev_b32 v30, 16, v103
    v_and_b32 v31, 0xffff0000, v103
    v_lshlrev_b32 v32, 16, v104
    v_and_b32 v33, 0xffff0000, v104
    v_lshlrev_b32 v34, 16, v105
    v_and_b32 v35, 0xffff0000, v105
    s_branch Lxr_44
Lxr_45:
    s_cmp_eq_u32 s80, 1
    s_cbranch_scc0 Lxr_46
    v_lshlrev_b32 v36, 16, v96
    v_and_b32 v37, 0xffff0000, v96
    v_lshlrev_b32 v38, 16, v97
    v_and_b32 v39, 0xffff0000, v97
    v_lshlrev_b32 v40, 16, v98
    v_and_b32 v41, 0xffff0000, v98
    v_lshlrev_b32 v42, 16, v99
    v_and_b32 v43, 0xffff0000, v99
    v_lshlrev_b32 v44, 16, v100
    v_and_b32 v45, 0xffff0000, v100
    v_lshlrev_b32 v46, 16, v101
    v_and_b32 v47, 0xffff0000, v101
    v_lshlrev_b32 v48, 16, v102
    v_and_b32 v49, 0xffff0000, v102
    v_lshlrev_b32 v50, 16, v103
    v_and_b32 v51, 0xffff0000, v103
    v_lshlrev_b32 v52, 16, v104
    v_and_b32 v53, 0xffff0000, v104
    v_lshlrev_b32 v54, 16, v105
    v_and_b32 v55, 0xffff0000, v105
    s_branch Lxr_44
Lxr_46:
    s_cmp_eq_u32 s80, 2
    s_cbranch_scc0 Lxr_47
    v_lshlrev_b32 v56, 16, v96
    v_and_b32 v57, 0xffff0000, v96
    v_lshlrev_b32 v58, 16, v97
    v_and_b32 v59, 0xffff0000, v97
    v_lshlrev_b32 v60, 16, v98
    v_and_b32 v61, 0xffff0000, v98
    v_lshlrev_b32 v62, 16, v99
    v_and_b32 v63, 0xffff0000, v99
    v_lshlrev_b32 v64, 16, v100
    v_and_b32 v65, 0xffff0000, v100
    v_lshlrev_b32 v66, 16, v101
    v_and_b32 v67, 0xffff0000, v101
    v_lshlrev_b32 v68, 16, v102
    v_and_b32 v69, 0xffff0000, v102
    v_lshlrev_b32 v70, 16, v103
    v_and_b32 v71, 0xffff0000, v103
    v_lshlrev_b32 v72, 16, v104
    v_and_b32 v73, 0xffff0000, v104
    v_lshlrev_b32 v74, 16, v105
    v_and_b32 v75, 0xffff0000, v105
    s_branch Lxr_44
Lxr_47:
    v_lshlrev_b32 v76, 16, v96
    v_and_b32 v77, 0xffff0000, v96
    v_lshlrev_b32 v78, 16, v97
    v_and_b32 v79, 0xffff0000, v97
    v_lshlrev_b32 v80, 16, v98
    v_and_b32 v81, 0xffff0000, v98
    v_lshlrev_b32 v82, 16, v99
    v_and_b32 v83, 0xffff0000, v99
    v_lshlrev_b32 v84, 16, v100
    v_and_b32 v85, 0xffff0000, v100
    v_lshlrev_b32 v86, 16, v101
    v_and_b32 v87, 0xffff0000, v101
    v_lshlrev_b32 v88, 16, v102
    v_and_b32 v89, 0xffff0000, v102
    v_lshlrev_b32 v90, 16, v103
    v_and_b32 v91, 0xffff0000, v103
    v_lshlrev_b32 v92, 16, v104
    v_and_b32 v93, 0xffff0000, v104
    v_lshlrev_b32 v94, 16, v105
    v_and_b32 v95, 0xffff0000, v105
Lxr_44:
    s_cmp_eq_u32 s80, 0
    s_cbranch_scc0 Loa_41
    s_mov_b32 s8, 0
Lpoll_act_49:
    buffer_load_dword v13, v12, s[48:51], 0 offen sc1
    s_waitcnt vmcnt(0)
Lchk_act_50:
    s_add_u32 s8, s8, 1
    s_cmp_ge_u32 s8, 100000
    s_cbranch_scc1 Ldone_act_51
    v_cmp_ne_u32 vcc, s77, v13
    s_cbranch_vccnz Lpoll_act_49
Ldone_act_51:
    ds_write_b32 v3, v11
    s_branch Loa_42
Loa_41:
    s_mov_b32 s8, 0
Ls_actp_52:
    ds_read_b32 v15, v3
    s_add_u32 s8, s8, 1
    s_cmp_ge_u32 s8, 100000
    s_cbranch_scc1 Lsd_actp_53
    s_waitcnt lgkmcnt(0)
    v_cmp_eq_u32 vcc, 0, v15
    s_cbranch_vccnz Ls_actp_52
Lsd_actp_53:
    s_waitcnt lgkmcnt(0)
Loa_42:
    s_lshl_b32 s9, s4, 2
    v_mov_b32 v14, 163388
    s_mov_b32 s8, 0
Ls_gi_54:
    ds_read_b32 v15, v14
    s_add_u32 s8, s8, 1
    s_cmp_ge_u32 s8, 100000
    s_cbranch_scc1 Lsd_gi_55
    s_waitcnt lgkmcnt(0)
    v_cmp_gt_u32 vcc, s9, v15
    s_cbranch_vccnz Ls_gi_54
Lsd_gi_55:
    s_waitcnt lgkmcnt(0)
    buffer_load_dwordx4 v[96:99], v8, s[48:51], s92 offen offset:0 sc1
    buffer_load_dwordx4 v[100:103], v8, s[48:51], s92 offen offset:1024 sc1
    buffer_load_dwordx4 v[104:107], v8, s[48:51], s92 offen offset:2048 sc1
    buffer_load_dwordx4 v[108:111], v8, s[48:51], s92 offen offset:3072 sc1
    s_add_u32 s92, s92, 4096
    s_add_u32 s85, s85, 1
    s_cmp_eq_u32 s85, 12
    s_cselect_b32 s8, 49152, 0
    s_cselect_b32 s85, 0, s85
    s_sub_u32 s92, s92, s8
    buffer_load_dwordx4 v[112:115], v8, s[48:51], s92 offen offset:0 sc1
    buffer_load_dwordx4 v[116:119], v8, s[48:51], s92 offen offset:1024 sc1
    buffer_load_dwordx4 v[120:123], v8, s[48:51], s92 offen offset:2048 sc1
    buffer_load_dwordx4 v[124:127], v8, s[48:51], s92 offen offset:3072 sc1
    s_add_u32 s92, s92, 4096
    s_add_u32 s85, s85, 1
    s_cmp_eq_u32 s85, 12
    s_cselect_b32 s8, 49152, 0
    s_cselect_b32 s85, 0, s85
    s_sub_u32 s92, s92, s8
    buffer_load_dwordx4 v[128:131], v8, s[48:51], s92 offen offset:0 sc1
    buffer_load_dwordx4 v[132:135], v8, s[48:51], s92 offen offset:1024 sc1
    buffer_load_dwordx4 v[136:139], v8, s[48:51], s92 offen offset:2048 sc1
    buffer_load_dwordx4 v[140:143], v8, s[48:51], s92 offen offset:3072 sc1
    s_add_u32 s92, s92, 4096
    s_add_u32 s85, s85, 1
    s_cmp_eq_u32 s85, 12
    s_cselect_b32 s8, 49152, 0
    s_cselect_b32 s85, 0, s85
    s_sub_u32 s92, s92, s8
    s_lshl_b32 s9, s4, 3
    v_mov_b32 v14, 163360
    s_mov_b32 s8, 0
Ls_qd_56:
    ds_read_b32 v15, v14
    s_add_u32 s8, s8, 1
    s_cmp_ge_u32 s8, 100000
    s_cbranch_scc1 Lsd_qd_57
    s_waitcnt lgkmcnt(0)
    v_cmp_gt_u32 vcc, s9, v15
    s_cbranch_vccnz Ls_qd_56
Lsd_qd_57:
    s_waitcnt lgkmcnt(0)
    v_add_u32 v5, 65536, v4
    s_waitcnt vmcnt(8)
    v_mfma_f32_16x16x32_bf16 v[16:19], v[156:159], v[96:99], v[16:19]
    v_mfma_f32_16x16x32_bf16 v[20:23], v[160:163], v[96:99], v[20:23]
    v_mfma_f32_16x16x32_bf16 v[24:27], v[164:167], v[96:99], v[24:27]
    v_mfma_f32_16x16x32_bf16 v[28:31], v[168:171], v[96:99], v[28:31]
    v_mfma_f32_16x16x32_bf16 v[32:35], v[172:175], v[96:99], v[32:35]
    v_mfma_f32_16x16x32_bf16 v[36:39], v[156:159], v[100:103], v[36:39]
    v_mfma_f32_16x16x32_bf16 v[40:43], v[160:163], v[100:103], v[40:43]
    v_mfma_f32_16x16x32_bf16 v[44:47], v[164:167], v[100:103], v[44:47]
    v_mfma_f32_16x16x32_bf16 v[48:51], v[168:171], v[100:103], v[48:51]
    v_mfma_f32_16x16x32_bf16 v[52:55], v[172:175], v[100:103], v[52:55]
    v_mfma_f32_16x16x32_bf16 v[56:59], v[156:159], v[104:107], v[56:59]
    v_mfma_f32_16x16x32_bf16 v[60:63], v[160:163], v[104:107], v[60:63]
    v_mfma_f32_16x16x32_bf16 v[64:67], v[164:167], v[104:107], v[64:67]
    v_mfma_f32_16x16x32_bf16 v[68:71], v[168:171], v[104:107], v[68:71]
    v_mfma_f32_16x16x32_bf16 v[72:75], v[172:175], v[104:107], v[72:75]
    v_mfma_f32_16x16x32_bf16 v[76:79], v[156:159], v[108:111], v[76:79]
    v_mfma_f32_16x16x32_bf16 v[80:83], v[160:163], v[108:111], v[80:83]
    v_mfma_f32_16x16x32_bf16 v[84:87], v[164:167], v[108:111], v[84:87]
    v_mfma_f32_16x16x32_bf16 v[88:91], v[168:171], v[108:111], v[88:91]
    v_mfma_f32_16x16x32_bf16 v[92:95], v[172:175], v[108:111], v[92:95]
    s_waitcnt vmcnt(4)
    v_mfma_f32_16x16x32_bf16 v[16:19], v[176:179], v[112:115], v[16:19]
    v_mfma_f32_16x16x32_bf16 v[20:23], v[180:183], v[112:115], v[20:23]
    buffer_load_dwordx4 v[96:99], v8, s[48:51], s92 offen offset:0 sc1
    v_mfma_f32_16x16x32_bf16 v[24:27], v[184:187], v[112:115], v[24:27]
    buffer_load_dwordx4 v[100:103], v8, s[48:51], s92 offen offset:1024 sc1
    v_mfma_f32_16x16x32_bf16 v[28:31], v[188:191], v[112:115], v[28:31]
    buffer_load_dwordx4 v[104:107], v8, s[48:51], s92 offen offset:2048 sc1
    v_mfma_f32_16x16x32_bf16 v[32:35], v[192:195], v[112:115], v[32:35]
    buffer_load_dwordx4 v[108:111], v8, s[48:51], s92 offen offset:3072 sc1
    s_add_u32 s92, s92, 4096
    s_add_u32 s85, s85, 1
    s_cmp_eq_u32 s85, 12
    s_cselect_b32 s8, 49152, 0
    s_cselect_b32 s85, 0, s85
    s_sub_u32 s92, s92, s8
    v_mfma_f32_16x16x32_bf16 v[36:39], v[176:179], v[116:119], v[36:39]
    v_mfma_f32_16x16x32_bf16 v[40:43], v[180:183], v[116:119], v[40:43]
    v_mfma_f32_16x16x32_bf16 v[44:47], v[184:187], v[116:119], v[44:47]
    v_mfma_f32_16x16x32_bf16 v[48:51], v[188:191], v[116:119], v[48:51]
    v_mfma_f32_16x16x32_bf16 v[52:55], v[192:195], v[116:119], v[52:55]
    v_mfma_f32_16x16x32_bf16 v[56:59], v[176:179], v[120:123], v[56:59]
    v_mfma_f32_16x16x32_bf16 v[60:63], v[180:183], v[120:123], v[60:63]
    v_mfma_f32_16x16x32_bf16 v[64:67], v[184:187], v[120:123], v[64:67]
    v_mfma_f32_16x16x32_bf16 v[68:71], v[188:191], v[120:123], v[68:71]
    v_mfma_f32_16x16x32_bf16 v[72:75], v[192:195], v[120:123], v[72:75]
    v_mfma_f32_16x16x32_bf16 v[76:79], v[176:179], v[124:127], v[76:79]
    v_mfma_f32_16x16x32_bf16 v[80:83], v[180:183], v[124:127], v[80:83]
    v_mfma_f32_16x16x32_bf16 v[84:87], v[184:187], v[124:127], v[84:87]
    v_mfma_f32_16x16x32_bf16 v[88:91], v[188:191], v[124:127], v[88:91]
    v_mfma_f32_16x16x32_bf16 v[92:95], v[192:195], v[124:127], v[92:95]
    s_waitcnt vmcnt(4)
    v_mfma_f32_16x16x32_bf16 v[16:19], v[196:199], v[128:131], v[16:19]
    v_mfma_f32_16x16x32_bf16 v[20:23], v[200:203], v[128:131], v[20:23]
    buffer_load_dwordx4 v[112:115], v8, s[48:51], s92 offen offset:0 sc1
    v_mfma_f32_16x16x32_bf16 v[24:27], v[204:207], v[128:131], v[24:27]
    buffer_load_dwordx4 v[116:119], v8, s[48:51], s92 offen offset:1024 sc1
    v_mfma_f32_16x16x32_bf16 v[28:31], v[208:211], v[128:131], v[28:31]
    buffer_load_dwordx4 v[120:123], v8, s[48:51], s92 offen offset:2048 sc1
    v_mfma_f32_16x16x32_bf16 v[32:35], v[212:215], v[128:131], v[32:35]
    buffer_load_dwordx4 v[124:127], v8, s[48:51], s92 offen offset:3072 sc1
    s_add_u32 s92, s92, 4096
    s_add_u32 s85, s85, 1
    s_cmp_eq_u32 s85, 12
    s_cselect_b32 s8, 49152, 0
    s_cselect_b32 s85, 0, s85
    s_sub_u32 s92, s92, s8
    v_mfma_f32_16x16x32_bf16 v[36:39], v[196:199], v[132:135], v[36:39]
    v_mfma_f32_16x16x32_bf16 v[40:43], v[200:203], v[132:135], v[40:43]
    v_mfma_f32_16x16x32_bf16 v[44:47], v[204:207], v[132:135], v[44:47]
    v_mfma_f32_16x16x32_bf16 v[48:51], v[208:211], v[132:135], v[48:51]
    v_mfma_f32_16x16x32_bf16 v[52:55], v[212:215], v[132:135], v[52:55]
    v_mfma_f32_16x16x32_bf16 v[56:59], v[196:199], v[136:139], v[56:59]
    v_mfma_f32_16x16x32_bf16 v[60:63], v[200:203], v[136:139], v[60:63]
    v_mfma_f32_16x16x32_bf16 v[64:67], v[204:207], v[136:139], v[64:67]
    v_mfma_f32_16x16x32_bf16 v[68:71], v[208:211], v[136:139], v[68:71]
    v_mfma_f32_16x16x32_bf16 v[72:75], v[212:215], v[136:139], v[72:75]
    v_mfma_f32_16x16x32_bf16 v[76:79], v[196:199], v[140:143], v[76:79]
    v_mfma_f32_16x16x32_bf16 v[80:83], v[200:203], v[140:143], v[80:83]
    v_mfma_f32_16x16x32_bf16 v[84:87], v[204:207], v[140:143], v[84:87]
    v_mfma_f32_16x16x32_bf16 v[88:91], v[208:211], v[140:143], v[88:91]
    v_mfma_f32_16x16x32_bf16 v[92:95], v[212:215], v[140:143], v[92:95]
    s_waitcnt vmcnt(4)
    v_mfma_f32_16x16x32_bf16 v[16:19], v[216:219], v[96:99], v[16:19]
    v_mfma_f32_16x16x32_bf16 v[20:23], v[220:223], v[96:99], v[20:23]
    ds_read_b128 v[156:159], v4 offset:61440
    v_mfma_f32_16x16x32_bf16 v[24:27], v[224:227], v[96:99], v[24:27]
    ds_read_b128 v[160:163], v4 offset:62464
    v_mfma_f32_16x16x32_bf16 v[28:31], v[228:231], v[96:99], v[28:31]
    ds_read_b128 v[164:167], v4 offset:63488
    v_mfma_f32_16x16x32_bf16 v[32:35], v[232:235], v[96:99], v[32:35]
    ds_read_b128 v[168:171], v4 offset:64512
    v_mfma_f32_16x16x32_bf16 v[36:39], v[216:219], v[100:103], v[36:39]
    ds_read_b128 v[172:175], v5 offset:0
    v_mfma_f32_16x16x32_bf16 v[40:43], v[220:223], v[100:103], v[40:43]
    buffer_load_dwordx4 v[128:131], v8, s[48:51], s92 offen offset:0 sc1
    v_mfma_f32_16x16x32_bf16 v[44:47], v[224:227], v[100:103], v[44:47]
    buffer_load_dwordx4 v[132:135], v8, s[48:51], s92 offen offset:1024 sc1
    v_mfma_f32_16x16x32_bf16 v[48:51], v[228:231], v[100:103], v[48:51]
    buffer_load_dwordx4 v[136:139], v8, s[48:51], s92 offen offset:2048 sc1
    v_mfma_f32_16x16x32_bf16 v[52:55], v[232:235], v[100:103], v[52:55]
    buffer_load_dwordx4 v[140:143], v8, s[48:51], s92 offen offset:3072 sc1
    s_add_u32 s92, s92, 4096
    s_add_u32 s85, s85, 1
    s_cmp_eq_u32 s85, 12
    s_cselect_b32 s8, 49152, 0
    s_cselect_b32 s85, 0, s85
    s_sub_u32 s92, s92, s8
    v_mfma_f32_16x16x32_bf16 v[56:59], v[216:219], v[104:107], v[56:59]
    buffer_load_dwordx4 v[196:199], v8, s[48:51], s92 offen offset:0 sc1
    v_mfma_f32_16x16x32_bf16 v[60:63], v[220:223], v[104:107], v[60:63]
    buffer_load_dwordx4 v[200:203], v8, s[48:51], s92 offen offset:1024 sc1
    v_mfma_f32_16x16x32_bf16 v[64:67], v[224:227], v[104:107], v[64:67]
    buffer_load_dwordx4 v[204:207], v8, s[48:51], s92 offen offset:2048 sc1
    v_mfma_f32_16x16x32_bf16 v[68:71], v[228:231], v[104:107], v[68:71]
    buffer_load_dwordx4 v[208:211], v8, s[48:51], s92 offen offset:3072 sc1
    s_add_u32 s92, s92, 4096
    s_add_u32 s85, s85, 1
    s_cmp_eq_u32 s85, 12
    s_cselect_b32 s8, 49152, 0
    s_cselect_b32 s85, 0, s85
    s_sub_u32 s92, s92, s8
    v_mfma_f32_16x16x32_bf16 v[72:75], v[232:235], v[104:107], v[72:75]
    v_mfma_f32_16x16x32_bf16 v[76:79], v[216:219], v[108:111], v[76:79]
    v_mfma_f32_16x16x32_bf16 v[80:83], v[220:223], v[108:111], v[80:83]
    v_mfma_f32_16x16x32_bf16 v[84:87], v[224:227], v[108:111], v[84:87]
    v_mfma_f32_16x16x32_bf16 v[88:91], v[228:231], v[108:111], v[88:91]
    v_mfma_f32_16x16x32_bf16 v[92:95], v[232:235], v[108:111], v[92:95]
    s_waitcnt vmcnt(8)
    v_mfma_f32_16x16x32_bf16 v[16:19], v[236:239], v[112:115], v[16:19]
    v_mfma_f32_16x16x32_bf16 v[20:23], v[240:243], v[112:115], v[20:23]
    buffer_load_dwordx4 v[96:99], v8, s[48:51], s92 offen offset:0 sc1
    v_mfma_f32_16x16x32_bf16 v[24:27], v[244:247], v[112:115], v[24:27]
    buffer_load_dwordx4 v[100:103], v8, s[48:51], s92 offen offset:1024 sc1
    v_mfma_f32_16x16x32_bf16 v[28:31], v[248:251], v[112:115], v[28:31]
    buffer_load_dwordx4 v[104:107], v8, s[48:51], s92 offen offset:2048 sc1
    v_mfma_f32_16x16x32_bf16 v[32:35], v[252:255], v[112:115], v[32:35]
    buffer_load_dwordx4 v[108:111], v8, s[48:51], s92 offen offset:3072 sc1
    s_add_u32 s92, s92, 4096
    s_add_u32 s85, s85, 1
    s_cmp_eq_u32 s85, 12
    s_cselect_b32 s8, 49152, 0
    s_cselect_b32 s85, 0, s85
    s_sub_u32 s92, s92, s8
    v_mfma_f32_16x16x32_bf16 v[36:39], v[236:239], v[116:119], v[36:39]
    buffer_load_dwordx4 v[216:219], v8, s[48:51], s92 offen offset:0 sc1
    v_mfma_f32_16x16x32_bf16 v[40:43], v[240:243], v[116:119], v[40:43]
    buffer_load_dwordx4 v[220:223], v8, s[48:51], s92 offen offset:1024 sc1
    v_mfma_f32_16x16x32_bf16 v[44:47], v[244:247], v[116:119], v[44:47]
    buffer_load_dwordx4 v[224:227], v8, s[48:51], s92 offen offset:2048 sc1
    v_mfma_f32_16x16x32_bf16 v[48:51], v[248:251], v[116:119], v[48:51]
    buffer_load_dwordx4 v[228:231], v8, s[48:51], s92 offen offset:3072 sc1
    s_add_u32 s92, s92, 4096
    s_add_u32 s85, s85, 1
    s_cmp_eq_u32 s85, 12
    s_cselect_b32 s8, 49152, 0
    s_cselect_b32 s85, 0, s85
    s_sub_u32 s92, s92, s8
    v_mfma_f32_16x16x32_bf16 v[52:55], v[252:255], v[116:119], v[52:55]
    v_mfma_f32_16x16x32_bf16 v[56:59], v[236:239], v[120:123], v[56:59]
    v_mfma_f32_16x16x32_bf16 v[60:63], v[240:243], v[120:123], v[60:63]
    v_mfma_f32_16x16x32_bf16 v[64:67], v[244:247], v[120:123], v[64:67]
    v_mfma_f32_16x16x32_bf16 v[68:71], v[248:251], v[120:123], v[68:71]
    v_mfma_f32_16x16x32_bf16 v[72:75], v[252:255], v[120:123], v[72:75]
    v_mfma_f32_16x16x32_bf16 v[76:79], v[236:239], v[124:127], v[76:79]
    v_mfma_f32_16x16x32_bf16 v[80:83], v[240:243], v[124:127], v[80:83]
    v_mfma_f32_16x16x32_bf16 v[84:87], v[244:247], v[124:127], v[84:87]
    v_mfma_f32_16x16x32_bf16 v[88:91], v[248:251], v[124:127], v[88:91]
    v_mfma_f32_16x16x32_bf16 v[92:95], v[252:255], v[124:127], v[92:95]
    s_waitcnt vmcnt(12) lgkmcnt(0)
    v_mfma_f32_16x16x32_bf16 v[16:19], v[156:159], v[128:131], v[16:19]
    v_mfma_f32_16x16x32_bf16 v[20:23], v[160:163], v[128:131], v[20:23]
    ds_read_b128 v[176:179], v5 offset:16384
    v_mfma_f32_16x16x32_bf16 v[24:27], v[164:167], v[128:131], v[24:27]
    ds_read_b128 v[180:183], v5 offset:17408
    v_mfma_f32_16x16x32_bf16 v[28:31], v[168:171], v[128:131], v[28:31]
    ds_read_b128 v[184:187], v5 offset:18432
    v_mfma_f32_16x16x32_bf16 v[32:35], v[172:175], v[128:131], v[32:35]
    ds_read_b128 v[188:191], v5 offset:19456
    v_mfma_f32_16x16x32_bf16 v[36:39], v[156:159], v[132:135], v[36:39]
    ds_read_b128 v[192:195], v5 offset:20480
    v_mfma_f32_16x16x32_bf16 v[40:43], v[160:163], v[132:135], v[40:43]
    buffer_load_dwordx4 v[112:115], v8, s[48:51], s92 offen offset:0 sc1
    v_mfma_f32_16x16x32_bf16 v[44:47], v[164:167], v[132:135], v[44:47]
    buffer_load_dwordx4 v[116:119], v8, s[48:51], s92 offen offset:1024 sc1
    v_mfma_f32_16x16x32_bf16 v[48:51], v[168:171], v[132:135], v[48:51]
    buffer_load_dwordx4 v[120:123], v8, s[48:51], s92 offen offset:2048 sc1
    v_mfma_f32_16x16x32_bf16 v[52:55], v[172:175], v[132:135], v[52:55]
    buffer_load_dwordx4 v[124:127], v8, s[48:51], s92 offen offset:3072 sc1
    s_add_u32 s92, s92, 4096
    s_add_u32 s85, s85, 1
    s_cmp_eq_u32 s85, 12
    s_cselect_b32 s8, 49152, 0
    s_cselect_b32 s85, 0, s85
    s_sub_u32 s92, s92, s8
    v_mfma_f32_16x16x32_bf16 v[56:59], v[156:159], v[136:139], v[56:59]
    buffer_load_dwordx4 v[236:239], v8, s[48:51], s92 offen offset:0 sc1
    v_mfma_f32_16x16x32_bf16 v[60:63], v[160:163], v[136:139], v[60:63]
    buffer_load_dwordx4 v[240:243], v8, s[48:51], s92 offen offset:1024 sc1
    v_mfma_f32_16x16x32_bf16 v[64:67], v[164:167], v[136:139], v[64:67]
    buffer_load_dwordx4 v[244:247], v8, s[48:51], s92 offen offset:2048 sc1
    v_mfma_f32_16x16x32_bf16 v[68:71], v[168:171], v[136:139], v[68:71]
    buffer_load_dwordx4 v[248:251], v8, s[48:51], s92 offen offset:3072 sc1
    s_add_u32 s92, s92, 4096
    s_add_u32 s85, s85, 1
    s_cmp_eq_u32 s85, 12
    s_cselect_b32 s8, 49152, 0
    s_cselect_b32 s85, 0, s85
    s_sub_u32 s92, s92, s8
    v_mfma_f32_16x16x32_bf16 v[72:75], v[172:175], v[136:139], v[72:75]
    v_mfma_f32_16x16x32_bf16 v[76:79], v[156:159], v[140:143], v[76:79]
    v_mfma_f32_16x16x32_bf16 v[80:83], v[160:163], v[140:143], v[80:83]
    v_mfma_f32_16x16x32_bf16 v[84:87], v[164:167], v[140:143], v[84:87]
    v_mfma_f32_16x16x32_bf16 v[88:91], v[168:171], v[140:143], v[88:91]
    v_mfma_f32_16x16x32_bf16 v[92:95], v[172:175], v[140:143], v[92:95]
    s_waitcnt vmcnt(16) lgkmcnt(0)
    v_mfma_f32_16x16x32_bf16 v[16:19], v[176:179], v[196:199], v[16:19]
    v_mfma_f32_16x16x32_bf16 v[20:23], v[180:183], v[196:199], v[20:23]
    ds_read_b128 v[156:159], v5 offset:36864
    v_mfma_f32_16x16x32_bf16 v[24:27], v[184:187], v[196:199], v[24:27]
    ds_read_b128 v[160:163], v5 offset:37888
    v_mfma_f32_16x16x32_bf16 v[28:31], v[188:191], v[196:199], v[28:31]
    ds_read_b128 v[164:167], v5 offset:38912
    v_mfma_f32_16x16x32_bf16 v[32:35], v[192:195], v[196:199], v[32:35]
    ds_read_b128 v[168:171], v5 offset:39936
    v_mfma_f32_16x16x32_bf16 v[36:39], v[176:179], v[200:203], v[36:39]
    ds_read_b128 v[172:175], v5 offset:40960
    v_mfma_f32_16x16x32_bf16 v[40:43], v[180:183], v[200:203], v[40:43]
    buffer_load_dwordx4 v[128:131], v8, s[48:51], s92 offen offset:0 sc1
    v_mfma_f32_16x16x32_bf16 v[44:47], v[184:187], v[200:203], v[44:47]
    buffer_load_dwordx4 v[132:135], v8, s[48:51], s92 offen offset:1024 sc1
    v_mfma_f32_16x16x32_bf16 v[48:51], v[188:191], v[200:203], v[48:51]
    buffer_load_dwordx4 v[136:139], v8, s[48:51], s92 offen offset:2048 sc1
    v_mfma_f32_16x16x32_bf16 v[52:55], v[192:195], v[200:203], v[52:55]
    buffer_load_dwordx4 v[140:143], v8, s[48:51], s92 offen offset:3072 sc1
    s_add_u32 s92, s92, 4096
    s_add_u32 s85, s85, 1
    s_cmp_eq_u32 s85, 12
    s_cselect_b32 s8, 49152, 0
    s_cselect_b32 s85, 0, s85
    s_sub_u32 s92, s92, s8
    v_mfma_f32_16x16x32_bf16 v[56:59], v[176:179], v[204:207], v[56:59]
    v_mfma_f32_16x16x32_bf16 v[60:63], v[180:183], v[204:207], v[60:63]
    v_mfma_f32_16x16x32_bf16 v[64:67], v[184:187], v[204:207], v[64:67]
    v_mfma_f32_16x16x32_bf16 v[68:71], v[188:191], v[204:207], v[68:71]
    v_mfma_f32_16x16x32_bf16 v[72:75], v[192:195], v[204:207], v[72:75]
    v_mfma_f32_16x16x32_bf16 v[76:79], v[176:179], v[208:211], v[76:79]
    v_mfma_f32_16x16x32_bf16 v[80:83], v[180:183], v[208:211], v[80:83]
    v_mfma_f32_16x16x32_bf16 v[84:87], v[184:187], v[208:211], v[84:87]
    v_mfma_f32_16x16x32_bf16 v[88:91], v[188:191], v[208:211], v[88:91]
    v_mfma_f32_16x16x32_bf16 v[92:95], v[192:195], v[208:211], v[92:95]
    s_waitcnt vmcnt(16) lgkmcnt(0)
    v_mfma_f32_16x16x32_bf16 v[16:19], v[156:159], v[96:99], v[16:19]
    v_mfma_f32_16x16x32_bf16 v[20:23], v[160:163], v[96:99], v[20:23]
    ds_read_b128 v[176:179], v5 offset:57344
    v_mfma_f32_16x16x32_bf16 v[24:27], v[164:167], v[96:99], v[24:27]
    ds_read_b128 v[180:183], v5 offset:58368
    v_mfma_f32_16x16x32_bf16 v[28:31], v[168:171], v[96:99], v[28:31]
    ds_read_b128 v[184:187], v5 offset:59392
    v_mfma_f32_16x16x32_bf16 v[32:35], v[172:175], v[96:99], v[32:35]
    ds_read_b128 v[188:191], v5 offset:60416
    v_mfma_f32_16x16x32_bf16 v[36:39], v[156:159], v[100:103], v[36:39]
    ds_read_b128 v[192:195], v5 offset:61440
    v_mfma_f32_16x16x32_bf16 v[40:43], v[160:163], v[100:103], v[40:43]
    ds_read_b128 v[196:199], v4 offset:0
    v_mfma_f32_16x16x32_bf16 v[44:47], v[164:167], v[100:103], v[44:47]
    ds_read_b128 v[200:203], v4 offset:1024
    v_mfma_f32_16x16x32_bf16 v[48:51], v[168:171], v[100:103], v[48:51]
    ds_read_b128 v[204:207], v4 offset:2048
    v_mfma_f32_16x16x32_bf16 v[52:55], v[172:175], v[100:103], v[52:55]
    ds_read_b128 v[208:211], v4 offset:3072
    v_mfma_f32_16x16x32_bf16 v[56:59], v[156:159], v[104:107], v[56:59]
    ds_read_b128 v[212:215], v4 offset:4096
    v_mfma_f32_16x16x32_bf16 v[60:63], v[160:163], v[104:107], v[60:63]
    v_mfma_f32_16x16x32_bf16 v[64:67], v[164:167], v[104:107], v[64:67]
    v_mfma_f32_16x16x32_bf16 v[68:71], v[168:171], v[104:107], v[68:71]
    v_mfma_f32_16x16x32_bf16 v[72:75], v[172:175], v[104:107], v[72:75]
    v_mfma_f32_16x16x32_bf16 v[76:79], v[156:159], v[108:111], v[76:79]
    v_mfma_f32_16x16x32_bf16 v[80:83], v[160:163], v[108:111], v[80:83]
    v_mfma_f32_16x16x32_bf16 v[84:87], v[164:167], v[108:111], v[84:87]
    v_mfma_f32_16x16x32_bf16 v[88:91], v[168:171], v[108:111], v[88:91]
    v_mfma_f32_16x16x32_bf16 v[92:95], v[172:175], v[108:111], v[92:95]
    v_mov_b32 v14, 163380
    ds_write_b32 v14, v11
    s_waitcnt vmcnt(12) lgkmcnt(5)
    v_mfma_f32_16x16x32_bf16 v[16:19], v[176:179], v[216:219], v[16:19]
    v_mfma_f32_16x16x32_bf16 v[20:23], v[180:183], v[216:219], v[20:23]
    ds_read_b128 v[156:159], v4 offset:20480
    v_mfma_f32_16x16x32_bf16 v[24:27], v[184:187], v[216:219], v[24:27]
    ds_read_b128 v[160:163], v4 offset:21504
    v_mfma_f32_16x16x32_bf16 v[28:31], v[188:191], v[216:219], v[28:31]
    ds_read_b128 v[164:167], v4 offset:22528
    v_mfma_f32_16x16x32_bf16 v[32:35], v[192:195], v[216:219], v[32:35]
    ds_read_b128 v[168:171], v4 offset:23552
    v_mfma_f32_16x16x32_bf16 v[36:39], v[176:179], v[220:223], v[36:39]
    ds_read_b128 v[172:175], v4 offset:24576
    v_mfma_f32_16x16x32_bf16 v[40:43], v[180:183], v[220:223], v[40:43]
    v_mfma_f32_16x16x32_bf16 v[44:47], v[184:187], v[220:223], v[44:47]
    v_mfma_f32_16x16x32_bf16 v[48:51], v[188:191], v[220:223], v[48:51]
    v_mfma_f32_16x16x32_bf16 v[52:55], v[192:195], v[220:223], v[52:55]
    v_mfma_f32_16x16x32_bf16 v[56:59], v[176:179], v[224:227], v[56:59]
    v_mfma_f32_16x16x32_bf16 v[60:63], v[180:183], v[224:227], v[60:63]
    v_mfma_f32_16x16x32_bf16 v[64:67], v[184:187], v[224:227], v[64:67]
    v_mfma_f32_16x16x32_bf16 v[68:71], v[188:191], v[224:227], v[68:71]
    v_mfma_f32_16x16x32_bf16 v[72:75], v[192:195], v[224:227], v[72:75]
    v_mfma_f32_16x16x32_bf16 v[76:79], v[176:179], v[228:231], v[76:79]
    v_mfma_f32_16x16x32_bf16 v[80:83], v[180:183], v[228:231], v[80:83]
    v_mfma_f32_16x16x32_bf16 v[84:87], v[184:187], v[228:231], v[84:87]
    v_mfma_f32_16x16x32_bf16 v[88:91], v[188:191], v[228:231], v[88:91]
    v_mfma_f32_16x16x32_bf16 v[92:95], v[192:195], v[228:231], v[92:95]
    s_waitcnt vmcnt(8) lgkmcnt(5)
    v_mfma_f32_16x16x32_bf16 v[16:19], v[196:199], v[112:115], v[16:19]
    ds_read_b128 v[216:219], v4 offset:40960
    ds_read_b128 v[220:223], v4 offset:41984
    ds_read_b128 v[224:227], v4 offset:43008
    ds_read_b128 v[228:231], v4 offset:44032
    ds_read_b128 v[232:235], v4 offset:45056
    v_mfma_f32_16x16x32_bf16 v[20:23], v[200:203], v[112:115], v[20:23]
    v_mfma_f32_16x16x32_bf16 v[24:27], v[204:207], v[112:115], v[24:27]
    v_mfma_f32_16x16x32_bf16 v[28:31], v[208:211], v[112:115], v[28:31]
    v_mfma_f32_16x16x32_bf16 v[32:35], v[212:215], v[112:115], v[32:35]
    s_waitcnt vmcnt(4) lgkmcnt(5)
    v_mfma_f32_16x16x32_bf16 v[16:19], v[156:159], v[236:239], v[16:19]
    v_mfma_f32_16x16x32_bf16 v[20:23], v[160:163], v[236:239], v[20:23]
    v_mfma_f32_16x16x32_bf16 v[24:27], v[164:167], v[236:239], v[24:27]
    v_mfma_f32_16x16x32_bf16 v[28:31], v[168:171], v[236:239], v[28:31]
    v_mfma_f32_16x16x32_bf16 v[32:35], v[172:175], v[236:239], v[32:35]
    s_waitcnt vmcnt(0) lgkmcnt(0)
    v_mfma_f32_16x16x32_bf16 v[16:19], v[216:219], v[128:131], v[16:19]
    v_mfma_f32_16x16x32_bf16 v[20:23], v[220:223], v[128:131], v[20:23]
    v_mfma_f32_16x16x32_bf16 v[24:27], v[224:227], v[128:131], v[24:27]
    v_mfma_f32_16x16x32_bf16 v[28:31], v[228:231], v[128:131], v[28:31]
    v_mfma_f32_16x16x32_bf16 v[32:35], v[232:235], v[128:131], v[32:35]
    v_mfma_f32_16x16x32_bf16 v[36:39], v[196:199], v[116:119], v[36:39]
    v_mfma_f32_16x16x32_bf16 v[40:43], v[200:203], v[116:119], v[40:43]
    v_mfma_f32_16x16x32_bf16 v[44:47], v[204:207], v[116:119], v[44:47]
    v_mfma_f32_16x16x32_bf16 v[48:51], v[208:211], v[116:119], v[48:51]
    v_mfma_f32_16x16x32_bf16 v[52:55], v[212:215], v[116:119], v[52:55]
    v_mfma_f32_16x16x32_bf16 v[36:39], v[156:159], v[240:243], v[36:39]
    v_mfma_f32_16x16x32_bf16 v[40:43], v[160:163], v[240:243], v[40:43]
    v_mfma_f32_16x16x32_bf16 v[44:47], v[164:167], v[240:243], v[44:47]
    ds_write_b128 v4, v[16:19] offset:61440
    v_mfma_f32_16x16x32_bf16 v[48:51], v[168:171], v[240:243], v[48:51]
    ds_write_b128 v4, v[20:23] offset:62464
    v_mfma_f32_16x16x32_bf16 v[52:55], v[172:175], v[240:243], v[52:55]
    ds_write_b128 v4, v[24:27] offset:63488
    v_mfma_f32_16x16x32_bf16 v[36:39], v[216:219], v[132:135], v[36:39]
    ds_write_b128 v4, v[28:31] offset:64512
    v_mfma_f32_16x16x32_bf16 v[40:43], v[220:223], v[132:135], v[40:43]
    ds_write_b128 v5, v[32:35] offset:0
    v_mfma_f32_16x16x32_bf16 v[44:47], v[224:227], v[132:135], v[44:47]
    v_mfma_f32_16x16x32_bf16 v[48:51], v[228:231], v[132:135], v[48:51]
    v_mfma_f32_16x16x32_bf16 v[52:55], v[232:235], v[132:135], v[52:55]
    v_mfma_f32_16x16x32_bf16 v[56:59], v[196:199], v[120:123], v[56:59]
    v_mfma_f32_16x16x32_bf16 v[60:63], v[200:203], v[120:123], v[60:63]
    v_mfma_f32_16x16x32_bf16 v[64:67], v[204:207], v[120:123], v[64:67]
    v_mfma_f32_16x16x32_bf16 v[68:71], v[208:211], v[120:123], v[68:71]
    v_mfma_f32_16x16x32_bf16 v[72:75], v[212:215], v[120:123], v[72:75]
    v_mfma_f32_16x16x32_bf16 v[56:59], v[156:159], v[244:247], v[56:59]
    v_mfma_f32_16x16x32_bf16 v[60:63], v[160:163], v[244:247], v[60:63]
    v_mfma_f32_16x16x32_bf16 v[64:67], v[164:167], v[244:247], v[64:67]
    ds_write_b128 v5, v[36:39] offset:16384
    v_mfma_f32_16x16x32_bf16 v[68:71], v[168:171], v[244:247], v[68:71]
    ds_write_b128 v5, v[40:43] offset:17408
    v_mfma_f32_16x16x32_bf16 v[72:75], v[172:175], v[244:247], v[72:75]
    ds_write_b128 v5, v[44:47] offset:18432
    v_mfma_f32_16x16x32_bf16 v[56:59], v[216:219], v[136:139], v[56:59]
    ds_write_b128 v5, v[48:51] offset:19456
    v_mfma_f32_16x16x32_bf16 v[60:63], v[220:223], v[136:139], v[60:63]
    ds_write_b128 v5, v[52:55] offset:20480
    v_mfma_f32_16x16x32_bf16 v[64:67], v[224:227], v[136:139], v[64:67]
    v_mfma_f32_16x16x32_bf16 v[68:71], v[228:231], v[136:139], v[68:71]
    v_mfma_f32_16x16x32_bf16 v[72:75], v[232:235], v[136:139], v[72:75]
    v_mfma_f32_16x16x32_bf16 v[76:79], v[196:199], v[124:127], v[76:79]
    v_mfma_f32_16x16x32_bf16 v[80:83], v[200:203], v[124:127], v[80:83]
    v_mfma_f32_16x16x32_bf16 v[84:87], v[204:207], v[124:127], v[84:87]
    v_mfma_f32_16x16x32_bf16 v[88:91], v[208:211], v[124:127], v[88:91]
    v_mfma_f32_16x16x32_bf16 v[92:95], v[212:215], v[124:127], v[92:95]
    v_mfma_f32_16x16x32_bf16 v[76:79], v[156:159], v[248:251], v[76:79]
    v_mfma_f32_16x16x32_bf16 v[80:83], v[160:163], v[248:251], v[80:83]
    v_mfma_f32_16x16x32_bf16 v[84:87], v[164:167], v[248:251], v[84:87]
    ds_write_b128 v5, v[56:59] offset:36864
    v_mfma_f32_16x16x32_bf16 v[88:91], v[168:171], v[248:251], v[88:91]
    ds_write_b128 v5, v[60:63] offset:37888
    v_mfma_f32_16x16x32_bf16 v[92:95], v[172:175], v[248:251], v[92:95]
    ds_write_b128 v5, v[64:67] offset:38912
    v_mfma_f32_16x16x32_bf16 v[76:79], v[216:219], v[140:143], v[76:79]
    ds_write_b128 v5, v[68:71] offset:39936
    v_mfma_f32_16x16x32_bf16 v[80:83], v[220:223], v[140:143], v[80:83]
    ds_write_b128 v5, v[72:75] offset:40960
    v_mfma_f32_16x16x32_bf16 v[84:87], v[224:227], v[140:143], v[84:87]
    v_mfma_f32_16x16x32_bf16 v[88:91], v[228:231], v[140:143], v[88:91]
    v_mfma_f32_16x16x32_bf16 v[92:95], v[232:235], v[140:143], v[92:95]
    s_nop 1
    ds_write_b128 v5, v[76:79] offset:57344
    s_nop 0
    ds_write_b128 v5, v[80:83] offset:58368
    s_nop 0
    ds_write_b128 v5, v[84:87] offset:59392
    ds_write_b128 v5, v[88:91] offset:60416
    ds_write_b128 v5, v[92:95] offset:61440
    s_waitcnt lgkmcnt(0)
    s_barrier
    s_endpgm
L_heavy:
    s_lshl_b32 s8, s5, 1
    s_add_u32 s8, s8, s4
    s_lshl_b32 s8, s8, 2
    s_add_u32 s8, s8, s3
    s_lshl_b32 s8, s8, 1
    s_lshl_b32 s9, s6, 7
    s_add_u32 s70, s8, s9
    s_mul_i32 s9, s70, 1280
    v_lshrrev_b32 v3, 5, v0
    v_mul_u32_u24 v3, 1280, v3
    v_and_b32 v4, 31, v0
    v_lshl_add_u32 v5, v4, 4, v3
    v_lshl_add_u32 v6, v4, 3, v3
    s_waitcnt lgkmcnt(0)
    s_mov_b32 s48, s34
    s_mov_b32 s49, s35
    s_mov_b32 s50, 268435456
    s_mov_b32 s51, 0x20000
    s_mov_b32 s36, s16
    s_mov_b32 s37, s17
    s_mov_b32 s38, 2621440
    s_mov_b32 s39, 0x20000
    buffer_load_dword v211, off, s[48:51], 0 sc1
    buffer_load_dwordx4 v[116:119], v5, s[36:39], s9 offen
    buffer_load_dwordx4 v[120:123], v5, s[36:39], s9 offen offset:512
    buffer_load_dwordx2 v[124:125], v6, s[36:39], s9 offen offset:1024
    s_and_b32 s8, s2, 7
    s_lshr_b32 s9, s2, 3
    s_and_b32 s10, s8, 1
    s_lshl_b32 s10, s10, 3
    s_and_b32 s14, s8, 6
    s_lshl_b32 s10, s10, 1
    s_lshl_b32 s14, s14, 1
    s_add_u32 s10, s10, s14
    s_and_b32 s11, s9, 3
    s_add_u32 s78, s10, s11
    s_lshr_b32 s79, s9, 2
    s_mov_b32 s96, 2.0
    s_mov_b32 s97, 2.0
    s_mov_b32 s98, 3216077336
    s_mov_b32 s99, 1060205080
    s_mov_b32 s100, 1069066811
    s_mov_b32 s101, 897988541
    s_mov_b32 s68, 0
    s_mov_b32 s75, 0
    v_mov_b32 v11, 0x3f803f80
    v_lshlrev_b32 v8, 4, v0
    v_add_u32 v9, 4096, v8
    v_lshrrev_b32 v3, 1, v15
    v_xor_b32 v3, v3, v14
    v_lshlrev_b32 v3, 4, v3
    v_lshl_add_u32 v3, v15, 7, v3
    s_lshl_b32 s8, s7, 13
    v_add_u32 v1, s8, v3
    v_xor_b32 v2, 64, v1
    v_lshrrev_b32 v12, 5, v0
    v_lshlrev_b32 v12, 4, v12
    v_and_b32 v3, 1, v14
    v_lshl_add_u32 v12, v3, 2, v12
    v_bfe_u32 v3, v0, 2, 2
    v_add_u32 v12, v12, v3
    v_and_b32 v13, 3, v0
    v_lshlrev_b32 v13, 3, v13
    s_lshr_b32 s9, s2, 1
    s_lshl_b32 s10, s9, 2
    s_add_u32 s10, s10, s3
    s_lshl_b32 s11, s3, 7
    s_add_u32 s11, s11, s9
    s_add_u32 s11, s11, 512
    s_cmp_eq_u32 s4, 0
    s_cselect_b32 s8, s11, s10
    s_cmp_lt_u32 s8, 680
    s_cselect_b32 s83, 1, 0
    s_min_u32 s8, s8, 679
    s_mul_i32 s9, s8, 6554
    s_lshr_b32 s9, s9, 16
    s_mul_i32 s10, s9, 10
    s_sub_u32 s10, s8, s10
    s_mul_i32 s11, s9, 3856
    s_lshr_b32 s11, s11, 16
    s_mul_i32 s12, s11, 17
    s_sub_u32 s12, s9, s12
    s_lshl_b32 s13, s9, 6
    s_lshl_b32 s14, s10, 2
    s_add_u32 s13, s13, s14
    s_add_u32 s86, s13, 24576
    s_lshl_b32 s13, s10, 2
    s_add_u32 s13, s13, 0
    s_mul_i32 s14, s13, 13108
    s_lshr_b32 s14, s14, 16
    s_mul_i32 s15, s14, 5
    s_sub_u32 s13, s13, s15
    s_mul_i32 s14, s14, 68
    s_add_u32 s14, s14, s9
    s_mul_i32 s14, s14, 5
    s_add_u32 s14, s14, s13
    s_lshl_b32 s14, s14, 10
    s_add_u32 s87, s14, 10485760
    s_lshl_b32 s13, s10, 2
    s_add_u32 s13, s13, 1
    s_mul_i32 s14, s13, 13108
    s_lshr_b32 s14, s14, 16
    s_mul_i32 s15, s14, 5
    s_sub_u32 s13, s13, s15
    s_mul_i32 s14, s14, 68
    s_add_u32 s14, s14, s9
    s_mul_i32 s14, s14, 5
    s_add_u32 s14, s14, s13
    s_lshl_b32 s14, s14, 10
    s_add_u32 s88, s14, 10485760
    s_lshl_b32 s13, s10, 2
    s_add_u32 s13, s13, 2
    s_mul_i32 s14, s13, 13108
    s_lshr_b32 s14, s14, 16
    s_mul_i32 s15, s14, 5
    s_sub_u32 s13, s13, s15
    s_mul_i32 s14, s14, 68
    s_add_u32 s14, s14, s9
    s_mul_i32 s14, s14, 5
    s_add_u32 s14, s14, s13
    s_lshl_b32 s14, s14, 10
    s_add_u32 s89, s14, 10485760
    s_lshl_b32 s13, s10, 2
    s_add_u32 s13, s13, 3
    s_mul_i32 s14, s13, 13108
    s_lshr_b32 s14, s14, 16
    s_mul_i32 s15, s14, 5
    s_sub_u32 s13, s13, s15
    s_mul_i32 s14, s14, 68
    s_add_u32 s14, s14, s9
    s_mul_i32 s14, s14, 5
    s_add_u32 s14, s14, s13
    s_lshl_b32 s14, s14, 10
    s_add_u32 s90, s14, 10485760
    s_mul_i32 s13, s11, 384
    s_lshl_b32 s14, s12, 5
    s_add_u32 s15, s14, 64
    s_add_u32 s8, s14, 128
    s_cmp_ge_u32 s12, 4
    s_cselect_b32 s15, s8, s15
    s_sub_u32 s8, s14, 256
    s_cmp_ge_u32 s12, 8
    s_cselect_b32 s15, s8, s15
    s_sub_u32 s8, s14, 128
    s_cmp_ge_u32 s12, 10
    s_cselect_b32 s15, s8, s15
    s_mul_i32 s9, s11, 160
    s_sub_u32 s8, s14, 384
    s_cmp_ge_u32 s12, 12
    s_cselect_b32 s13, s9, s13
    s_cselect_b32 s15, s8, s15
    s_sub_u32 s8, s14, 368
    s_cmp_ge_u32 s12, 14
    s_cselect_b32 s15, s8, s15
    s_cmp_eq_u32 s12, 16
    s_cselect_b32 s15, 64, s15
    s_cselect_b32 s8, 80, 16
    s_add_u32 s13, s13, s15
    s_mul_i32 s84, s13, 1280
    s_lshl_b32 s10, s10, 7
    s_add_u32 s84, s84, s10
    s_mul_i32 s8, s8, 1280
    s_add_u32 s85, s84, s8
    s_mov_b32 s54, 1966080
    s_cmp_ge_u32 s12, 12
    s_cselect_b32 s52, s20, s28
    s_cselect_b32 s53, s21, s29
    s_cselect_b32 s54, 819200, s54
    s_mov_b32 s55, 0x20000
    v_lshrrev_b32 v3, 3, v0
    v_mul_u32_u24 v3, 1280, v3
    v_and_b32 v4, 7, v0
    v_lshl_add_u32 v209, v4, 4, v3
    v_bfe_u32 v3, v0, 2, 2
    v_lshl_add_u32 v3, v14, 2, v3
    v_lshl_add_u32 v3, v3, 7, v13
    s_lshl_b32 s8, s3, 12
    s_add_u32 s8, s8, 143360
    v_add_u32 v210, s8, v3
    v_mov_b32 v3, 0
    v_mov_b32 v4, 163328
    v_lshl_add_u32 v4, v0, 2, v4
    s_mov_b64 exec, 0xefff
    ds_write_b32 v4, v3
    s_mov_b64 exec, -1
    s_lshl_b32 s8, s6, 7
    s_lshl_b32 s9, s3, 5
    s_add_u32 s8, s8, s9
    s_lshl_b32 s8, s8, 3
    s_add_u32 s8, s8, 36864
    v_and_b32 v4, 31, v0
    v_lshl_add_u32 v230, v4, 3, s8
    s_mul_i32 s91, s3, 17
    s_add_u32 s91, s91, 12
    s_lshr_b32 s80, s3, 1
    s_cmp_eq_u32 s4, 0
    s_cbranch_scc0 L_heavy2
    s_mul_i32 s8, s80, 80
    s_add_u32 s8, s8, 16384
    v_mul_u32_u24 v5, 352, v12
    v_add3_u32 v3, v5, v13, s8
    v_cmp_lt_u32 vcc, 8, v13
    v_mov_b32 v5, 64
    v_mov_b32 v6, 160
    v_cndmask_b32 v5, v5, v6, vcc
    v_add_u32 v4, v5, v3
    s_mul_i32 s8, s80, 10
    v_add_u32 v5, s8, v14
    v_mul_u32_u24 v5, 200, v5
    v_mov_b32 v136, 2147418112
    s_cmp_eq_u32 s7, 0
    s_cbranch_scc0 Lkva_58
    s_mov_b64 s[10:11], 0
    v_add_u32 v137, 20, v15
    v_subrev_u32 v138, 8, v15
    v_cmp_le_u32 vcc, 8, v15
    s_nop 1
    v_cndmask_b32 v137, v137, v138, vcc
    s_andn2_b64 s[14:15], vcc, s[10:11]
    v_cmp_gt_u32 vcc, 5, v15
    s_or_b64 s[14:15], s[14:15], vcc
    v_lshl_add_u32 v137, v137, 3, v5
    v_add_u32 v137, 0, v137
    v_cndmask_b32 v201, v136, v137, s[14:15]
    s_mov_b64 s[10:11], 0
    v_add_u32 v137, 8, v15
    v_subrev_u32 v138, 12, v15
    v_cmp_le_u32 vcc, 12, v15
    s_nop 1
    v_cndmask_b32 v137, v137, v138, vcc
    s_xnor_b64 s[14:15], vcc, s[10:11]
    v_lshl_add_u32 v137, v137, 3, v5
    v_add_u32 v137, 0, v137
    v_cndmask_b32 v202, v136, v137, s[14:15]
    v_cmp_le_u32 s[10:11], 1, v14
    v_add_u32 v137, 20, v15
    v_subrev_u32 v138, 8, v15
    v_cmp_le_u32 vcc, 8, v15
    s_nop 1
    v_cndmask_b32 v137, v137, v138, vcc
    s_andn2_b64 s[14:15], vcc, s[10:11]
    v_cmp_gt_u32 vcc, 5, v15
    s_or_b64 s[14:15], s[14:15], vcc
    v_lshl_add_u32 v137, v137, 3, v5
    v_add_u32 v137, 800, v137
    v_cndmask_b32 v203, v136, v137, s[14:15]
    v_cmp_le_u32 s[10:11], 1, v14
    v_add_u32 v137, 8, v15
    v_subrev_u32 v138, 12, v15
    v_cmp_le_u32 vcc, 12, v15
    s_nop 1
    v_cndmask_b32 v137, v137, v138, vcc
    s_xnor_b64 s[14:15], vcc, s[10:11]
    v_lshl_add_u32 v137, v137, 3, v5
    v_add_u32 v137, 800, v137
    v_cndmask_b32 v204, v136, v137, s[14:15]
    s_branch Lkvb_59
Lkva_58:
    v_cmp_le_u32 s[10:11], 1, v14
    v_add_u32 v137, 4, v15
    s_mov_b64 s[14:15], s[10:11]
    v_lshl_add_u32 v137, v137, 3, v5
    v_add_u32 v137, 800, v137
    v_cndmask_b32 v201, v136, v137, s[14:15]
    s_mov_b64 s[10:11], -1
    v_add_u32 v137, 20, v15
    v_subrev_u32 v138, 8, v15
    v_cmp_le_u32 vcc, 8, v15
    s_nop 1
    v_cndmask_b32 v137, v137, v138, vcc
    s_andn2_b64 s[14:15], vcc, s[10:11]
    v_cmp_gt_u32 vcc, 5, v15
    s_or_b64 s[14:15], s[14:15], vcc
    v_cmp_gt_u32 vcc, 2, v14
    s_and_b64 s[14:15], s[14:15], vcc
    v_lshl_add_u32 v137, v137, 3, v5
    v_add_u32 v137, 1600, v137
    v_cndmask_b32 v202, v136, v137, s[14:15]
    s_mov_b64 s[10:11], -1
    v_add_u32 v137, 8, v15
    v_subrev_u32 v138, 12, v15
    v_cmp_le_u32 vcc, 12, v15
    s_nop 1
    v_cndmask_b32 v137, v137, v138, vcc
    s_xnor_b64 s[14:15], vcc, s[10:11]
    v_cmp_gt_u32 vcc, 2, v14
    s_and_b64 s[14:15], s[14:15], vcc
    v_lshl_add_u32 v137, v137, 3, v5
    v_add_u32 v137, 1600, v137
    v_cndmask_b32 v203, v136, v137, s[14:15]
    s_mov_b64 s[10:11], -1
    v_add_u32 v137, 4, v15
    s_mov_b64 s[14:15], s[10:11]
    v_cmp_gt_u32 vcc, 2, v14
    s_and_b64 s[14:15], s[14:15], vcc
    v_lshl_add_u32 v137, v137, 3, v5
    v_add_u32 v137, 1600, v137
    v_cndmask_b32 v204, v136, v137, s[14:15]
Lkvb_59:
    v_mov_b32 v16, 0
    v_mov_b32 v17, 0
    v_mov_b32 v18, 0
    v_mov_b32 v19, 0
    v_mov_b32 v20, 0
    v_mov_b32 v21, 0
    v_mov_b32 v22, 0
    v_mov_b32 v23, 0
    v_mov_b32 v24, 0
    v_mov_b32 v25, 0
    v_mov_b32 v26, 0
    v_mov_b32 v27, 0
    v_mov_b32 v28, 0
    v_mov_b32 v29, 0
    v_mov_b32 v30, 0
    v_mov_b32 v31, 0
    v_mov_b32 v32, 0
    v_mov_b32 v33, 0
    v_mov_b32 v34, 0
    v_mov_b32 v35, 0
    v_mov_b32 v36, 0
    v_mov_b32 v37, 0
    v_mov_b32 v38, 0
    v_mov_b32 v39, 0
    v_mov_b32 v40, 0
    v_mov_b32 v41, 0
    v_mov_b32 v42, 0
    v_mov_b32 v43, 0
    v_mov_b32 v44, 0
    v_mov_b32 v45, 0
    v_mov_b32 v46, 0
    v_mov_b32 v47, 0
    v_mov_b32 v48, 0
    v_mov_b32 v49, 0
    v_mov_b32 v50, 0
    v_mov_b32 v51, 0
    v_mov_b32 v52, 0
    v_mov_b32 v53, 0
    v_mov_b32 v54, 0
    v_mov_b32 v55, 0
    v_mov_b32 v56, 0
    v_mov_b32 v57, 0
    v_mov_b32 v58, 0
    v_mov_b32 v59, 0
    v_mov_b32 v60, 0
    v_mov_b32 v61, 0
    v_mov_b32 v62, 0
    v_mov_b32 v63, 0
    v_mov_b32 v64, 0
    v_mov_b32 v65, 0
    v_mov_b32 v66, 0
    v_mov_b32 v67, 0
    v_mov_b32 v68, 0
    v_mov_b32 v69, 0
    v_mov_b32 v70, 0
    v_mov_b32 v71, 0
    v_mov_b32 v72, 0
    v_mov_b32 v73, 0
    v_mov_b32 v74, 0
    v_mov_b32 v75, 0
    v_mov_b32 v76, 0
    v_mov_b32 v77, 0
    v_mov_b32 v78, 0
    v_mov_b32 v79, 0
    v_mov_b32 v80, 0
    v_mov_b32 v81, 0
    v_mov_b32 v82, 0
    v_mov_b32 v83, 0
    v_mov_b32 v84, 0
    v_mov_b32 v85, 0
    v_mov_b32 v86, 0
    v_mov_b32 v87, 0
    v_mov_b32 v88, 0
    v_mov_b32 v89, 0
    v_mov_b32 v90, 0
    v_mov_b32 v91, 0
    v_mov_b32 v92, 0
    v_mov_b32 v93, 0
    v_mov_b32 v94, 0
    v_mov_b32 v95, 0
    v_mov_b32 v96, 0
    v_mov_b32 v97, 0
    v_mov_b32 v98, 0
    v_mov_b32 v99, 0
    v_mov_b32 v100, 0
    v_mov_b32 v101, 0
    v_mov_b32 v102, 0
    v_mov_b32 v103, 0
    v_mov_b32 v104, 0
    v_mov_b32 v105, 0
    v_mov_b32 v106, 0
    v_mov_b32 v107, 0
    v_mov_b32 v108, 0
    v_mov_b32 v109, 0
    v_mov_b32 v110, 0
    v_mov_b32 v111, 0
    v_mov_b32 v112, 0
    v_mov_b32 v113, 0
    v_mov_b32 v114, 0
    v_mov_b32 v115, 0
    v_mov_b32 v244, 0x3f803f80
    v_mov_b32 v245, 0x3f803f80
    v_mov_b32 v246, 0x3f803f80
    v_mov_b32 v247, 0x3f803f80
    s_mul_i32 s9, s79, 5
    s_lshr_b32 s9, s9, 2
    s_lshl_b32 s9, s9, 2
    s_lshl_b32 s10, s91, 6
    s_add_u32 s9, s9, s10
    s_add_u32 s9, s9, 24576
    v_min_u32 v14, 9, v0
    v_and_b32 v15, 1, v14
    v_lshrrev_b32 v14, 1, v14
    v_lshlrev_b32 v14, 6, v14
    v_lshl_add_u32 v14, v15, 2, v14
    v_add_u32 v12, s9, v14
    v_mov_b32 v126, 0
    v_mov_b32 v127, 0
    s_waitcnt vmcnt(0)
    v_readfirstlane_b32 s8, v211
    s_mul_i32 s8, s8, 0x9E3779B1
    s_add_u32 s77, s8, 0x7F4A7C15
    v_dot2c_f32_bf16 v126, v11, v116
    v_dot2c_f32_bf16 v127, v116, v116
    v_dot2c_f32_bf16 v126, v11, v117
    v_dot2c_f32_bf16 v127, v117, v117
    v_dot2c_f32_bf16 v126, v11, v118
    v_dot2c_f32_bf16 v127, v118, v118
    v_dot2c_f32_bf16 v126, v11, v119
    v_dot2c_f32_bf16 v127, v119, v119
    v_dot2c_f32_bf16 v126, v11, v120
    v_dot2c_f32_bf16 v127, v120, v120
    v_dot2c_f32_bf16 v126, v11, v121
    v_dot2c_f32_bf16 v127, v121, v121
    v_dot2c_f32_bf16 v126, v11, v122
    v_dot2c_f32_bf16 v127, v122, v122
    v_dot2c_f32_bf16 v126, v11, v123
    v_dot2c_f32_bf16 v127, v123, v123
    v_dot2c_f32_bf16 v126, v11, v124
    v_dot2c_f32_bf16 v127, v124, v124
    v_dot2c_f32_bf16 v126, v11, v125
    v_dot2c_f32_bf16 v127, v125, v125
    v_mov_b32 v129, s77
    v_mov_b32 v128, 163376
    ds_write_b32 v128, v129
    v_add_f32_dpp v126, v126, v126 row_ror:8 row_mask:0xf bank_mask:0xf
    v_add_f32_dpp v127, v127, v127 row_ror:8 row_mask:0xf bank_mask:0xf
    s_nop 0
    v_add_f32_dpp v126, v126, v126 row_ror:4 row_mask:0xf bank_mask:0xf
    v_add_f32_dpp v127, v127, v127 row_ror:4 row_mask:0xf bank_mask:0xf
    s_nop 0
    v_add_f32_dpp v126, v126, v126 row_ror:2 row_mask:0xf bank_mask:0xf
    v_add_f32_dpp v127, v127, v127 row_ror:2 row_mask:0xf bank_mask:0xf
    s_nop 0
    v_add_f32_dpp v126, v126, v126 row_ror:1 row_mask:0xf bank_mask:0xf
    v_add_f32_dpp v127, v127, v127 row_ror:1 row_mask:0xf bank_mask:0xf
    v_mov_b32 v128, v126
    v_mov_b32 v129, v127
    s_nop 0
    v_permlane16_swap_b32 v126, v128
    v_permlane16_swap_b32 v127, v129
    v_add_f32 v126, v126, v128
    v_add_f32 v127, v127, v129
    v_mul_f32 v126, 986500301, v126
    v_mul_f32 v127, 986500301, v127
    v_fma_f32 v127, -v126, v126, v127
    v_max_f32 v127, 0, v127
    v_cvt_pk_bf16_f32 v127, v127, v127
    v_and_b32 v127, 0xffff0000, v127
    v_add_f32 v127, 925353388, v127
    v_cvt_pk_bf16_f32 v127, v127, v127
    v_and_b32 v127, 0xffff0000, v127
    v_sqrt_f32 v127, v127
    v_lshrrev_b32 v128, 5, v0
    v_add_u32 v128, s70, v128
    v_lshlrev_b32 v128, 3, v128
    v_cvt_pk_bf16_f32 v126, v126, v127
    v_mov_b32 v127, s77
    s_mov_b32 s8, 36864
    s_mov_b32 exec_lo, 1
    s_mov_b32 exec_hi, 1
    buffer_store_dwordx2 v[126:127], v128, s[48:51], s8 offen sc1
    s_mov_b64 exec, -1
    s_cmp_eq_u32 s3, 3
    s_cbranch_scc0 Lft_60
    s_cmp_lt_u32 s2, 32
    s_cbranch_scc0 Lft_60
    s_mul_i32 s8, s2, 768
    s_and_b32 s9, s2, 7
    s_mul_i32 s9, s9, 768
    v_lshlrev_b32 v232, 6, v0
    v_add_u32 v233, s9, v232
    v_add_u32 v233, 589568, v233
    v_add_u32 v232, s8, v232
    v_add_u32 v232, 655360, v232
    v_add_u32 v234, 163648, v232
    v_cmp_eq_u32 vcc, 3, v0
    s_nop 1
    v_cndmask_b32 v232, v232, v234, vcc
    v_cmp_lt_u32 vcc, 3, v0
    s_nop 1
    v_cndmask_b32 v232, v232, v233, vcc
    s_mov_b64 exec, 0xff
    buffer_load_dword v233, v232, s[48:51], 0 offen sc1
    s_mov_b64 exec, -1
Lft_60:
    s_lshl_b32 s8, s5, 4
    s_add_u32 s8, s8, s6
    s_lshl_b32 s8, s8, 12
    s_lshl_b32 s9, s3, 10
    s_add_u32 s8, s8, s9
    s_add_u32 s8, s8, 65536
    v_lshlrev_b32 v232, 6, v0
    s_mov_b64 exec, 0xffff
    buffer_load_dword v233, v232, s[48:51], s8 offen sc1
    s_mov_b64 exec, -1
    s_waitcnt lgkmcnt(0)
    s_barrier
    ds_read_b128 v[116:119], v1 offset:0
    ds_read_b64_tr_b16 v[148:149], v3 offset:0
    ds_read_b64_tr_b16 v[150:151], v3 offset:2816
    ds_read_b128 v[120:123], v1 offset:2048
    ds_read_b64_tr_b16 v[152:153], v3 offset:32
    ds_read_b64_tr_b16 v[154:155], v3 offset:2848
    ds_read_b128 v[124:127], v1 offset:4096
    ds_read_b128 v[128:131], v1 offset:6144
    ds_read_b64_tr_b16 v[156:157], v4 offset:0
    ds_read_b64_tr_b16 v[158:159], v4 offset:2816
    ds_read_b64_tr_b16 v[160:161], v3 offset:192
    ds_read_b64_tr_b16 v[162:163], v3 offset:3008
    ds_read_b64_tr_b16 v[164:165], v3 offset:224
    ds_read_b64_tr_b16 v[166:167], v3 offset:3040
    s_cmp_eq_u32 s83, 0
    s_cbranch_scc1 Lnorp_61
    s_lshl_b32 s8, s3, 12
    s_add_u32 s8, s8, 143360
    s_add_u32 m0, s8, 0
    s_add_u32 s9, s84, 0
    buffer_load_dwordx4 v209, s[52:55], s9 offen lds
    s_add_u32 m0, s8, 1024
    s_add_u32 s9, s84, 10240
    buffer_load_dwordx4 v209, s[52:55], s9 offen lds
    s_add_u32 m0, s8, 2048
    s_add_u32 s9, s85, 0
    buffer_load_dwordx4 v209, s[52:55], s9 offen lds
    s_add_u32 m0, s8, 3072
    s_add_u32 s9, s85, 10240
    buffer_load_dwordx4 v209, s[52:55], s9 offen lds
Lnorp_61:
    s_mov_b32 s81, 148
L_loop_kv:
    s_waitcnt lgkmcnt(0)
    v_mfma_f32_16x16x32_bf16 v[16:19], v[116:119], v[148:151], v[16:19]
    ds_read_b128 v[132:135], v2 offset:0
    v_mfma_f32_16x16x32_bf16 v[20:23], v[116:119], v[152:155], v[20:23]
    ds_read_b64_tr_b16 v[168:169], v3 offset:11264
    v_mfma_f32_16x16x32_bf16 v[24:27], v[116:119], v[156:159], v[24:27]
    ds_read_b64_tr_b16 v[170:171], v3 offset:14080
    v_mfma_f32_16x16x32_bf16 v[28:31], v[116:119], v[160:163], v[28:31]
    ds_read_b128 v[136:139], v2 offset:2048
    v_mfma_f32_16x16x32_bf16 v[32:35], v[116:119], v[164:167], v[32:35]
    ds_read_b64_tr_b16 v[172:173], v3 offset:11296
    v_mfma_f32_16x16x32_bf16 v[36:39], v[120:123], v[148:151], v[36:39]
    ds_read_b64_tr_b16 v[174:175], v3 offset:14112
    v_mfma_f32_16x16x32_bf16 v[40:43], v[120:123], v[152:155], v[40:43]
    ds_read_b128 v[140:143], v2 offset:4096
    v_mfma_f32_16x16x32_bf16 v[44:47], v[120:123], v[156:159], v[44:47]
    ds_read_b128 v[144:147], v2 offset:6144
    v_mfma_f32_16x16x32_bf16 v[48:51], v[120:123], v[160:163], v[48:51]
    ds_read_b64_tr_b16 v[176:177], v4 offset:11264
    v_mfma_f32_16x16x32_bf16 v[52:55], v[120:123], v[164:167], v[52:55]
    ds_read_b64_tr_b16 v[178:179], v4 offset:14080
    v_mfma_f32_16x16x32_bf16 v[56:59], v[124:127], v[148:151], v[56:59]
    ds_read_b64_tr_b16 v[180:181], v3 offset:11456
    v_mfma_f32_16x16x32_bf16 v[60:63], v[124:127], v[152:155], v[60:63]
    ds_read_b64_tr_b16 v[182:183], v3 offset:14272
    v_mfma_f32_16x16x32_bf16 v[64:67], v[124:127], v[156:159], v[64:67]
    ds_read_b64_tr_b16 v[184:185], v3 offset:11488
    v_mfma_f32_16x16x32_bf16 v[68:71], v[124:127], v[160:163], v[68:71]
    ds_read_b64_tr_b16 v[186:187], v3 offset:14304
    v_mfma_f32_16x16x32_bf16 v[72:75], v[124:127], v[164:167], v[72:75]
    s_add_u32 s75, s75, 1
    s_cmp_eq_u32 s75, 3
    s_cselect_b32 s74, -2, 1
    s_cselect_b32 s75, 0, s75
    s_mul_i32 s74, s74, 47104
    v_mfma_f32_16x16x32_bf16 v[76:79], v[128:131], v[148:151], v[76:79]
    v_add_u32 v1, s74, v1
    v_mfma_f32_16x16x32_bf16 v[80:83], v[128:131], v[152:155], v[80:83]
    v_add_u32 v2, s74, v2
    v_mfma_f32_16x16x32_bf16 v[84:87], v[128:131], v[156:159], v[84:87]
    v_add_u32 v3, s74, v3
    v_mfma_f32_16x16x32_bf16 v[88:91], v[128:131], v[160:163], v[88:91]
    v_add_u32 v4, s74, v4
    v_mfma_f32_16x16x32_bf16 v[92:95], v[128:131], v[164:167], v[92:95]
    s_cmp_eq_u32 s7, 0
    s_cbranch_scc0 Lcs_62
    v_mfma_f32_16x16x32_bf16 v[96:99], v[244:247], v[148:151], v[96:99]
    v_mfma_f32_16x16x32_bf16 v[100:103], v[244:247], v[152:155], v[100:103]
    v_mfma_f32_16x16x32_bf16 v[104:107], v[244:247], v[156:159], v[104:107]
    v_mfma_f32_16x16x32_bf16 v[108:111], v[244:247], v[160:163], v[108:111]
    v_mfma_f32_16x16x32_bf16 v[112:115], v[244:247], v[164:167], v[112:115]
Lcs_62:
    s_waitcnt lgkmcnt(0)
    s_cmp_eq_u32 s68, 9
    s_cbranch_scc1 Lnb_63
    s_barrier
Lnb_63:
    s_bitcmp1_b32 s81, s68
    s_cbranch_scc1 L_x_kv
L_r_kv:
    v_mfma_f32_16x16x32_bf16 v[16:19], v[132:135], v[168:171], v[16:19]
    ds_read_b128 v[116:119], v1 offset:0
    v_mfma_f32_16x16x32_bf16 v[20:23], v[132:135], v[172:175], v[20:23]
    ds_read_b64_tr_b16 v[148:149], v3 offset:0
    v_mfma_f32_16x16x32_bf16 v[24:27], v[132:135], v[176:179], v[24:27]
    ds_read_b64_tr_b16 v[150:151], v3 offset:2816
    v_mfma_f32_16x16x32_bf16 v[28:31], v[132:135], v[180:183], v[28:31]
    ds_read_b128 v[120:123], v1 offset:2048
    v_mfma_f32_16x16x32_bf16 v[32:35], v[132:135], v[184:187], v[32:35]
    ds_read_b64_tr_b16 v[152:153], v3 offset:32
    v_mfma_f32_16x16x32_bf16 v[36:39], v[136:139], v[168:171], v[36:39]
    ds_read_b64_tr_b16 v[154:155], v3 offset:2848
    v_mfma_f32_16x16x32_bf16 v[40:43], v[136:139], v[172:175], v[40:43]
    ds_read_b128 v[124:127], v1 offset:4096
    v_mfma_f32_16x16x32_bf16 v[44:47], v[136:139], v[176:179], v[44:47]
    ds_read_b128 v[128:131], v1 offset:6144
    v_mfma_f32_16x16x32_bf16 v[48:51], v[136:139], v[180:183], v[48:51]
    ds_read_b64_tr_b16 v[156:157], v4 offset:0
    v_mfma_f32_16x16x32_bf16 v[52:55], v[136:139], v[184:187], v[52:55]
    ds_read_b64_tr_b16 v[158:159], v4 offset:2816
    v_mfma_f32_16x16x32_bf16 v[56:59], v[140:143], v[168:171], v[56:59]
    ds_read_b64_tr_b16 v[160:161], v3 offset:192
    v_mfma_f32_16x16x32_bf16 v[60:63], v[140:143], v[172:175], v[60:63]
    ds_read_b64_tr_b16 v[162:163], v3 offset:3008
    v_mfma_f32_16x16x32_bf16 v[64:67], v[140:143], v[176:179], v[64:67]
    ds_read_b64_tr_b16 v[164:165], v3 offset:224
    v_mfma_f32_16x16x32_bf16 v[68:71], v[140:143], v[180:183], v[68:71]
    ds_read_b64_tr_b16 v[166:167], v3 offset:3040
    v_mfma_f32_16x16x32_bf16 v[72:75], v[140:143], v[184:187], v[72:75]
    v_mfma_f32_16x16x32_bf16 v[76:79], v[144:147], v[168:171], v[76:79]
    v_mfma_f32_16x16x32_bf16 v[80:83], v[144:147], v[172:175], v[80:83]
    v_mfma_f32_16x16x32_bf16 v[84:87], v[144:147], v[176:179], v[84:87]
    v_mfma_f32_16x16x32_bf16 v[88:91], v[144:147], v[180:183], v[88:91]
    v_mfma_f32_16x16x32_bf16 v[92:95], v[144:147], v[184:187], v[92:95]
    s_cmp_eq_u32 s7, 1
    s_cbranch_scc0 Lcs_64
    v_mfma_f32_16x16x32_bf16 v[96:99], v[244:247], v[168:171], v[96:99]
    v_mfma_f32_16x16x32_bf16 v[100:103], v[244:247], v[172:175], v[100:103]
    v_mfma_f32_16x16x32_bf16 v[104:107], v[244:247], v[176:179], v[104:107]
    v_mfma_f32_16x16x32_bf16 v[108:111], v[244:247], v[180:183], v[108:111]
    v_mfma_f32_16x16x32_bf16 v[112:115], v[244:247], v[184:187], v[112:115]
Lcs_64:
    s_add_u32 s68, s68, 1
    s_cmp_lt_u32 s68, 10
    s_cbranch_scc1 L_loop_kv
    s_waitcnt lgkmcnt(0)
    s_mul_i32 s8, s3, 320
    s_add_u32 s8, s8, 160768
    v_lshl_add_u32 v14, v0, 2, s8
    s_mov_b64 exec, 0xffff
    ds_write_b32 v14, v96 offset:0
    ds_write_b32 v14, v100 offset:64
    ds_write_b32 v14, v104 offset:128
    ds_write_b32 v14, v108 offset:192
    ds_write_b32 v14, v112 offset:256
    s_mov_b64 exec, -1
    s_mov_b32 s8, 0
    s_branch Lstc_66
Lst_65:
    buffer_load_dwordx2 v[228:229], v230, s[48:51], 0 offen sc1
Lstc_66:
    s_waitcnt vmcnt(0)
    s_add_u32 s8, s8, 1
    s_cmp_ge_u32 s8, 100000
    s_cbranch_scc1 Lstd_67
    v_cmp_ne_u32 vcc, s77, v229
    s_cbranch_vccnz Lst_65
Lstd_67:
    v_and_b32 v117, 0xffff0000, v228
    v_rcp_f32 v117, v117
    v_lshlrev_b32 v116, 16, v228
    v_and_b32 v118, 31, v0
    v_lshrrev_b32 v119, 5, v0
    v_lshl_add_u32 v118, v119, 7, v118
    s_lshl_b32 s8, s3, 7
    s_add_u32 s8, s8, 159744
    v_cmp_gt_u32 vcc, 32, v0
    v_mul_f32 v116, -v116, v117
    v_lshl_add_u32 v118, v118, 2, s8
    v_cndmask_b32 v116, v116, v117, vcc
    ds_write_b32 v118, v116
    s_waitcnt lgkmcnt(0)
    s_barrier
    s_setprio 3
    s_lshl_b32 s8, s7, 8
    s_add_u32 s8, s8, 159744
    v_and_b32 v15, 48, v0
    v_add_u32 v15, s8, v15
    s_xor_b32 s8, s3, 1
    s_mul_i32 s8, s8, 320
    s_add_u32 s8, s8, 160768
    v_and_b32 v14, 15, v0
    v_lshl_add_u32 v14, v14, 2, s8
    ds_read_b32 v148, v14 offset:0
    ds_read_b32 v149, v14 offset:64
    ds_read_b32 v150, v14 offset:128
    ds_read_b32 v151, v14 offset:192
    ds_read_b32 v152, v14 offset:256
    ds_read_b128 v[116:119], v15 offset:0
    ds_read_b128 v[132:135], v15 offset:512
    ds_read_b128 v[120:123], v15 offset:64
    ds_read_b128 v[136:139], v15 offset:576
    ds_read_b128 v[124:127], v15 offset:128
    ds_read_b128 v[140:143], v15 offset:640
    ds_read_b128 v[128:131], v15 offset:192
    ds_read_b128 v[144:147], v15 offset:704
    s_mov_b32 s10, 0x00ff00ff
    s_mov_b32 s11, 0x00ff00ff
    v_mov_b32 v158, s101
    v_mov_b32 v159, s100
    v_mov_b32 v160, 0xff800000
    v_cndmask_b32 v154, 0, v158, s[10:11]
    v_cndmask_b32 v155, v160, v158, s[10:11]
    v_cndmask_b32 v156, 0, v159, s[10:11]
    v_cndmask_b32 v157, v160, 0, s[10:11]
    s_waitcnt lgkmcnt(8)
    v_add_f32 v148, v148, v96
    v_add_f32 v149, v149, v100
    v_add_f32 v150, v150, v104
    v_add_f32 v151, v151, v108
    v_add_f32 v152, v152, v112
    s_waitcnt lgkmcnt(0)
    v_pk_fma_f32 v[160:161], v[132:133], v[148:149], v[158:159] op_sel_hi:[1,0,0]
    v_pk_fma_f32 v[162:163], v[134:135], v[148:149], v[158:159] op_sel_hi:[1,0,0]
    v_pk_fma_f32 v[164:165], v[136:137], v[148:149], v[158:159] op_sel_hi:[1,0,0]
    v_pk_fma_f32 v[166:167], v[138:139], v[148:149], v[158:159] op_sel_hi:[1,0,0]
    v_pk_fma_f32 v[160:161], v[16:17], v[116:117], v[160:161]
    v_pk_fma_f32 v[162:163], v[18:19], v[118:119], v[162:163]
    v_pk_fma_f32 v[164:165], v[36:37], v[120:121], v[164:165]
    v_pk_fma_f32 v[166:167], v[38:39], v[122:123], v[166:167]
    v_pk_mul_f32 v[168:169], v[160:161], s[100:101] op_sel_hi:[1,0]
    v_pk_mul_f32 v[170:171], v[162:163], s[100:101] op_sel_hi:[1,0]
    v_pk_mul_f32 v[172:173], v[164:165], s[100:101] op_sel_hi:[1,0]
    v_pk_mul_f32 v[174:175], v[166:167], s[100:101] op_sel_hi:[1,0]
    v_exp_f32_e64 v168, v168 clamp
    v_exp_f32_e64 v169, v169 clamp
    v_exp_f32_e64 v170, v170 clamp
    v_exp_f32_e64 v171, v171 clamp
    v_exp_f32_e64 v172, v172 clamp
    v_exp_f32_e64 v173, v173 clamp
    v_exp_f32_e64 v174, v174 clamp
    v_exp_f32_e64 v175, v175 clamp
    v_max_f32 v160, s101, v160
    v_max_f32 v161, s101, v161
    v_max_f32 v162, s101, v162
    v_max_f32 v163, s101, v163
    v_max_f32 v164, s101, v164
    v_max_f32 v165, s101, v165
    v_max_f32 v166, s101, v166
    v_max_f32 v167, s101, v167
    v_pk_add_f32 v[160:161], v[160:161], v[168:169]
    v_pk_add_f32 v[162:163], v[162:163], v[170:171]
    v_pk_add_f32 v[164:165], v[164:165], v[172:173]
    v_pk_add_f32 v[166:167], v[166:167], v[174:175]
    v_cvt_pk_bf16_f32 v16, v160, v161
    v_cvt_pk_bf16_f32 v17, v162, v163
    v_cvt_pk_bf16_f32 v18, v164, v165
    v_cvt_pk_bf16_f32 v19, v166, v167
    v_pk_fma_f32 v[160:161], v[132:133], v[148:149], v[158:159] op_sel:[0,1,0] op_sel_hi:[1,1,0]
    v_pk_fma_f32 v[162:163], v[134:135], v[148:149], v[158:159] op_sel:[0,1,0] op_sel_hi:[1,1,0]
    v_pk_fma_f32 v[164:165], v[136:137], v[148:149], v[158:159] op_sel:[0,1,0] op_sel_hi:[1,1,0]
    v_pk_fma_f32 v[166:167], v[138:139], v[148:149], v[158:159] op_sel:[0,1,0] op_sel_hi:[1,1,0]
    v_pk_fma_f32 v[160:161], v[20:21], v[116:117], v[160:161]
    v_pk_fma_f32 v[162:163], v[22:23], v[118:119], v[162:163]
    v_pk_fma_f32 v[164:165], v[40:41], v[120:121], v[164:165]
    v_pk_fma_f32 v[166:167], v[42:43], v[122:123], v[166:167]
    v_pk_mul_f32 v[168:169], v[160:161], s[100:101] op_sel_hi:[1,0]
    v_pk_mul_f32 v[170:171], v[162:163], s[100:101] op_sel_hi:[1,0]
    v_pk_mul_f32 v[172:173], v[164:165], s[100:101] op_sel_hi:[1,0]
    v_pk_mul_f32 v[174:175], v[166:167], s[100:101] op_sel_hi:[1,0]
    v_exp_f32_e64 v168, v168 clamp
    v_exp_f32_e64 v169, v169 clamp
    v_exp_f32_e64 v170, v170 clamp
    v_exp_f32_e64 v171, v171 clamp
    v_exp_f32_e64 v172, v172 clamp
    v_exp_f32_e64 v173, v173 clamp
    v_exp_f32_e64 v174, v174 clamp
    v_exp_f32_e64 v175, v175 clamp
    v_max_f32 v160, s101, v160
    v_max_f32 v161, s101, v161
    v_max_f32 v162, s101, v162
    v_max_f32 v163, s101, v163
    v_max_f32 v164, s101, v164
    v_max_f32 v165, s101, v165
    v_max_f32 v166, s101, v166
    v_max_f32 v167, s101, v167
    v_pk_add_f32 v[160:161], v[160:161], v[168:169]
    v_pk_add_f32 v[162:163], v[162:163], v[170:171]
    v_pk_add_f32 v[164:165], v[164:165], v[172:173]
    v_pk_add_f32 v[166:167], v[166:167], v[174:175]
    v_cvt_pk_bf16_f32 v20, v160, v161
    v_cvt_pk_bf16_f32 v21, v162, v163
    v_cvt_pk_bf16_f32 v22, v164, v165
    v_cvt_pk_bf16_f32 v23, v166, v167
    v_pk_fma_f32 v[160:161], v[132:133], v[150:151], v[154:155] op_sel_hi:[1,0,0]
    v_pk_fma_f32 v[162:163], v[134:135], v[150:151], v[154:155] op_sel_hi:[1,0,0]
    v_pk_fma_f32 v[164:165], v[136:137], v[150:151], v[154:155] op_sel_hi:[1,0,0]
    v_pk_fma_f32 v[166:167], v[138:139], v[150:151], v[154:155] op_sel_hi:[1,0,0]
    v_pk_fma_f32 v[160:161], v[24:25], v[116:117], v[160:161]
    v_pk_fma_f32 v[162:163], v[26:27], v[118:119], v[162:163]
    v_pk_fma_f32 v[164:165], v[44:45], v[120:121], v[164:165]
    v_pk_fma_f32 v[166:167], v[46:47], v[122:123], v[166:167]
    v_pk_fma_f32 v[168:169], v[160:161], v[156:157], v[156:157] op_sel:[0,0,1] op_sel_hi:[1,0,1]
    v_pk_fma_f32 v[170:171], v[162:163], v[156:157], v[156:157] op_sel:[0,0,1] op_sel_hi:[1,0,1]
    v_pk_fma_f32 v[172:173], v[164:165], v[156:157], v[156:157] op_sel:[0,0,1] op_sel_hi:[1,0,1]
    v_pk_fma_f32 v[174:175], v[166:167], v[156:157], v[156:157] op_sel:[0,0,1] op_sel_hi:[1,0,1]
    v_exp_f32_e64 v168, v168 clamp
    v_exp_f32_e64 v169, v169 clamp
    v_exp_f32_e64 v170, v170 clamp
    v_exp_f32_e64 v171, v171 clamp
    v_exp_f32_e64 v172, v172 clamp
    v_exp_f32_e64 v173, v173 clamp
    v_exp_f32_e64 v174, v174 clamp
    v_exp_f32_e64 v175, v175 clamp
    v_max_f32 v160, v155, v160
    v_max_f32 v161, v155, v161
    v_max_f32 v162, v155, v162
    v_max_f32 v163, v155, v163
    v_max_f32 v164, v155, v164
    v_max_f32 v165, v155, v165
    v_max_f32 v166, v155, v166
    v_max_f32 v167, v155, v167
    v_pk_add_f32 v[160:161], v[160:161], v[168:169]
    v_pk_add_f32 v[162:163], v[162:163], v[170:171]
    v_pk_add_f32 v[164:165], v[164:165], v[172:173]
    v_pk_add_f32 v[166:167], v[166:167], v[174:175]
    v_cvt_pk_bf16_f32 v24, v160, v161
    v_cvt_pk_bf16_f32 v25, v162, v163
    v_cvt_pk_bf16_f32 v26, v164, v165
    v_cvt_pk_bf16_f32 v27, v166, v167
    v_cndmask_b32 v44, v24, v11, s[10:11]
    v_cndmask_b32 v45, v25, v11, s[10:11]
    v_cndmask_b32 v46, v26, v11, s[10:11]
    v_cndmask_b32 v47, v27, v11, s[10:11]
    v_pk_mul_f32 v[160:161], v[132:133], v[150:151] op_sel:[0,1]
    v_pk_mul_f32 v[162:163], v[134:135], v[150:151] op_sel:[0,1]
    v_pk_mul_f32 v[164:165], v[136:137], v[150:151] op_sel:[0,1]
    v_mfma_f32_16x16x32_bf16 v[96:99], v[16:19], v[44:47], 0
    v_pk_mul_f32 v[166:167], v[138:139], v[150:151] op_sel:[0,1]
    v_pk_fma_f32 v[160:161], v[28:29], v[116:117], v[160:161]
    v_pk_fma_f32 v[162:163], v[30:31], v[118:119], v[162:163]
    v_mfma_f32_16x16x32_bf16 v[104:107], v[20:23], v[44:47], 0
    v_pk_fma_f32 v[164:165], v[48:49], v[120:121], v[164:165]
    v_pk_fma_f32 v[166:167], v[50:51], v[122:123], v[166:167]
    v_cvt_pk_bf16_f32 v28, v160, v161
    v_mfma_f32_16x16x32_bf16 v[212:215], v[24:27], v[44:47], 0
    v_cvt_pk_bf16_f32 v29, v162, v163
    v_cvt_pk_bf16_f32 v30, v164, v165
    v_cvt_pk_bf16_f32 v31, v166, v167
    v_pk_mul_f32 v[160:161], v[132:133], v[152:153] op_sel_hi:[1,0]
    v_pk_mul_f32 v[162:163], v[134:135], v[152:153] op_sel_hi:[1,0]
    v_pk_mul_f32 v[164:165], v[136:137], v[152:153] op_sel_hi:[1,0]
    v_mfma_f32_16x16x32_bf16 v[100:103], v[16:19], v[28:31], 0
    v_pk_mul_f32 v[166:167], v[138:139], v[152:153] op_sel_hi:[1,0]
    v_pk_fma_f32 v[160:161], v[32:33], v[116:117], v[160:161]
    v_pk_fma_f32 v[162:163], v[34:35], v[118:119], v[162:163]
    v_mfma_f32_16x16x32_bf16 v[108:111], v[20:23], v[28:31], 0
    v_pk_fma_f32 v[164:165], v[52:53], v[120:121], v[164:165]
    v_pk_fma_f32 v[166:167], v[54:55], v[122:123], v[166:167]
    v_cvt_pk_bf16_f32 v32, v160, v161
    v_mfma_f32_16x16x32_bf16 v[216:219], v[24:27], v[28:31], 0
    v_cvt_pk_bf16_f32 v33, v162, v163
    v_cvt_pk_bf16_f32 v34, v164, v165
    v_cvt_pk_bf16_f32 v35, v166, v167
    v_pk_fma_f32 v[160:161], v[140:141], v[148:149], v[158:159] op_sel_hi:[1,0,0]
    v_pk_fma_f32 v[162:163], v[142:143], v[148:149], v[158:159] op_sel_hi:[1,0,0]
    v_pk_fma_f32 v[164:165], v[144:145], v[148:149], v[158:159] op_sel_hi:[1,0,0]
    v_pk_fma_f32 v[166:167], v[146:147], v[148:149], v[158:159] op_sel_hi:[1,0,0]
    v_pk_fma_f32 v[160:161], v[56:57], v[124:125], v[160:161]
    v_pk_fma_f32 v[162:163], v[58:59], v[126:127], v[162:163]
    v_pk_fma_f32 v[164:165], v[76:77], v[128:129], v[164:165]
    v_pk_fma_f32 v[166:167], v[78:79], v[130:131], v[166:167]
    v_pk_mul_f32 v[168:169], v[160:161], s[100:101] op_sel_hi:[1,0]
    v_pk_mul_f32 v[170:171], v[162:163], s[100:101] op_sel_hi:[1,0]
    v_pk_mul_f32 v[172:173], v[164:165], s[100:101] op_sel_hi:[1,0]
    v_pk_mul_f32 v[174:175], v[166:167], s[100:101] op_sel_hi:[1,0]
    v_mfma_f32_16x16x32_bf16 v[112:115], v[20:23], v[32:35], 0
    v_exp_f32_e64 v168, v168 clamp
    v_exp_f32_e64 v169, v169 clamp
    v_exp_f32_e64 v170, v170 clamp
    v_exp_f32_e64 v171, v171 clamp
    v_exp_f32_e64 v172, v172 clamp
    v_exp_f32_e64 v173, v173 clamp
    v_exp_f32_e64 v174, v174 clamp
    v_exp_f32_e64 v175, v175 clamp
    v_max_f32 v160, s101, v160
    v_max_f32 v161, s101, v161
    v_max_f32 v162, s101, v162
    v_max_f32 v163, s101, v163
    v_mfma_f32_16x16x32_bf16 v[220:223], v[24:27], v[32:35], 0
    v_max_f32 v164, s101, v164
    v_max_f32 v165, s101, v165
    v_max_f32 v166, s101, v166
    v_max_f32 v167, s101, v167
    v_pk_add_f32 v[160:161], v[160:161], v[168:169]
    v_pk_add_f32 v[162:163], v[162:163], v[170:171]
    v_pk_add_f32 v[164:165], v[164:165], v[172:173]
    v_pk_add_f32 v[166:167], v[166:167], v[174:175]
    v_cvt_pk_bf16_f32 v56, v160, v161
    v_cvt_pk_bf16_f32 v57, v162, v163
    v_cvt_pk_bf16_f32 v58, v164, v165
    v_cvt_pk_bf16_f32 v59, v166, v167
    v_pk_fma_f32 v[160:161], v[140:141], v[148:149], v[158:159] op_sel:[0,1,0] op_sel_hi:[1,1,0]
    v_pk_fma_f32 v[162:163], v[142:143], v[148:149], v[158:159] op_sel:[0,1,0] op_sel_hi:[1,1,0]
    v_pk_fma_f32 v[164:165], v[144:145], v[148:149], v[158:159] op_sel:[0,1,0] op_sel_hi:[1,1,0]
    v_pk_fma_f32 v[166:167], v[146:147], v[148:149], v[158:159] op_sel:[0,1,0] op_sel_hi:[1,1,0]
    v_pk_fma_f32 v[160:161], v[60:61], v[124:125], v[160:161]
    v_pk_fma_f32 v[162:163], v[62:63], v[126:127], v[162:163]
    v_pk_fma_f32 v[164:165], v[80:81], v[128:129], v[164:165]
    v_pk_fma_f32 v[166:167], v[82:83], v[130:131], v[166:167]
    v_pk_mul_f32 v[168:169], v[160:161], s[100:101] op_sel_hi:[1,0]
    v_pk_mul_f32 v[170:171], v[162:163], s[100:101] op_sel_hi:[1,0]
    v_pk_mul_f32 v[172:173], v[164:165], s[100:101] op_sel_hi:[1,0]
    v_pk_mul_f32 v[174:175], v[166:167], s[100:101] op_sel_hi:[1,0]
    v_exp_f32_e64 v168, v168 clamp
    v_exp_f32_e64 v169, v169 clamp
    v_exp_f32_e64 v170, v170 clamp
    v_exp_f32_e64 v171, v171 clamp
    v_exp_f32_e64 v172, v172 clamp
    v_exp_f32_e64 v173, v173 clamp
    v_exp_f32_e64 v174, v174 clamp
    v_exp_f32_e64 v175, v175 clamp
    v_max_f32 v160, s101, v160
    v_max_f32 v161, s101, v161
    v_max_f32 v162, s101, v162
    v_max_f32 v163, s101, v163
    v_max_f32 v164, s101, v164
    v_max_f32 v165, s101, v165
    v_max_f32 v166, s101, v166
    v_max_f32 v167, s101, v167
    v_pk_add_f32 v[160:161], v[160:161], v[168:169]
    v_pk_add_f32 v[162:163], v[162:163], v[170:171]
    v_pk_add_f32 v[164:165], v[164:165], v[172:173]
    v_pk_add_f32 v[166:167], v[166:167], v[174:175]
    v_cvt_pk_bf16_f32 v60, v160, v161
    v_cvt_pk_bf16_f32 v61, v162, v163
    v_cvt_pk_bf16_f32 v62, v164, v165
    v_cvt_pk_bf16_f32 v63, v166, v167
    v_pk_fma_f32 v[160:161], v[140:141], v[150:151], v[154:155] op_sel_hi:[1,0,0]
    v_pk_fma_f32 v[162:163], v[142:143], v[150:151], v[154:155] op_sel_hi:[1,0,0]
    v_pk_fma_f32 v[164:165], v[144:145], v[150:151], v[154:155] op_sel_hi:[1,0,0]
    v_pk_fma_f32 v[166:167], v[146:147], v[150:151], v[154:155] op_sel_hi:[1,0,0]
    v_pk_fma_f32 v[160:161], v[64:65], v[124:125], v[160:161]
    v_pk_fma_f32 v[162:163], v[66:67], v[126:127], v[162:163]
    v_pk_fma_f32 v[164:165], v[84:85], v[128:129], v[164:165]
    v_pk_fma_f32 v[166:167], v[86:87], v[130:131], v[166:167]
    v_pk_fma_f32 v[168:169], v[160:161], v[156:157], v[156:157] op_sel:[0,0,1] op_sel_hi:[1,0,1]
    v_pk_fma_f32 v[170:171], v[162:163], v[156:157], v[156:157] op_sel:[0,0,1] op_sel_hi:[1,0,1]
    v_pk_fma_f32 v[172:173], v[164:165], v[156:157], v[156:157] op_sel:[0,0,1] op_sel_hi:[1,0,1]
    v_pk_fma_f32 v[174:175], v[166:167], v[156:157], v[156:157] op_sel:[0,0,1] op_sel_hi:[1,0,1]
    v_exp_f32_e64 v168, v168 clamp
    v_exp_f32_e64 v169, v169 clamp
    v_exp_f32_e64 v170, v170 clamp
    v_exp_f32_e64 v171, v171 clamp
    v_exp_f32_e64 v172, v172 clamp
    v_exp_f32_e64 v173, v173 clamp
    v_exp_f32_e64 v174, v174 clamp
    v_exp_f32_e64 v175, v175 clamp
    v_max_f32 v160, v155, v160
    v_max_f32 v161, v155, v161
    v_max_f32 v162, v155, v162
    v_max_f32 v163, v155, v163
    v_max_f32 v164, v155, v164
    v_max_f32 v165, v155, v165
    v_max_f32 v166, v155, v166
    v_max_f32 v167, v155, v167
    v_pk_add_f32 v[160:161], v[160:161], v[168:169]
    v_pk_add_f32 v[162:163], v[162:163], v[170:171]
    v_pk_add_f32 v[164:165], v[164:165], v[172:173]
    v_pk_add_f32 v[166:167], v[166:167], v[174:175]
    v_cvt_pk_bf16_f32 v64, v160, v161
    v_cvt_pk_bf16_f32 v65, v162, v163
    v_cvt_pk_bf16_f32 v66, v164, v165
    v_cvt_pk_bf16_f32 v67, v166, v167
    v_cndmask_b32 v84, v64, v11, s[10:11]
    v_cndmask_b32 v85, v65, v11, s[10:11]
    v_cndmask_b32 v86, v66, v11, s[10:11]
    v_cndmask_b32 v87, v67, v11, s[10:11]
    v_pk_mul_f32 v[160:161], v[140:141], v[150:151] op_sel:[0,1]
    v_pk_mul_f32 v[162:163], v[142:143], v[150:151] op_sel:[0,1]
    v_pk_mul_f32 v[164:165], v[144:145], v[150:151] op_sel:[0,1]
    v_mfma_f32_16x16x32_bf16 v[96:99], v[56:59], v[84:87], v[96:99]
    v_pk_mul_f32 v[166:167], v[146:147], v[150:151] op_sel:[0,1]
    v_pk_fma_f32 v[160:161], v[68:69], v[124:125], v[160:161]
    v_pk_fma_f32 v[162:163], v[70:71], v[126:127], v[162:163]
    v_mfma_f32_16x16x32_bf16 v[104:107], v[60:63], v[84:87], v[104:107]
    v_pk_fma_f32 v[164:165], v[88:89], v[128:129], v[164:165]
    v_pk_fma_f32 v[166:167], v[90:91], v[130:131], v[166:167]
    v_cvt_pk_bf16_f32 v68, v160, v161
    v_mfma_f32_16x16x32_bf16 v[212:215], v[64:67], v[84:87], v[212:215]
    v_cvt_pk_bf16_f32 v69, v162, v163
    v_cvt_pk_bf16_f32 v70, v164, v165
    v_cvt_pk_bf16_f32 v71, v166, v167
    v_pk_mul_f32 v[160:161], v[140:141], v[152:153] op_sel_hi:[1,0]
    v_pk_mul_f32 v[162:163], v[142:143], v[152:153] op_sel_hi:[1,0]
    v_pk_mul_f32 v[164:165], v[144:145], v[152:153] op_sel_hi:[1,0]
    v_mfma_f32_16x16x32_bf16 v[100:103], v[56:59], v[68:71], v[100:103]
    v_pk_mul_f32 v[166:167], v[146:147], v[152:153] op_sel_hi:[1,0]
    v_pk_fma_f32 v[160:161], v[72:73], v[124:125], v[160:161]
    v_pk_fma_f32 v[162:163], v[74:75], v[126:127], v[162:163]
    v_mfma_f32_16x16x32_bf16 v[108:111], v[60:63], v[68:71], v[108:111]
    v_pk_fma_f32 v[164:165], v[92:93], v[128:129], v[164:165]
    v_pk_fma_f32 v[166:167], v[94:95], v[130:131], v[166:167]
    v_cvt_pk_bf16_f32 v72, v160, v161
    v_mfma_f32_16x16x32_bf16 v[216:219], v[64:67], v[68:71], v[216:219]
    v_cvt_pk_bf16_f32 v73, v162, v163
    v_cvt_pk_bf16_f32 v74, v164, v165
    v_cvt_pk_bf16_f32 v75, v166, v167
    s_nop 1
    v_mfma_f32_16x16x32_bf16 v[112:115], v[60:63], v[72:75], v[112:115]
    v_mfma_f32_16x16x32_bf16 v[220:223], v[64:67], v[72:75], v[220:223]
    s_lshl_b32 s8, s3, 12
    s_add_u32 s8, s8, 143360
    v_add_u32 v3, s8, v8
    s_xor_b32 s9, s3, 1
    s_lshl_b32 s9, s9, 12
    s_add_u32 s9, s9, 143360
    v_add_u32 v4, s9, v8
    s_lshl_b32 s9, s3, 2
    s_add_u32 s9, s9, 163328
    v_mov_b32 v5, s9
    v_xor_b32 v6, 4, v5
    s_lshl_b32 s8, s5, 4
    s_add_u32 s8, s8, s6
    s_lshl_b32 s70, s8, 12
    s_add_u32 s70, s70, 65536
    s_mul_i32 s8, s5, 768
    s_lshl_b32 s9, s6, 4
    s_add_u32 s8, s8, s9
    s_lshl_b32 s9, s3, 2
    s_add_u32 s8, s8, s9
    s_add_u32 s71, s8, 589824
    s_cmp_eq_u32 s7, 0
    s_cbranch_scc0 Lkx_68
    ds_write_b128 v3, v[112:115] offset:0
    ds_write_b128 v3, v[212:215] offset:1024
    ds_write_b128 v3, v[216:219] offset:2048
    ds_write_b128 v3, v[220:223] offset:3072
    s_waitcnt lgkmcnt(0)
    ds_write_b32 v5, v11
    s_mov_b32 s8, 0
Ls_kx_70:
    ds_read_b32 v15, v6
    s_add_u32 s8, s8, 1
    s_cmp_ge_u32 s8, 100000
    s_cbranch_scc1 Lsd_kx_71
    s_waitcnt lgkmcnt(0)
    v_cmp_eq_u32 vcc, 0, v15
    s_cbranch_vccnz Ls_kx_70
Lsd_kx_71:
    s_waitcnt lgkmcnt(0)
    ds_read_b128 v[160:163], v4 offset:0
    ds_read_b128 v[164:167], v4 offset:1024
    ds_read_b128 v[168:171], v4 offset:2048
    ds_read_b128 v[172:175], v4 offset:3072
    s_waitcnt lgkmcnt(3)
    v_pk_add_f32 v[160:161], v[160:161], v[96:97]
    v_pk_add_f32 v[162:163], v[162:163], v[98:99]
    v_cvt_pk_bf16_f32 v176, v160, v161
    v_cvt_pk_bf16_f32 v177, v162, v163
    buffer_store_dwordx2 v[176:177], v201, s[48:51], s70 offen sc1
    s_waitcnt lgkmcnt(2)
    v_pk_add_f32 v[164:165], v[164:165], v[100:101]
    v_pk_add_f32 v[166:167], v[166:167], v[102:103]
    v_cvt_pk_bf16_f32 v178, v164, v165
    v_cvt_pk_bf16_f32 v179, v166, v167
    buffer_store_dwordx2 v[178:179], v202, s[48:51], s70 offen sc1
    s_waitcnt lgkmcnt(1)
    v_pk_add_f32 v[168:169], v[168:169], v[104:105]
    v_pk_add_f32 v[170:171], v[170:171], v[106:107]
    v_cvt_pk_bf16_f32 v180, v168, v169
    v_cvt_pk_bf16_f32 v181, v170, v171
    buffer_store_dwordx2 v[180:181], v203, s[48:51], s70 offen sc1
    s_waitcnt lgkmcnt(0)
    v_pk_add_f32 v[172:173], v[172:173], v[108:109]
    v_pk_add_f32 v[174:175], v[174:175], v[110:111]
    v_cvt_pk_bf16_f32 v182, v172, v173
    v_cvt_pk_bf16_f32 v183, v174, v175
    buffer_store_dwordx2 v[182:183], v204, s[48:51], s70 offen sc1
    s_branch Lky_69
Lkx_68:
    ds_write_b128 v3, v[96:99] offset:0
    ds_write_b128 v3, v[100:103] offset:1024
    ds_write_b128 v3, v[104:107] offset:2048
    ds_write_b128 v3, v[108:111] offset:3072
    s_waitcnt lgkmcnt(0)
    ds_write_b32 v5, v11
    s_mov_b32 s8, 0
Ls_kx_72:
    ds_read_b32 v15, v6
    s_add_u32 s8, s8, 1
    s_cmp_ge_u32 s8, 100000
    s_cbranch_scc1 Lsd_kx_73
    s_waitcnt lgkmcnt(0)
    v_cmp_eq_u32 vcc, 0, v15
    s_cbranch_vccnz Ls_kx_72
Lsd_kx_73:
    s_waitcnt lgkmcnt(0)
    ds_read_b128 v[160:163], v4 offset:0
    ds_read_b128 v[164:167], v4 offset:1024
    ds_read_b128 v[168:171], v4 offset:2048
    ds_read_b128 v[172:175], v4 offset:3072
    s_waitcnt lgkmcnt(3)
    v_pk_add_f32 v[160:161], v[160:161], v[112:113]
    v_pk_add_f32 v[162:163], v[162:163], v[114:115]
    v_cvt_pk_bf16_f32 v176, v160, v161
    v_cvt_pk_bf16_f32 v177, v162, v163
    buffer_store_dwordx2 v[176:177], v201, s[48:51], s70 offen sc1
    s_waitcnt lgkmcnt(2)
    v_pk_add_f32 v[164:165], v[164:165], v[212:213]
    v_pk_add_f32 v[166:167], v[166:167], v[214:215]
    v_cvt_pk_bf16_f32 v178, v164, v165
    v_cvt_pk_bf16_f32 v179, v166, v167
    buffer_store_dwordx2 v[178:179], v202, s[48:51], s70 offen sc1
    s_waitcnt lgkmcnt(1)
    v_pk_add_f32 v[168:169], v[168:169], v[216:217]
    v_pk_add_f32 v[170:171], v[170:171], v[218:219]
    v_cvt_pk_bf16_f32 v180, v168, v169
    v_cvt_pk_bf16_f32 v181, v170, v171
    buffer_store_dwordx2 v[180:181], v203, s[48:51], s70 offen sc1
    s_waitcnt lgkmcnt(0)
    v_pk_add_f32 v[172:173], v[172:173], v[220:221]
    v_pk_add_f32 v[174:175], v[174:175], v[222:223]
    v_cvt_pk_bf16_f32 v182, v172, v173
    v_cvt_pk_bf16_f32 v183, v174, v175
    buffer_store_dwordx2 v[182:183], v204, s[48:51], s70 offen sc1
Lky_69:
    s_waitcnt vmcnt(0)
    v_lshlrev_b32 v14, 2, v0
    v_mov_b32 v15, s77
    s_mov_b64 exec, 1
    buffer_store_dword v15, v14, s[48:51], s71 offen offset:0 sc1
    s_mov_b64 exec, -1
    v_mov_b32 v14, 163352
    v_mov_b32 v15, 1
    s_mov_b64 exec, 1
    ds_add_u32 v14, v15
    s_mov_b64 exec, -1
    s_setprio 0
    s_lshl_b32 s9, s4, 1
    s_sub_u32 s9, 8, s9
    v_mov_b32 v14, 163352
    s_mov_b32 s8, 0
Ls_pub_74:
    ds_read_b32 v15, v14
    s_add_u32 s8, s8, 1
    s_cmp_ge_u32 s8, 100000
    s_cbranch_scc1 Lsd_pub_75
    s_waitcnt lgkmcnt(0)
    v_cmp_gt_u32 vcc, s9, v15
    s_cbranch_vccnz Ls_pub_74
Lsd_pub_75:
    s_waitcnt lgkmcnt(0)
    s_mov_b32 s8, 0
    s_branch Lchk_rpl_77
Lpoll_rpl_76:
    buffer_load_dword v13, v12, s[48:51], 0 offen sc1
    s_waitcnt vmcnt(0)
Lchk_rpl_77:
    s_add_u32 s8, s8, 1
    s_cmp_ge_u32 s8, 100000
    s_cbranch_scc1 Ldone_rpl_78
    v_cmp_ne_u32 vcc, s77, v13
    s_cbranch_vccnz Lpoll_rpl_76
Ldone_rpl_78:
    s_mul_i32 s8, s79, 68
    s_add_u32 s8, s8, s91
    s_mul_i32 s8, s8, 5120
    s_add_u32 s83, s8, 10485760
    buffer_load_dwordx4 v[156:159], v8, s[48:51], s83 offen offset:0 sc1
    buffer_load_dwordx4 v[160:163], v8, s[48:51], s83 offen offset:1024 sc1
    buffer_load_dwordx4 v[164:167], v8, s[48:51], s83 offen offset:2048 sc1
    buffer_load_dwordx4 v[168:171], v8, s[48:51], s83 offen offset:3072 sc1
    buffer_load_dwordx4 v[172:175], v9, s[48:51], s83 offen offset:0 sc1
    s_add_u32 s83, s83, 5120
    buffer_load_dwordx4 v[176:179], v8, s[48:51], s83 offen offset:0 sc1
    buffer_load_dwordx4 v[180:183], v8, s[48:51], s83 offen offset:1024 sc1
    buffer_load_dwordx4 v[184:187], v8, s[48:51], s83 offen offset:2048 sc1
    buffer_load_dwordx4 v[188:191], v8, s[48:51], s83 offen offset:3072 sc1
    buffer_load_dwordx4 v[192:195], v9, s[48:51], s83 offen offset:0 sc1
    s_add_u32 s83, s83, 5120
    buffer_load_dwordx4 v[196:199], v8, s[48:51], s83 offen offset:0 sc1
    buffer_load_dwordx4 v[200:203], v8, s[48:51], s83 offen offset:1024 sc1
    buffer_load_dwordx4 v[204:207], v8, s[48:51], s83 offen offset:2048 sc1
    buffer_load_dwordx4 v[208:211], v8, s[48:51], s83 offen offset:3072 sc1
    buffer_load_dwordx4 v[212:215], v9, s[48:51], s83 offen offset:0 sc1
    s_add_u32 s83, s83, 5120
    buffer_load_dwordx4 v[216:219], v8, s[48:51], s83 offen offset:0 sc1
    buffer_load_dwordx4 v[220:223], v8, s[48:51], s83 offen offset:1024 sc1
    buffer_load_dwordx4 v[224:227], v8, s[48:51], s83 offen offset:2048 sc1
    buffer_load_dwordx4 v[228:231], v8, s[48:51], s83 offen offset:3072 sc1
    buffer_load_dwordx4 v[232:235], v9, s[48:51], s83 offen offset:0 sc1
    s_add_u32 s83, s83, 5120
    buffer_load_dwordx4 v[236:239], v8, s[48:51], s83 offen offset:0 sc1
    buffer_load_dwordx4 v[240:243], v8, s[48:51], s83 offen offset:1024 sc1
    buffer_load_dwordx4 v[244:247], v8, s[48:51], s83 offen offset:2048 sc1
    buffer_load_dwordx4 v[248:251], v8, s[48:51], s83 offen offset:3072 sc1
    buffer_load_dwordx4 v[252:255], v9, s[48:51], s83 offen offset:0 sc1
    s_branch L_p2late
L_x_kv:
    s_cmp_eq_u32 s68, 7
    s_cbranch_scc0 Lj3_81
    buffer_load_dwordx2 v[228:229], v230, s[48:51], 0 offen sc1
    buffer_load_dword v13, v12, s[48:51], 0 offen sc1
    s_branch L_r_kv
Lj3_81:
    s_cmp_eq_u32 s83, 0
    s_cbranch_scc1 L_r_kv
    s_cmp_eq_u32 s68, 2
    s_waitcnt vmcnt(0)
    s_cbranch_scc0 Lj2_80
    ds_read_b64_tr_b16 v[212:213], v210 offset:0
    ds_read_b64_tr_b16 v[214:215], v210 offset:2048
    ds_read_b64_tr_b16 v[216:217], v210 offset:32
    ds_read_b64_tr_b16 v[218:219], v210 offset:2080
    ds_read_b64_tr_b16 v[220:221], v210 offset:64
    ds_read_b64_tr_b16 v[222:223], v210 offset:2112
    ds_read_b64_tr_b16 v[224:225], v210 offset:96
    ds_read_b64_tr_b16 v[226:227], v210 offset:2144
    s_waitcnt lgkmcnt(6)
    buffer_store_dwordx4 v[212:215], v8, s[48:51], s87 offen sc1
    s_waitcnt lgkmcnt(4)
    buffer_store_dwordx4 v[216:219], v8, s[48:51], s88 offen sc1
    s_waitcnt lgkmcnt(2)
    buffer_store_dwordx4 v[220:223], v8, s[48:51], s89 offen sc1
    s_waitcnt lgkmcnt(0)
    buffer_store_dwordx4 v[224:227], v8, s[48:51], s90 offen sc1
    s_branch L_r_kv
Lj2_80:
    v_lshlrev_b32 v14, 2, v0
    v_mov_b32 v15, s77
    s_mov_b64 exec, 1
    buffer_store_dword v15, v14, s[48:51], s86 offen offset:0 sc1
    s_mov_b64 exec, -1
    s_branch L_r_kv
L_heavy2:
    s_cmp_eq_u32 s80, 0
    s_cbranch_scc0 L_h4
    v_mul_u32_u24 v5, 160, v12
    v_add_u32 v5, v5, v13
    v_add_u32 v3, 16384, v5
    v_mov_b32 v16, 0
    v_mov_b32 v17, 0
    v_mov_b32 v18, 0
    v_mov_b32 v19, 0
    v_mov_b32 v20, 0
    v_mov_b32 v21, 0
    v_mov_b32 v22, 0
    v_mov_b32 v23, 0
    v_mov_b32 v24, 0
    v_mov_b32 v25, 0
    v_mov_b32 v26, 0
    v_mov_b32 v27, 0
    v_mov_b32 v28, 0
    v_mov_b32 v29, 0
    v_mov_b32 v30, 0
    v_mov_b32 v31, 0
    v_mov_b32 v32, 0
    v_mov_b32 v33, 0
    v_mov_b32 v34, 0
    v_mov_b32 v35, 0
    v_mov_b32 v36, 0
    v_mov_b32 v37, 0
    v_mov_b32 v38, 0
    v_mov_b32 v39, 0
    v_mov_b32 v40, 0
    v_mov_b32 v41, 0
    v_mov_b32 v42, 0
    v_mov_b32 v43, 0
    v_mov_b32 v44, 0
    v_mov_b32 v45, 0
    v_mov_b32 v46, 0
    v_mov_b32 v47, 0
    v_mov_b32 v48, 0
    v_mov_b32 v49, 0
    v_mov_b32 v50, 0
    v_mov_b32 v51, 0
    v_mov_b32 v52, 0
    v_mov_b32 v53, 0
    v_mov_b32 v54, 0
    v_mov_b32 v55, 0
    v_mov_b32 v56, 0
    v_mov_b32 v57, 0
    v_mov_b32 v58, 0
    v_mov_b32 v59, 0
    v_mov_b32 v60, 0
    v_mov_b32 v61, 0
    v_mov_b32 v62, 0
    v_mov_b32 v63, 0
    v_mov_b32 v64, 0
    v_mov_b32 v65, 0
    v_mov_b32 v66, 0
    v_mov_b32 v67, 0
    v_mov_b32 v68, 0
    v_mov_b32 v69, 0
    v_mov_b32 v70, 0
    v_mov_b32 v71, 0
    v_mov_b32 v72, 0
    v_mov_b32 v73, 0
    v_mov_b32 v74, 0
    v_mov_b32 v75, 0
    v_mov_b32 v76, 0
    v_mov_b32 v77, 0
    v_mov_b32 v78, 0
    v_mov_b32 v79, 0
    v_mov_b32 v80, 0
    v_mov_b32 v81, 0
    v_mov_b32 v82, 0
    v_mov_b32 v83, 0
    v_mov_b32 v84, 0
    v_mov_b32 v85, 0
    v_mov_b32 v86, 0
    v_mov_b32 v87, 0
    v_mov_b32 v88, 0
    v_mov_b32 v89, 0
    v_mov_b32 v90, 0
    v_mov_b32 v91, 0
    v_mov_b32 v92, 0
    v_mov_b32 v93, 0
    v_mov_b32 v94, 0
    v_mov_b32 v95, 0
    v_mov_b32 v96, 0
    v_mov_b32 v97, 0
    v_mov_b32 v98, 0
    v_mov_b32 v99, 0
    v_mov_b32 v100, 0
    v_mov_b32 v101, 0
    v_mov_b32 v102, 0
    v_mov_b32 v103, 0
    v_mov_b32 v104, 0
    v_mov_b32 v105, 0
    v_mov_b32 v106, 0
    v_mov_b32 v107, 0
    v_mov_b32 v108, 0
    v_mov_b32 v109, 0
    v_mov_b32 v110, 0
    v_mov_b32 v111, 0
    v_mov_b32 v112, 0
    v_mov_b32 v113, 0
    v_mov_b32 v114, 0
    v_mov_b32 v115, 0
    v_mov_b32 v244, 0x3f803f80
    v_mov_b32 v245, 0x3f803f80
    v_mov_b32 v246, 0x3f803f80
    v_mov_b32 v247, 0x3f803f80
    s_mul_i32 s9, s79, 5
    s_lshr_b32 s9, s9, 2
    s_lshl_b32 s9, s9, 2
    s_lshl_b32 s10, s91, 6
    s_add_u32 s9, s9, s10
    s_add_u32 s9, s9, 24576
    v_min_u32 v14, 9, v0
    v_and_b32 v15, 1, v14
    v_lshrrev_b32 v14, 1, v14
    v_lshlrev_b32 v14, 6, v14
    v_lshl_add_u32 v14, v15, 2, v14
    v_add_u32 v12, s9, v14
    v_mov_b32 v126, 0
    v_mov_b32 v127, 0
    s_waitcnt vmcnt(0)
    v_readfirstlane_b32 s8, v211
    s_mul_i32 s8, s8, 0x9E3779B1
    s_add_u32 s77, s8, 0x7F4A7C15
    v_dot2c_f32_bf16 v126, v11, v116
    v_dot2c_f32_bf16 v127, v116, v116
    v_dot2c_f32_bf16 v126, v11, v117
    v_dot2c_f32_bf16 v127, v117, v117
    v_dot2c_f32_bf16 v126, v11, v118
    v_dot2c_f32_bf16 v127, v118, v118
    v_dot2c_f32_bf16 v126, v11, v119
    v_dot2c_f32_bf16 v127, v119, v119
    v_dot2c_f32_bf16 v126, v11, v120
    v_dot2c_f32_bf16 v127, v120, v120
    v_dot2c_f32_bf16 v126, v11, v121
    v_dot2c_f32_bf16 v127, v121, v121
    v_dot2c_f32_bf16 v126, v11, v122
    v_dot2c_f32_bf16 v127, v122, v122
    v_dot2c_f32_bf16 v126, v11, v123
    v_dot2c_f32_bf16 v127, v123, v123
    v_dot2c_f32_bf16 v126, v11, v124
    v_dot2c_f32_bf16 v127, v124, v124
    v_dot2c_f32_bf16 v126, v11, v125
    v_dot2c_f32_bf16 v127, v125, v125
    v_mov_b32 v129, s77
    v_mov_b32 v128, 163376
    ds_write_b32 v128, v129
    v_add_f32_dpp v126, v126, v126 row_ror:8 row_mask:0xf bank_mask:0xf
    v_add_f32_dpp v127, v127, v127 row_ror:8 row_mask:0xf bank_mask:0xf
    s_nop 0
    v_add_f32_dpp v126, v126, v126 row_ror:4 row_mask:0xf bank_mask:0xf
    v_add_f32_dpp v127, v127, v127 row_ror:4 row_mask:0xf bank_mask:0xf
    s_nop 0
    v_add_f32_dpp v126, v126, v126 row_ror:2 row_mask:0xf bank_mask:0xf
    v_add_f32_dpp v127, v127, v127 row_ror:2 row_mask:0xf bank_mask:0xf
    s_nop 0
    v_add_f32_dpp v126, v126, v126 row_ror:1 row_mask:0xf bank_mask:0xf
    v_add_f32_dpp v127, v127, v127 row_ror:1 row_mask:0xf bank_mask:0xf
    v_mov_b32 v128, v126
    v_mov_b32 v129, v127
    s_nop 0
    v_permlane16_swap_b32 v126, v128
    v_permlane16_swap_b32 v127, v129
    v_add_f32 v126, v126, v128
    v_add_f32 v127, v127, v129
    v_mul_f32 v126, 986500301, v126
    v_mul_f32 v127, 986500301, v127
    v_fma_f32 v127, -v126, v126, v127
    v_max_f32 v127, 0, v127
    v_cvt_pk_bf16_f32 v127, v127, v127
    v_and_b32 v127, 0xffff0000, v127
    v_add_f32 v127, 925353388, v127
    v_cvt_pk_bf16_f32 v127, v127, v127
    v_and_b32 v127, 0xffff0000, v127
    v_sqrt_f32 v127, v127
    v_lshrrev_b32 v128, 5, v0
    v_add_u32 v128, s70, v128
    v_lshlrev_b32 v128, 3, v128
    v_cvt_pk_bf16_f32 v126, v126, v127
    v_mov_b32 v127, s77
    s_mov_b32 s8, 36864
    s_mov_b32 exec_lo, 1
    s_mov_b32 exec_hi, 1
    buffer_store_dwordx2 v[126:127], v128, s[48:51], s8 offen sc1
    s_mov_b64 exec, -1
    s_cmp_eq_u32 s3, 3
    s_cbranch_scc0 Lft_82
    s_cmp_lt_u32 s2, 32
    s_cbranch_scc0 Lft_82
    s_mul_i32 s8, s2, 768
    s_and_b32 s9, s2, 7
    s_mul_i32 s9, s9, 768
    v_lshlrev_b32 v232, 6, v0
    v_add_u32 v233, s9, v232
    v_add_u32 v233, 589568, v233
    v_add_u32 v232, s8, v232
    v_add_u32 v232, 655360, v232
    v_add_u32 v234, 163648, v232
    v_cmp_eq_u32 vcc, 3, v0
    s_nop 1
    v_cndmask_b32 v232, v232, v234, vcc
    v_cmp_lt_u32 vcc, 3, v0
    s_nop 1
    v_cndmask_b32 v232, v232, v233, vcc
    s_mov_b64 exec, 0xff
    buffer_load_dword v233, v232, s[48:51], 0 offen sc1
    s_mov_b64 exec, -1
Lft_82:
    s_waitcnt lgkmcnt(0)
    s_barrier
    ds_read_b128 v[116:119], v1 offset:0
    ds_read_b64_tr_b16 v[148:149], v3 offset:0
    ds_read_b64_tr_b16 v[150:151], v3 offset:1280
    ds_read_b128 v[120:123], v1 offset:2048
    ds_read_b64_tr_b16 v[152:153], v3 offset:32
    ds_read_b64_tr_b16 v[154:155], v3 offset:1312
    ds_read_b128 v[124:127], v1 offset:4096
    ds_read_b128 v[128:131], v1 offset:6144
    ds_read_b64_tr_b16 v[156:157], v3 offset:64
    ds_read_b64_tr_b16 v[158:159], v3 offset:1344
    ds_read_b64_tr_b16 v[160:161], v3 offset:96
    ds_read_b64_tr_b16 v[162:163], v3 offset:1376
    ds_read_b64_tr_b16 v[164:165], v3 offset:128
    ds_read_b64_tr_b16 v[166:167], v3 offset:1408
    s_cmp_eq_u32 s83, 0
    s_cbranch_scc1 Lnorp_83
    s_lshl_b32 s8, s3, 12
    s_add_u32 s8, s8, 143360
    s_add_u32 m0, s8, 0
    s_add_u32 s9, s84, 0
    buffer_load_dwordx4 v209, s[52:55], s9 offen lds
    s_add_u32 m0, s8, 1024
    s_add_u32 s9, s84, 10240
    buffer_load_dwordx4 v209, s[52:55], s9 offen lds
    s_add_u32 m0, s8, 2048
    s_add_u32 s9, s85, 0
    buffer_load_dwordx4 v209, s[52:55], s9 offen lds
    s_add_u32 m0, s8, 3072
    s_add_u32 s9, s85, 10240
    buffer_load_dwordx4 v209, s[52:55], s9 offen lds
Lnorp_83:
    s_mov_b32 s81, 148
L_loop_q5:
    s_waitcnt lgkmcnt(0)
    v_mfma_f32_16x16x32_bf16 v[16:19], v[148:151], v[116:119], v[16:19]
    ds_read_b128 v[132:135], v2 offset:0
    v_mfma_f32_16x16x32_bf16 v[20:23], v[152:155], v[116:119], v[20:23]
    ds_read_b64_tr_b16 v[168:169], v3 offset:5120
    v_mfma_f32_16x16x32_bf16 v[24:27], v[156:159], v[116:119], v[24:27]
    ds_read_b64_tr_b16 v[170:171], v3 offset:6400
    v_mfma_f32_16x16x32_bf16 v[28:31], v[160:163], v[116:119], v[28:31]
    ds_read_b128 v[136:139], v2 offset:2048
    v_mfma_f32_16x16x32_bf16 v[32:35], v[164:167], v[116:119], v[32:35]
    ds_read_b64_tr_b16 v[172:173], v3 offset:5152
    v_mfma_f32_16x16x32_bf16 v[36:39], v[148:151], v[120:123], v[36:39]
    ds_read_b64_tr_b16 v[174:175], v3 offset:6432
    v_mfma_f32_16x16x32_bf16 v[40:43], v[152:155], v[120:123], v[40:43]
    ds_read_b128 v[140:143], v2 offset:4096
    v_mfma_f32_16x16x32_bf16 v[44:47], v[156:159], v[120:123], v[44:47]
    ds_read_b128 v[144:147], v2 offset:6144
    v_mfma_f32_16x16x32_bf16 v[48:51], v[160:163], v[120:123], v[48:51]
    ds_read_b64_tr_b16 v[176:177], v3 offset:5184
    v_mfma_f32_16x16x32_bf16 v[52:55], v[164:167], v[120:123], v[52:55]
    ds_read_b64_tr_b16 v[178:179], v3 offset:6464
    v_mfma_f32_16x16x32_bf16 v[56:59], v[148:151], v[124:127], v[56:59]
    ds_read_b64_tr_b16 v[180:181], v3 offset:5216
    v_mfma_f32_16x16x32_bf16 v[60:63], v[152:155], v[124:127], v[60:63]
    ds_read_b64_tr_b16 v[182:183], v3 offset:6496
    v_mfma_f32_16x16x32_bf16 v[64:67], v[156:159], v[124:127], v[64:67]
    ds_read_b64_tr_b16 v[184:185], v3 offset:5248
    v_mfma_f32_16x16x32_bf16 v[68:71], v[160:163], v[124:127], v[68:71]
    ds_read_b64_tr_b16 v[186:187], v3 offset:6528
    v_mfma_f32_16x16x32_bf16 v[72:75], v[164:167], v[124:127], v[72:75]
    s_add_u32 s75, s75, 1
    s_cmp_eq_u32 s75, 3
    s_cselect_b32 s74, -2, 1
    s_cselect_b32 s75, 0, s75
    s_mul_i32 s74, s74, 43008
    v_mfma_f32_16x16x32_bf16 v[76:79], v[148:151], v[128:131], v[76:79]
    v_add_u32 v1, s74, v1
    v_mfma_f32_16x16x32_bf16 v[80:83], v[152:155], v[128:131], v[80:83]
    v_add_u32 v2, s74, v2
    v_mfma_f32_16x16x32_bf16 v[84:87], v[156:159], v[128:131], v[84:87]
    v_add_u32 v3, s74, v3
    v_mfma_f32_16x16x32_bf16 v[88:91], v[160:163], v[128:131], v[88:91]
    v_mfma_f32_16x16x32_bf16 v[92:95], v[164:167], v[128:131], v[92:95]
    s_cmp_eq_u32 s7, 0
    s_cbranch_scc0 Lcs_84
    v_mfma_f32_16x16x32_bf16 v[96:99], v[148:151], v[244:247], v[96:99]
    v_mfma_f32_16x16x32_bf16 v[100:103], v[152:155], v[244:247], v[100:103]
    v_mfma_f32_16x16x32_bf16 v[104:107], v[156:159], v[244:247], v[104:107]
    v_mfma_f32_16x16x32_bf16 v[108:111], v[160:163], v[244:247], v[108:111]
    v_mfma_f32_16x16x32_bf16 v[112:115], v[164:167], v[244:247], v[112:115]
Lcs_84:
    s_waitcnt lgkmcnt(0)
    s_cmp_eq_u32 s68, 9
    s_cbranch_scc1 Lnb_85
    s_barrier
Lnb_85:
    s_bitcmp1_b32 s81, s68
    s_cbranch_scc1 L_x_q5
L_r_q5:
    v_mfma_f32_16x16x32_bf16 v[16:19], v[168:171], v[132:135], v[16:19]
    ds_read_b128 v[116:119], v1 offset:0
    v_mfma_f32_16x16x32_bf16 v[20:23], v[172:175], v[132:135], v[20:23]
    ds_read_b64_tr_b16 v[148:149], v3 offset:0
    v_mfma_f32_16x16x32_bf16 v[24:27], v[176:179], v[132:135], v[24:27]
    ds_read_b64_tr_b16 v[150:151], v3 offset:1280
    v_mfma_f32_16x16x32_bf16 v[28:31], v[180:183], v[132:135], v[28:31]
    ds_read_b128 v[120:123], v1 offset:2048
    v_mfma_f32_16x16x32_bf16 v[32:35], v[184:187], v[132:135], v[32:35]
    ds_read_b64_tr_b16 v[152:153], v3 offset:32
    v_mfma_f32_16x16x32_bf16 v[36:39], v[168:171], v[136:139], v[36:39]
    ds_read_b64_tr_b16 v[154:155], v3 offset:1312
    v_mfma_f32_16x16x32_bf16 v[40:43], v[172:175], v[136:139], v[40:43]
    ds_read_b128 v[124:127], v1 offset:4096
    v_mfma_f32_16x16x32_bf16 v[44:47], v[176:179], v[136:139], v[44:47]
    ds_read_b128 v[128:131], v1 offset:6144
    v_mfma_f32_16x16x32_bf16 v[48:51], v[180:183], v[136:139], v[48:51]
    ds_read_b64_tr_b16 v[156:157], v3 offset:64
    v_mfma_f32_16x16x32_bf16 v[52:55], v[184:187], v[136:139], v[52:55]
    ds_read_b64_tr_b16 v[158:159], v3 offset:1344
    v_mfma_f32_16x16x32_bf16 v[56:59], v[168:171], v[140:143], v[56:59]
    ds_read_b64_tr_b16 v[160:161], v3 offset:96
    v_mfma_f32_16x16x32_bf16 v[60:63], v[172:175], v[140:143], v[60:63]
    ds_read_b64_tr_b16 v[162:163], v3 offset:1376
    v_mfma_f32_16x16x32_bf16 v[64:67], v[176:179], v[140:143], v[64:67]
    ds_read_b64_tr_b16 v[164:165], v3 offset:128
    v_mfma_f32_16x16x32_bf16 v[68:71], v[180:183], v[140:143], v[68:71]
    ds_read_b64_tr_b16 v[166:167], v3 offset:1408
    v_mfma_f32_16x16x32_bf16 v[72:75], v[184:187], v[140:143], v[72:75]
    v_mfma_f32_16x16x32_bf16 v[76:79], v[168:171], v[144:147], v[76:79]
    v_mfma_f32_16x16x32_bf16 v[80:83], v[172:175], v[144:147], v[80:83]
    v_mfma_f32_16x16x32_bf16 v[84:87], v[176:179], v[144:147], v[84:87]
    v_mfma_f32_16x16x32_bf16 v[88:91], v[180:183], v[144:147], v[88:91]
    v_mfma_f32_16x16x32_bf16 v[92:95], v[184:187], v[144:147], v[92:95]
    s_cmp_eq_u32 s7, 1
    s_cbranch_scc0 Lcs_86
    v_mfma_f32_16x16x32_bf16 v[96:99], v[168:171], v[244:247], v[96:99]
    v_mfma_f32_16x16x32_bf16 v[100:103], v[172:175], v[244:247], v[100:103]
    v_mfma_f32_16x16x32_bf16 v[104:107], v[176:179], v[244:247], v[104:107]
    v_mfma_f32_16x16x32_bf16 v[108:111], v[180:183], v[244:247], v[108:111]
    v_mfma_f32_16x16x32_bf16 v[112:115], v[184:187], v[244:247], v[112:115]
Lcs_86:
    s_add_u32 s68, s68, 1
    s_cmp_lt_u32 s68, 10
    s_cbranch_scc1 L_loop_q5
    s_waitcnt lgkmcnt(0)
    s_mul_i32 s8, s3, 320
    s_add_u32 s8, s8, 160768
    v_add_u32 v14, s8, v0
    s_mov_b32 exec_lo, 0x00010001
    s_mov_b32 exec_hi, 0x00010001
    ds_write_b128 v14, v[96:99] offset:0
    ds_write_b128 v14, v[100:103] offset:64
    ds_write_b128 v14, v[104:107] offset:128
    ds_write_b128 v14, v[108:111] offset:192
    ds_write_b128 v14, v[112:115] offset:256
    s_mov_b64 exec, -1
    s_mov_b32 s8, 0
    s_branch Lstc_88
Lst_87:
    buffer_load_dwordx2 v[228:229], v230, s[48:51], 0 offen sc1
Lstc_88:
    s_waitcnt vmcnt(0)
    s_add_u32 s8, s8, 1
    s_cmp_ge_u32 s8, 100000
    s_cbranch_scc1 Lstd_89
    v_cmp_ne_u32 vcc, s77, v229
    s_cbranch_vccnz Lst_87
Lstd_89:
    v_and_b32 v117, 0xffff0000, v228
    v_rcp_f32 v117, v117
    v_lshlrev_b32 v116, 16, v228
    v_and_b32 v118, 31, v0
    v_lshrrev_b32 v119, 5, v0
    v_lshl_add_u32 v118, v119, 7, v118
    s_lshl_b32 s8, s3, 7
    s_add_u32 s8, s8, 159744
    v_cmp_gt_u32 vcc, 32, v0
    v_mul_f32 v116, -v116, v117
    v_lshl_add_u32 v118, v118, 2, s8
    v_cndmask_b32 v116, v116, v117, vcc
    ds_write_b32 v118, v116
    s_waitcnt lgkmcnt(0)
    s_barrier
    s_xor_b32 s8, s3, 1
    s_mul_i32 s8, s8, 320
    s_add_u32 s8, s8, 160768
    v_and_b32 v14, 48, v0
    v_add_u32 v14, s8, v14
    ds_read_b128 v[116:119], v14 offset:0
    ds_read_b128 v[120:123], v14 offset:64
    ds_read_b128 v[124:127], v14 offset:128
    ds_read_b128 v[128:131], v14 offset:192
    ds_read_b128 v[132:135], v14 offset:256
    s_lshl_b32 s8, s7, 8
    s_add_u32 s8, s8, 159744
    v_and_b32 v15, 15, v0
    v_lshl_add_u32 v15, v15, 2, s8
    ds_read2_b32 v[136:137], v15 offset0:0 offset1:128
    ds_read2_b32 v[138:139], v15 offset0:16 offset1:144
    ds_read2_b32 v[140:141], v15 offset0:32 offset1:160
    ds_read2_b32 v[142:143], v15 offset0:48 offset1:176
    s_lshl_b32 s8, s7, 13
    s_add_u32 s8, s8, 143360
    v_add_u32 v3, s8, v8
    v_mov_b32 v166, 0
    v_mov_b32 v167, 0
    v_mov_b32 v178, 0
    v_mov_b32 v179, 0
    s_waitcnt lgkmcnt(0)
    s_mul_i32 s9, s79, 3
    s_lshr_b32 s9, s9, 1
    s_mul_i32 s10, s79, 68
    s_mul_i32 s11, s3, 34
    s_add_u32 s10, s10, s11
    s_mul_i32 s90, s3, 10240
    s_add_u32 s11, s9, 9
    s_sub_u32 s12, s11, 12
    s_cmp_ge_u32 s11, 12
    s_cselect_b32 s11, s12, s11
    s_add_u32 s11, s11, s10
    s_mul_i32 s11, s11, 5120
    s_add_u32 s84, s11, 10485760
    s_add_u32 s87, s84, 87040
    s_add_u32 s11, s9, 10
    s_sub_u32 s12, s11, 12
    s_cmp_ge_u32 s11, 12
    s_cselect_b32 s11, s12, s11
    s_add_u32 s11, s11, s10
    s_mul_i32 s11, s11, 5120
    s_add_u32 s85, s11, 10485760
    s_add_u32 s88, s85, 87040
    s_add_u32 s11, s9, 11
    s_sub_u32 s12, s11, 12
    s_cmp_ge_u32 s11, 12
    s_cselect_b32 s11, s12, s11
    s_add_u32 s11, s11, s10
    s_mul_i32 s11, s11, 5120
    s_add_u32 s86, s11, 10485760
    s_add_u32 s89, s86, 87040
    v_pk_add_f32 v[96:97], v[96:97], v[116:117]
    v_pk_add_f32 v[98:99], v[98:99], v[118:119]
    v_pk_add_f32 v[100:101], v[100:101], v[120:121]
    v_pk_add_f32 v[102:103], v[102:103], v[122:123]
    v_pk_add_f32 v[104:105], v[104:105], v[124:125]
    v_pk_add_f32 v[106:107], v[106:107], v[126:127]
    v_pk_add_f32 v[108:109], v[108:109], v[128:129]
    v_pk_add_f32 v[110:111], v[110:111], v[130:131]
    v_pk_add_f32 v[112:113], v[112:113], v[132:133]
    v_pk_add_f32 v[114:115], v[114:115], v[134:135]
    v_pk_fma_f32 v[144:145], v[140:141], v[96:97], s[100:101] op_sel:[1,0,1]
    v_pk_fma_f32 v[146:147], v[140:141], v[98:99], s[100:101] op_sel:[1,0,1]
    v_pk_fma_f32 v[148:149], v[140:141], v[100:101], s[100:101] op_sel:[1,0,1]
    v_pk_fma_f32 v[150:151], v[140:141], v[102:103], s[100:101] op_sel:[1,0,1]
    v_pk_fma_f32 v[144:145], v[56:57], v[140:141], v[144:145] op_sel_hi:[1,0,1]
    v_pk_fma_f32 v[146:147], v[58:59], v[140:141], v[146:147] op_sel_hi:[1,0,1]
    v_pk_fma_f32 v[148:149], v[60:61], v[140:141], v[148:149] op_sel_hi:[1,0,1]
    v_pk_fma_f32 v[150:151], v[62:63], v[140:141], v[150:151] op_sel_hi:[1,0,1]
    v_pk_mul_f32 v[116:117], v[144:145], s[100:101] op_sel_hi:[1,0]
    v_pk_mul_f32 v[118:119], v[146:147], s[100:101] op_sel_hi:[1,0]
    v_pk_mul_f32 v[120:121], v[148:149], s[100:101] op_sel_hi:[1,0]
    v_pk_mul_f32 v[122:123], v[150:151], s[100:101] op_sel_hi:[1,0]
    v_exp_f32_e64 v116, v116 clamp
    v_exp_f32_e64 v117, v117 clamp
    v_exp_f32_e64 v118, v118 clamp
    v_exp_f32_e64 v119, v119 clamp
    v_exp_f32_e64 v120, v120 clamp
    v_exp_f32_e64 v121, v121 clamp
    v_exp_f32_e64 v122, v122 clamp
    v_exp_f32_e64 v123, v123 clamp
    v_max_f32 v144, s101, v144
    v_max_f32 v145, s101, v145
    v_max_f32 v146, s101, v146
    v_max_f32 v147, s101, v147
    v_max_f32 v148, s101, v148
    v_max_f32 v149, s101, v149
    v_max_f32 v150, s101, v150
    v_max_f32 v151, s101, v151
    v_pk_add_f32 v[144:145], v[144:145], v[116:117]
    v_pk_add_f32 v[146:147], v[146:147], v[118:119]
    v_pk_add_f32 v[148:149], v[148:149], v[120:121]
    v_pk_add_f32 v[150:151], v[150:151], v[122:123]
    v_cvt_pk_bf16_f32 v156, v144, v145
    v_cvt_pk_bf16_f32 v157, v146, v147
    v_cvt_pk_bf16_f32 v158, v148, v149
    v_cvt_pk_bf16_f32 v159, v150, v151
    v_pk_fma_f32 v[124:125], v[140:141], v[104:105], s[100:101] op_sel:[1,0,1]
    v_pk_fma_f32 v[126:127], v[140:141], v[106:107], s[100:101] op_sel:[1,0,1]
    v_pk_fma_f32 v[128:129], v[140:141], v[108:109], s[100:101] op_sel:[1,0,1]
    v_pk_fma_f32 v[130:131], v[140:141], v[110:111], s[100:101] op_sel:[1,0,1]
    v_pk_fma_f32 v[124:125], v[64:65], v[140:141], v[124:125] op_sel_hi:[1,0,1]
    v_pk_fma_f32 v[126:127], v[66:67], v[140:141], v[126:127] op_sel_hi:[1,0,1]
    v_pk_fma_f32 v[128:129], v[68:69], v[140:141], v[128:129] op_sel_hi:[1,0,1]
    v_pk_fma_f32 v[130:131], v[70:71], v[140:141], v[130:131] op_sel_hi:[1,0,1]
    v_pk_mul_f32 v[180:181], v[124:125], s[100:101] op_sel_hi:[1,0]
    v_pk_mul_f32 v[182:183], v[126:127], s[100:101] op_sel_hi:[1,0]
    v_pk_mul_f32 v[184:185], v[128:129], s[100:101] op_sel_hi:[1,0]
    v_pk_mul_f32 v[186:187], v[130:131], s[100:101] op_sel_hi:[1,0]
    v_exp_f32_e64 v180, v180 clamp
    v_exp_f32_e64 v181, v181 clamp
    v_exp_f32_e64 v182, v182 clamp
    v_exp_f32_e64 v183, v183 clamp
    v_exp_f32_e64 v184, v184 clamp
    v_exp_f32_e64 v185, v185 clamp
    v_exp_f32_e64 v186, v186 clamp
    v_exp_f32_e64 v187, v187 clamp
    v_max_f32 v124, s101, v124
    v_max_f32 v125, s101, v125
    v_max_f32 v126, s101, v126
    v_max_f32 v127, s101, v127
    v_max_f32 v128, s101, v128
    v_max_f32 v129, s101, v129
    v_max_f32 v130, s101, v130
    v_max_f32 v131, s101, v131
    v_pk_add_f32 v[124:125], v[124:125], v[180:181]
    v_pk_add_f32 v[126:127], v[126:127], v[182:183]
    v_pk_add_f32 v[128:129], v[128:129], v[184:185]
    v_pk_add_f32 v[130:131], v[130:131], v[186:187]
    v_cvt_pk_bf16_f32 v160, v124, v125
    v_cvt_pk_bf16_f32 v161, v126, v127
    v_cvt_pk_bf16_f32 v162, v128, v129
    v_cvt_pk_bf16_f32 v163, v130, v131
    v_pk_fma_f32 v[144:145], v[140:141], v[112:113], s[100:101] op_sel:[1,0,1]
    v_pk_fma_f32 v[146:147], v[140:141], v[114:115], s[100:101] op_sel:[1,0,1]
    v_pk_fma_f32 v[144:145], v[72:73], v[140:141], v[144:145] op_sel_hi:[1,0,1]
    v_pk_fma_f32 v[146:147], v[74:75], v[140:141], v[146:147] op_sel_hi:[1,0,1]
    v_pk_mul_f32 v[116:117], v[144:145], s[100:101] op_sel_hi:[1,0]
    v_pk_mul_f32 v[118:119], v[146:147], s[100:101] op_sel_hi:[1,0]
    v_exp_f32_e64 v116, v116 clamp
    v_exp_f32_e64 v117, v117 clamp
    v_exp_f32_e64 v118, v118 clamp
    v_exp_f32_e64 v119, v119 clamp
    v_max_f32 v144, s101, v144
    v_max_f32 v145, s101, v145
    v_max_f32 v146, s101, v146
    v_max_f32 v147, s101, v147
    v_pk_add_f32 v[144:145], v[144:145], v[116:117]
    v_pk_add_f32 v[146:147], v[146:147], v[118:119]
    v_cvt_pk_bf16_f32 v164, v144, v145
    v_cvt_pk_bf16_f32 v165, v146, v147
    ds_write_b128 v3, v[156:159] offset:0
    ds_write_b128 v3, v[160:163] offset:1024
    ds_write_b128 v3, v[164:167] offset:2048
    v_pk_fma_f32 v[144:145], v[142:143], v[96:97], s[100:101] op_sel:[1,0,1]
    v_pk_fma_f32 v[146:147], v[142:143], v[98:99], s[100:101] op_sel:[1,0,1]
    v_pk_fma_f32 v[148:149], v[142:143], v[100:101], s[100:101] op_sel:[1,0,1]
    v_pk_fma_f32 v[150:151], v[142:143], v[102:103], s[100:101] op_sel:[1,0,1]
    v_pk_fma_f32 v[144:145], v[76:77], v[142:143], v[144:145] op_sel_hi:[1,0,1]
    v_pk_fma_f32 v[146:147], v[78:79], v[142:143], v[146:147] op_sel_hi:[1,0,1]
    v_pk_fma_f32 v[148:149], v[80:81], v[142:143], v[148:149] op_sel_hi:[1,0,1]
    v_pk_fma_f32 v[150:151], v[82:83], v[142:143], v[150:151] op_sel_hi:[1,0,1]
    v_pk_mul_f32 v[116:117], v[144:145], s[100:101] op_sel_hi:[1,0]
    v_pk_mul_f32 v[118:119], v[146:147], s[100:101] op_sel_hi:[1,0]
    v_pk_mul_f32 v[120:121], v[148:149], s[100:101] op_sel_hi:[1,0]
    v_pk_mul_f32 v[122:123], v[150:151], s[100:101] op_sel_hi:[1,0]
    v_exp_f32_e64 v116, v116 clamp
    v_exp_f32_e64 v117, v117 clamp
    v_exp_f32_e64 v118, v118 clamp
    v_exp_f32_e64 v119, v119 clamp
    v_exp_f32_e64 v120, v120 clamp
    v_exp_f32_e64 v121, v121 clamp
    v_exp_f32_e64 v122, v122 clamp
    v_exp_f32_e64 v123, v123 clamp
    v_max_f32 v144, s101, v144
    v_max_f32 v145, s101, v145
    v_max_f32 v146, s101, v146
    v_max_f32 v147, s101, v147
    v_max_f32 v148, s101, v148
    v_max_f32 v149, s101, v149
    v_max_f32 v150, s101, v150
    v_max_f32 v151, s101, v151
    v_pk_add_f32 v[144:145], v[144:145], v[116:117]
    v_pk_add_f32 v[146:147], v[146:147], v[118:119]
    v_pk_add_f32 v[148:149], v[148:149], v[120:121]
    v_pk_add_f32 v[150:151], v[150:151], v[122:123]
    v_cvt_pk_bf16_f32 v168, v144, v145
    v_cvt_pk_bf16_f32 v169, v146, v147
    v_cvt_pk_bf16_f32 v170, v148, v149
    v_cvt_pk_bf16_f32 v171, v150, v151
    v_pk_fma_f32 v[124:125], v[142:143], v[104:105], s[100:101] op_sel:[1,0,1]
    v_pk_fma_f32 v[126:127], v[142:143], v[106:107], s[100:101] op_sel:[1,0,1]
    v_pk_fma_f32 v[128:129], v[142:143], v[108:109], s[100:101] op_sel:[1,0,1]
    v_pk_fma_f32 v[130:131], v[142:143], v[110:111], s[100:101] op_sel:[1,0,1]
    v_pk_fma_f32 v[124:125], v[84:85], v[142:143], v[124:125] op_sel_hi:[1,0,1]
    v_pk_fma_f32 v[126:127], v[86:87], v[142:143], v[126:127] op_sel_hi:[1,0,1]
    v_pk_fma_f32 v[128:129], v[88:89], v[142:143], v[128:129] op_sel_hi:[1,0,1]
    v_pk_fma_f32 v[130:131], v[90:91], v[142:143], v[130:131] op_sel_hi:[1,0,1]
    v_pk_mul_f32 v[180:181], v[124:125], s[100:101] op_sel_hi:[1,0]
    v_pk_mul_f32 v[182:183], v[126:127], s[100:101] op_sel_hi:[1,0]
    v_pk_mul_f32 v[184:185], v[128:129], s[100:101] op_sel_hi:[1,0]
    v_pk_mul_f32 v[186:187], v[130:131], s[100:101] op_sel_hi:[1,0]
    v_exp_f32_e64 v180, v180 clamp
    v_exp_f32_e64 v181, v181 clamp
    v_exp_f32_e64 v182, v182 clamp
    v_exp_f32_e64 v183, v183 clamp
    v_exp_f32_e64 v184, v184 clamp
    v_exp_f32_e64 v185, v185 clamp
    v_exp_f32_e64 v186, v186 clamp
    v_exp_f32_e64 v187, v187 clamp
    v_max_f32 v124, s101, v124
    v_max_f32 v125, s101, v125
    v_max_f32 v126, s101, v126
    v_max_f32 v127, s101, v127
    v_max_f32 v128, s101, v128
    v_max_f32 v129, s101, v129
    v_max_f32 v130, s101, v130
    v_max_f32 v131, s101, v131
    v_pk_add_f32 v[124:125], v[124:125], v[180:181]
    v_pk_add_f32 v[126:127], v[126:127], v[182:183]
    v_pk_add_f32 v[128:129], v[128:129], v[184:185]
    v_pk_add_f32 v[130:131], v[130:131], v[186:187]
    v_cvt_pk_bf16_f32 v172, v124, v125
    v_cvt_pk_bf16_f32 v173, v126, v127
    v_cvt_pk_bf16_f32 v174, v128, v129
    v_cvt_pk_bf16_f32 v175, v130, v131
    v_pk_fma_f32 v[144:145], v[142:143], v[112:113], s[100:101] op_sel:[1,0,1]
    v_pk_fma_f32 v[146:147], v[142:143], v[114:115], s[100:101] op_sel:[1,0,1]
    v_pk_fma_f32 v[144:145], v[92:93], v[142:143], v[144:145] op_sel_hi:[1,0,1]
    v_pk_fma_f32 v[146:147], v[94:95], v[142:143], v[146:147] op_sel_hi:[1,0,1]
    v_pk_mul_f32 v[116:117], v[144:145], s[100:101] op_sel_hi:[1,0]
    v_pk_mul_f32 v[118:119], v[146:147], s[100:101] op_sel_hi:[1,0]
    v_exp_f32_e64 v116, v116 clamp
    v_exp_f32_e64 v117, v117 clamp
    v_exp_f32_e64 v118, v118 clamp
    v_exp_f32_e64 v119, v119 clamp
    v_max_f32 v144, s101, v144
    v_max_f32 v145, s101, v145
    v_max_f32 v146, s101, v146
    v_max_f32 v147, s101, v147
    v_pk_add_f32 v[144:145], v[144:145], v[116:117]
    v_pk_add_f32 v[146:147], v[146:147], v[118:119]
    v_cvt_pk_bf16_f32 v176, v144, v145
    v_cvt_pk_bf16_f32 v177, v146, v147
    ds_write_b128 v3, v[168:171] offset:3072
    ds_write_b128 v3, v[172:175] offset:4096
    ds_write_b128 v3, v[176:179] offset:5120
    v_pk_fma_f32 v[144:145], v[136:137], v[96:97], s[100:101] op_sel:[1,0,1]
    v_pk_fma_f32 v[146:147], v[136:137], v[98:99], s[100:101] op_sel:[1,0,1]
    v_pk_fma_f32 v[148:149], v[136:137], v[100:101], s[100:101] op_sel:[1,0,1]
    v_pk_fma_f32 v[150:151], v[136:137], v[102:103], s[100:101] op_sel:[1,0,1]
    v_pk_fma_f32 v[144:145], v[16:17], v[136:137], v[144:145] op_sel_hi:[1,0,1]
    v_pk_fma_f32 v[146:147], v[18:19], v[136:137], v[146:147] op_sel_hi:[1,0,1]
    v_pk_fma_f32 v[148:149], v[20:21], v[136:137], v[148:149] op_sel_hi:[1,0,1]
    v_pk_fma_f32 v[150:151], v[22:23], v[136:137], v[150:151] op_sel_hi:[1,0,1]
    v_pk_mul_f32 v[116:117], v[144:145], s[100:101] op_sel_hi:[1,0]
    s_add_u32 m0, s90, 0
    s_nop 0
    buffer_load_dwordx4 v8, s[48:51], s84 offen offset:0 sc1 lds
    v_pk_mul_f32 v[118:119], v[146:147], s[100:101] op_sel_hi:[1,0]
    v_pk_mul_f32 v[120:121], v[148:149], s[100:101] op_sel_hi:[1,0]
    v_pk_mul_f32 v[122:123], v[150:151], s[100:101] op_sel_hi:[1,0]
    v_exp_f32_e64 v116, v116 clamp
    v_exp_f32_e64 v117, v117 clamp
    buffer_load_dwordx4 v8, s[48:51], s84 offen offset:1024 sc1 lds
    v_exp_f32_e64 v118, v118 clamp
    v_exp_f32_e64 v119, v119 clamp
    v_exp_f32_e64 v120, v120 clamp
    v_exp_f32_e64 v121, v121 clamp
    v_exp_f32_e64 v122, v122 clamp
    buffer_load_dwordx4 v8, s[48:51], s84 offen offset:2048 sc1 lds
    v_exp_f32_e64 v123, v123 clamp
    v_max_f32 v144, s101, v144
    v_max_f32 v145, s101, v145
    v_max_f32 v146, s101, v146
    v_max_f32 v147, s101, v147
    buffer_load_dwordx4 v8, s[48:51], s84 offen offset:3072 sc1 lds
    v_max_f32 v148, s101, v148
    v_max_f32 v149, s101, v149
    v_max_f32 v150, s101, v150
    v_max_f32 v151, s101, v151
    v_pk_add_f32 v[144:145], v[144:145], v[116:117]
    s_add_u32 m0, s90, 4096
    s_nop 0
    buffer_load_dwordx4 v9, s[48:51], s84 offen offset:0 sc1 lds
    v_pk_add_f32 v[146:147], v[146:147], v[118:119]
    v_pk_add_f32 v[148:149], v[148:149], v[120:121]
    v_pk_add_f32 v[150:151], v[150:151], v[122:123]
    v_cvt_pk_bf16_f32 v16, v144, v145
    v_cvt_pk_bf16_f32 v17, v146, v147
    s_add_u32 m0, s90, 5120
    s_nop 0
    buffer_load_dwordx4 v8, s[48:51], s87 offen offset:0 sc1 lds
    v_cvt_pk_bf16_f32 v18, v148, v149
    v_cvt_pk_bf16_f32 v19, v150, v151
    v_pk_fma_f32 v[124:125], v[136:137], v[104:105], s[100:101] op_sel:[1,0,1]
    v_pk_fma_f32 v[126:127], v[136:137], v[106:107], s[100:101] op_sel:[1,0,1]
    v_pk_fma_f32 v[128:129], v[136:137], v[108:109], s[100:101] op_sel:[1,0,1]
    buffer_load_dwordx4 v8, s[48:51], s87 offen offset:1024 sc1 lds
    v_pk_fma_f32 v[130:131], v[136:137], v[110:111], s[100:101] op_sel:[1,0,1]
    v_pk_fma_f32 v[124:125], v[24:25], v[136:137], v[124:125] op_sel_hi:[1,0,1]
    v_pk_fma_f32 v[126:127], v[26:27], v[136:137], v[126:127] op_sel_hi:[1,0,1]
    v_pk_fma_f32 v[128:129], v[28:29], v[136:137], v[128:129] op_sel_hi:[1,0,1]
    v_pk_fma_f32 v[130:131], v[30:31], v[136:137], v[130:131] op_sel_hi:[1,0,1]
    buffer_load_dwordx4 v8, s[48:51], s87 offen offset:2048 sc1 lds
    v_pk_mul_f32 v[180:181], v[124:125], s[100:101] op_sel_hi:[1,0]
    v_pk_mul_f32 v[182:183], v[126:127], s[100:101] op_sel_hi:[1,0]
    v_pk_mul_f32 v[184:185], v[128:129], s[100:101] op_sel_hi:[1,0]
    v_pk_mul_f32 v[186:187], v[130:131], s[100:101] op_sel_hi:[1,0]
    v_exp_f32_e64 v180, v180 clamp
    buffer_load_dwordx4 v8, s[48:51], s87 offen offset:3072 sc1 lds
    v_exp_f32_e64 v181, v181 clamp
    v_exp_f32_e64 v182, v182 clamp
    v_exp_f32_e64 v183, v183 clamp
    v_exp_f32_e64 v184, v184 clamp
    v_exp_f32_e64 v185, v185 clamp
    s_add_u32 m0, s90, 9216
    s_nop 0
    buffer_load_dwordx4 v9, s[48:51], s87 offen offset:0 sc1 lds
    v_exp_f32_e64 v186, v186 clamp
    v_exp_f32_e64 v187, v187 clamp
    v_max_f32 v124, s101, v124
    v_max_f32 v125, s101, v125
    v_max_f32 v126, s101, v126
    s_add_u32 m0, s90, 20480
    s_nop 0
    buffer_load_dwordx4 v8, s[48:51], s85 offen offset:0 sc1 lds
    v_max_f32 v127, s101, v127
    v_max_f32 v128, s101, v128
    v_max_f32 v129, s101, v129
    v_max_f32 v130, s101, v130
    v_max_f32 v131, s101, v131
    buffer_load_dwordx4 v8, s[48:51], s85 offen offset:1024 sc1 lds
    v_pk_add_f32 v[124:125], v[124:125], v[180:181]
    v_pk_add_f32 v[126:127], v[126:127], v[182:183]
    v_pk_add_f32 v[128:129], v[128:129], v[184:185]
    v_pk_add_f32 v[130:131], v[130:131], v[186:187]
    v_cvt_pk_bf16_f32 v20, v124, v125
    buffer_load_dwordx4 v8, s[48:51], s85 offen offset:2048 sc1 lds
    v_cvt_pk_bf16_f32 v21, v126, v127
    v_cvt_pk_bf16_f32 v22, v128, v129
    v_cvt_pk_bf16_f32 v23, v130, v131
    v_pk_fma_f32 v[144:145], v[136:137], v[112:113], s[100:101] op_sel:[1,0,1]
    v_pk_fma_f32 v[146:147], v[136:137], v[114:115], s[100:101] op_sel:[1,0,1]
    buffer_load_dwordx4 v8, s[48:51], s85 offen offset:3072 sc1 lds
    v_pk_fma_f32 v[144:145], v[32:33], v[136:137], v[144:145] op_sel_hi:[1,0,1]
    v_pk_fma_f32 v[146:147], v[34:35], v[136:137], v[146:147] op_sel_hi:[1,0,1]
    v_pk_mul_f32 v[116:117], v[144:145], s[100:101] op_sel_hi:[1,0]
    v_pk_mul_f32 v[118:119], v[146:147], s[100:101] op_sel_hi:[1,0]
    v_exp_f32_e64 v116, v116 clamp
    s_add_u32 m0, s90, 24576
    s_nop 0
    buffer_load_dwordx4 v9, s[48:51], s85 offen offset:0 sc1 lds
    v_exp_f32_e64 v117, v117 clamp
    v_exp_f32_e64 v118, v118 clamp
    v_exp_f32_e64 v119, v119 clamp
    v_max_f32 v144, s101, v144
    v_max_f32 v145, s101, v145
    s_add_u32 m0, s90, 25600
    s_nop 0
    buffer_load_dwordx4 v8, s[48:51], s88 offen offset:0 sc1 lds
    v_max_f32 v146, s101, v146
    v_max_f32 v147, s101, v147
    v_pk_add_f32 v[144:145], v[144:145], v[116:117]
    v_pk_add_f32 v[146:147], v[146:147], v[118:119]
    v_cvt_pk_bf16_f32 v24, v144, v145
    buffer_load_dwordx4 v8, s[48:51], s88 offen offset:1024 sc1 lds
    v_cvt_pk_bf16_f32 v25, v146, v147
    v_mov_b32 v26, 0
    v_mov_b32 v27, 0
    s_lshl_b32 s8, s7, 2
    s_add_u32 s8, s8, 163364
    v_mov_b32 v14, s8
    s_waitcnt lgkmcnt(0)
    ds_write_b32 v14, v11
    v_pk_fma_f32 v[144:145], v[138:139], v[96:97], s[100:101] op_sel:[1,0,1]
    v_pk_fma_f32 v[146:147], v[138:139], v[98:99], s[100:101] op_sel:[1,0,1]
    v_pk_fma_f32 v[148:149], v[138:139], v[100:101], s[100:101] op_sel:[1,0,1]
    buffer_load_dwordx4 v8, s[48:51], s88 offen offset:2048 sc1 lds
    v_pk_fma_f32 v[150:151], v[138:139], v[102:103], s[100:101] op_sel:[1,0,1]
    v_pk_fma_f32 v[144:145], v[36:37], v[138:139], v[144:145] op_sel_hi:[1,0,1]
    v_pk_fma_f32 v[146:147], v[38:39], v[138:139], v[146:147] op_sel_hi:[1,0,1]
    v_pk_fma_f32 v[148:149], v[40:41], v[138:139], v[148:149] op_sel_hi:[1,0,1]
    v_pk_fma_f32 v[150:151], v[42:43], v[138:139], v[150:151] op_sel_hi:[1,0,1]
    buffer_load_dwordx4 v8, s[48:51], s88 offen offset:3072 sc1 lds
    v_pk_mul_f32 v[116:117], v[144:145], s[100:101] op_sel_hi:[1,0]
    v_pk_mul_f32 v[118:119], v[146:147], s[100:101] op_sel_hi:[1,0]
    v_pk_mul_f32 v[120:121], v[148:149], s[100:101] op_sel_hi:[1,0]
    v_pk_mul_f32 v[122:123], v[150:151], s[100:101] op_sel_hi:[1,0]
    v_exp_f32_e64 v116, v116 clamp
    s_add_u32 m0, s90, 29696
    s_nop 0
    buffer_load_dwordx4 v9, s[48:51], s88 offen offset:0 sc1 lds
    v_exp_f32_e64 v117, v117 clamp
    v_exp_f32_e64 v118, v118 clamp
    v_exp_f32_e64 v119, v119 clamp
    v_exp_f32_e64 v120, v120 clamp
    v_exp_f32_e64 v121, v121 clamp
    s_add_u32 m0, s90, 40960
    s_nop 0
    buffer_load_dwordx4 v8, s[48:51], s86 offen offset:0 sc1 lds
    v_exp_f32_e64 v122, v122 clamp
    v_exp_f32_e64 v123, v123 clamp
    v_max_f32 v144, s101, v144
    v_max_f32 v145, s101, v145
    v_max_f32 v146, s101, v146
    buffer_load_dwordx4 v8, s[48:51], s86 offen offset:1024 sc1 lds
    v_max_f32 v147, s101, v147
    v_max_f32 v148, s101, v148
    v_max_f32 v149, s101, v149
    v_max_f32 v150, s101, v150
    v_max_f32 v151, s101, v151
    buffer_load_dwordx4 v8, s[48:51], s86 offen offset:2048 sc1 lds
    v_pk_add_f32 v[144:145], v[144:145], v[116:117]
    v_pk_add_f32 v[146:147], v[146:147], v[118:119]
    v_pk_add_f32 v[148:149], v[148:149], v[120:121]
    v_pk_add_f32 v[150:151], v[150:151], v[122:123]
    v_cvt_pk_bf16_f32 v28, v144, v145
    buffer_load_dwordx4 v8, s[48:51], s86 offen offset:3072 sc1 lds
    v_cvt_pk_bf16_f32 v29, v146, v147
    v_cvt_pk_bf16_f32 v30, v148, v149
    v_cvt_pk_bf16_f32 v31, v150, v151
    v_pk_fma_f32 v[124:125], v[138:139], v[104:105], s[100:101] op_sel:[1,0,1]
    v_pk_fma_f32 v[126:127], v[138:139], v[106:107], s[100:101] op_sel:[1,0,1]
    s_add_u32 m0, s90, 45056
    s_nop 0
    buffer_load_dwordx4 v9, s[48:51], s86 offen offset:0 sc1 lds
    v_pk_fma_f32 v[128:129], v[138:139], v[108:109], s[100:101] op_sel:[1,0,1]
    v_pk_fma_f32 v[130:131], v[138:139], v[110:111], s[100:101] op_sel:[1,0,1]
    v_pk_fma_f32 v[124:125], v[44:45], v[138:139], v[124:125] op_sel_hi:[1,0,1]
    v_pk_fma_f32 v[126:127], v[46:47], v[138:139], v[126:127] op_sel_hi:[1,0,1]
    v_pk_fma_f32 v[128:129], v[48:49], v[138:139], v[128:129] op_sel_hi:[1,0,1]
    s_add_u32 m0, s90, 46080
    s_nop 0
    buffer_load_dwordx4 v8, s[48:51], s89 offen offset:0 sc1 lds
    v_pk_fma_f32 v[130:131], v[50:51], v[138:139], v[130:131] op_sel_hi:[1,0,1]
    v_pk_mul_f32 v[180:181], v[124:125], s[100:101] op_sel_hi:[1,0]
    v_pk_mul_f32 v[182:183], v[126:127], s[100:101] op_sel_hi:[1,0]
    v_pk_mul_f32 v[184:185], v[128:129], s[100:101] op_sel_hi:[1,0]
    v_pk_mul_f32 v[186:187], v[130:131], s[100:101] op_sel_hi:[1,0]
    buffer_load_dwordx4 v8, s[48:51], s89 offen offset:1024 sc1 lds
    v_exp_f32_e64 v180, v180 clamp
    v_exp_f32_e64 v181, v181 clamp
    v_exp_f32_e64 v182, v182 clamp
    v_exp_f32_e64 v183, v183 clamp
    v_exp_f32_e64 v184, v184 clamp
    buffer_load_dwordx4 v8, s[48:51], s89 offen offset:2048 sc1 lds
    v_exp_f32_e64 v185, v185 clamp
    v_exp_f32_e64 v186, v186 clamp
    v_exp_f32_e64 v187, v187 clamp
    v_max_f32 v124, s101, v124
    v_max_f32 v125, s101, v125
    buffer_load_dwordx4 v8, s[48:51], s89 offen offset:3072 sc1 lds
    v_max_f32 v126, s101, v126
    v_max_f32 v127, s101, v127
    v_max_f32 v128, s101, v128
    v_max_f32 v129, s101, v129
    v_max_f32 v130, s101, v130
    s_add_u32 m0, s90, 50176
    s_nop 0
    buffer_load_dwordx4 v9, s[48:51], s89 offen offset:0 sc1 lds
    v_max_f32 v131, s101, v131
    v_pk_add_f32 v[124:125], v[124:125], v[180:181]
    v_pk_add_f32 v[126:127], v[126:127], v[182:183]
    v_pk_add_f32 v[128:129], v[128:129], v[184:185]
    v_pk_add_f32 v[130:131], v[130:131], v[186:187]
    v_cvt_pk_bf16_f32 v32, v124, v125
    v_cvt_pk_bf16_f32 v33, v126, v127
    v_cvt_pk_bf16_f32 v34, v128, v129
    v_cvt_pk_bf16_f32 v35, v130, v131
    v_pk_fma_f32 v[144:145], v[138:139], v[112:113], s[100:101] op_sel:[1,0,1]
    v_pk_fma_f32 v[146:147], v[138:139], v[114:115], s[100:101] op_sel:[1,0,1]
    v_pk_fma_f32 v[144:145], v[52:53], v[138:139], v[144:145] op_sel_hi:[1,0,1]
    v_pk_fma_f32 v[146:147], v[54:55], v[138:139], v[146:147] op_sel_hi:[1,0,1]
    v_pk_mul_f32 v[116:117], v[144:145], s[100:101] op_sel_hi:[1,0]
    v_pk_mul_f32 v[118:119], v[146:147], s[100:101] op_sel_hi:[1,0]
    v_exp_f32_e64 v116, v116 clamp
    v_exp_f32_e64 v117, v117 clamp
    v_exp_f32_e64 v118, v118 clamp
    v_exp_f32_e64 v119, v119 clamp
    v_max_f32 v144, s101, v144
    v_max_f32 v145, s101, v145
    v_max_f32 v146, s101, v146
    v_max_f32 v147, s101, v147
    v_pk_add_f32 v[144:145], v[144:145], v[116:117]
    v_pk_add_f32 v[146:147], v[146:147], v[118:119]
    v_cvt_pk_bf16_f32 v36, v144, v145
    v_cvt_pk_bf16_f32 v37, v146, v147
    v_mov_b32 v38, 0
    v_mov_b32 v39, 0
    s_branch L_kvg
L_x_q5:
    s_cmp_eq_u32 s68, 7
    s_cbranch_scc0 Lj3_92
    buffer_load_dwordx2 v[228:229], v230, s[48:51], 0 offen sc1
    buffer_load_dword v13, v12, s[48:51], 0 offen sc1
    s_branch L_r_q5
Lj3_92:
    s_cmp_eq_u32 s83, 0
    s_cbranch_scc1 L_r_q5
    s_cmp_eq_u32 s68, 2
    s_waitcnt vmcnt(0)
    s_cbranch_scc0 Lj2_91
    ds_read_b64_tr_b16 v[212:213], v210 offset:0
    ds_read_b64_tr_b16 v[214:215], v210 offset:2048
    ds_read_b64_tr_b16 v[216:217], v210 offset:32
    ds_read_b64_tr_b16 v[218:219], v210 offset:2080
    ds_read_b64_tr_b16 v[220:221], v210 offset:64
    ds_read_b64_tr_b16 v[222:223], v210 offset:2112
    ds_read_b64_tr_b16 v[224:225], v210 offset:96
    ds_read_b64_tr_b16 v[226:227], v210 offset:2144
    s_waitcnt lgkmcnt(6)
    buffer_store_dwordx4 v[212:215], v8, s[48:51], s87 offen sc1
    s_waitcnt lgkmcnt(4)
    buffer_store_dwordx4 v[216:219], v8, s[48:51], s88 offen sc1
    s_waitcnt lgkmcnt(2)
    buffer_store_dwordx4 v[220:223], v8, s[48:51], s89 offen sc1
    s_waitcnt lgkmcnt(0)
    buffer_store_dwordx4 v[224:227], v8, s[48:51], s90 offen sc1
    s_branch L_r_q5
Lj2_91:
    v_lshlrev_b32 v14, 2, v0
    v_mov_b32 v15, s77
    s_mov_b64 exec, 1
    buffer_store_dword v15, v14, s[48:51], s86 offen offset:0 sc1
    s_mov_b64 exec, -1
    s_branch L_r_q5
L_h4:
    s_mov_b32 s60, s26
    s_mov_b32 s61, s27
    s_mov_b32 s62, 3072
    s_mov_b32 s63, 0x20000
    s_mul_i32 s8, s5, 384
    s_add_u32 s8, s8, 128
    v_lshlrev_b32 v3, 3, v14
    buffer_load_dwordx2 v[194:195], v3, s[60:63], s8 offen offset:0
    buffer_load_dwordx2 v[196:197], v3, s[60:63], s8 offen offset:32
    buffer_load_dwordx2 v[198:199], v3, s[60:63], s8 offen offset:64
    buffer_load_dwordx2 v[200:201], v3, s[60:63], s8 offen offset:96
    v_and_b32 v5, 7, v12
    v_lshl_add_u32 v6, v12, 8, v13
    v_lshl_add_u32 v3, v5, 5, v6
    v_add_u32 v3, 26624, v3
    v_xor_b32 v4, 32, v3
    v_xor_b32 v5, 64, v3
    v_xor_b32 v6, 96, v3
    v_mov_b32 v16, 0
    v_mov_b32 v17, 0
    v_mov_b32 v18, 0
    v_mov_b32 v19, 0
    v_mov_b32 v20, 0
    v_mov_b32 v21, 0
    v_mov_b32 v22, 0
    v_mov_b32 v23, 0
    v_mov_b32 v24, 0
    v_mov_b32 v25, 0
    v_mov_b32 v26, 0
    v_mov_b32 v27, 0
    v_mov_b32 v28, 0
    v_mov_b32 v29, 0
    v_mov_b32 v30, 0
    v_mov_b32 v31, 0
    v_mov_b32 v32, 0
    v_mov_b32 v33, 0
    v_mov_b32 v34, 0
    v_mov_b32 v35, 0
    v_mov_b32 v36, 0
    v_mov_b32 v37, 0
    v_mov_b32 v38, 0
    v_mov_b32 v39, 0
    v_mov_b32 v40, 0
    v_mov_b32 v41, 0
    v_mov_b32 v42, 0
    v_mov_b32 v43, 0
    v_mov_b32 v44, 0
    v_mov_b32 v45, 0
    v_mov_b32 v46, 0
    v_mov_b32 v47, 0
    v_mov_b32 v48, 0
    v_mov_b32 v49, 0
    v_mov_b32 v50, 0
    v_mov_b32 v51, 0
    v_mov_b32 v52, 0
    v_mov_b32 v53, 0
    v_mov_b32 v54, 0
    v_mov_b32 v55, 0
    v_mov_b32 v56, 0
    v_mov_b32 v57, 0
    v_mov_b32 v58, 0
    v_mov_b32 v59, 0
    v_mov_b32 v60, 0
    v_mov_b32 v61, 0
    v_mov_b32 v62, 0
    v_mov_b32 v63, 0
    v_mov_b32 v64, 0
    v_mov_b32 v65, 0
    v_mov_b32 v66, 0
    v_mov_b32 v67, 0
    v_mov_b32 v68, 0
    v_mov_b32 v69, 0
    v_mov_b32 v70, 0
    v_mov_b32 v71, 0
    v_mov_b32 v72, 0
    v_mov_b32 v73, 0
    v_mov_b32 v74, 0
    v_mov_b32 v75, 0
    v_mov_b32 v76, 0
    v_mov_b32 v77, 0
    v_mov_b32 v78, 0
    v_mov_b32 v79, 0
    v_mov_b32 v96, 0
    v_mov_b32 v97, 0
    v_mov_b32 v98, 0
    v_mov_b32 v99, 0
    v_mov_b32 v100, 0
    v_mov_b32 v101, 0
    v_mov_b32 v102, 0
    v_mov_b32 v103, 0
    v_mov_b32 v104, 0
    v_mov_b32 v105, 0
    v_mov_b32 v106, 0
    v_mov_b32 v107, 0
    v_mov_b32 v108, 0
    v_mov_b32 v109, 0
    v_mov_b32 v110, 0
    v_mov_b32 v111, 0
    v_mov_b32 v244, 0x3f803f80
    v_mov_b32 v245, 0x3f803f80
    v_mov_b32 v246, 0x3f803f80
    v_mov_b32 v247, 0x3f803f80
    s_mul_i32 s9, s79, 5
    s_lshr_b32 s9, s9, 2
    s_lshl_b32 s9, s9, 2
    s_lshl_b32 s10, s91, 6
    s_add_u32 s9, s9, s10
    s_add_u32 s9, s9, 24576
    v_min_u32 v14, 9, v0
    v_and_b32 v15, 1, v14
    v_lshrrev_b32 v14, 1, v14
    v_lshlrev_b32 v14, 6, v14
    v_lshl_add_u32 v14, v15, 2, v14
    v_add_u32 v12, s9, v14
    v_mov_b32 v126, 0
    v_mov_b32 v127, 0
    s_waitcnt vmcnt(0)
    v_readfirstlane_b32 s8, v211
    s_mul_i32 s8, s8, 0x9E3779B1
    s_add_u32 s77, s8, 0x7F4A7C15
    v_dot2c_f32_bf16 v126, v11, v116
    v_dot2c_f32_bf16 v127, v116, v116
    v_dot2c_f32_bf16 v126, v11, v117
    v_dot2c_f32_bf16 v127, v117, v117
    v_dot2c_f32_bf16 v126, v11, v118
    v_dot2c_f32_bf16 v127, v118, v118
    v_dot2c_f32_bf16 v126, v11, v119
    v_dot2c_f32_bf16 v127, v119, v119
    v_dot2c_f32_bf16 v126, v11, v120
    v_dot2c_f32_bf16 v127, v120, v120
    v_dot2c_f32_bf16 v126, v11, v121
    v_dot2c_f32_bf16 v127, v121, v121
    v_dot2c_f32_bf16 v126, v11, v122
    v_dot2c_f32_bf16 v127, v122, v122
    v_dot2c_f32_bf16 v126, v11, v123
    v_dot2c_f32_bf16 v127, v123, v123
    v_dot2c_f32_bf16 v126, v11, v124
    v_dot2c_f32_bf16 v127, v124, v124
    v_dot2c_f32_bf16 v126, v11, v125
    v_dot2c_f32_bf16 v127, v125, v125
    v_mov_b32 v129, s77
    v_mov_b32 v128, 163376
    ds_write_b32 v128, v129
    v_add_f32_dpp v126, v126, v126 row_ror:8 row_mask:0xf bank_mask:0xf
    v_add_f32_dpp v127, v127, v127 row_ror:8 row_mask:0xf bank_mask:0xf
    s_nop 0
    v_add_f32_dpp v126, v126, v126 row_ror:4 row_mask:0xf bank_mask:0xf
    v_add_f32_dpp v127, v127, v127 row_ror:4 row_mask:0xf bank_mask:0xf
    s_nop 0
    v_add_f32_dpp v126, v126, v126 row_ror:2 row_mask:0xf bank_mask:0xf
    v_add_f32_dpp v127, v127, v127 row_ror:2 row_mask:0xf bank_mask:0xf
    s_nop 0
    v_add_f32_dpp v126, v126, v126 row_ror:1 row_mask:0xf bank_mask:0xf
    v_add_f32_dpp v127, v127, v127 row_ror:1 row_mask:0xf bank_mask:0xf
    v_mov_b32 v128, v126
    v_mov_b32 v129, v127
    s_nop 0
    v_permlane16_swap_b32 v126, v128
    v_permlane16_swap_b32 v127, v129
    v_add_f32 v126, v126, v128
    v_add_f32 v127, v127, v129
    v_mul_f32 v126, 986500301, v126
    v_mul_f32 v127, 986500301, v127
    v_fma_f32 v127, -v126, v126, v127
    v_max_f32 v127, 0, v127
    v_cvt_pk_bf16_f32 v127, v127, v127
    v_and_b32 v127, 0xffff0000, v127
    v_add_f32 v127, 925353388, v127
    v_cvt_pk_bf16_f32 v127, v127, v127
    v_and_b32 v127, 0xffff0000, v127
    v_sqrt_f32 v127, v127
    v_lshrrev_b32 v128, 5, v0
    v_add_u32 v128, s70, v128
    v_lshlrev_b32 v128, 3, v128
    v_cvt_pk_bf16_f32 v126, v126, v127
    v_mov_b32 v127, s77
    s_mov_b32 s8, 36864
    s_mov_b32 exec_lo, 1
    s_mov_b32 exec_hi, 1
    buffer_store_dwordx2 v[126:127], v128, s[48:51], s8 offen sc1
    s_mov_b64 exec, -1
    s_cmp_eq_u32 s3, 3
    s_cbranch_scc0 Lft_93
    s_cmp_lt_u32 s2, 32
    s_cbranch_scc0 Lft_93
    s_mul_i32 s8, s2, 768
    s_and_b32 s9, s2, 7
    s_mul_i32 s9, s9, 768
    v_lshlrev_b32 v232, 6, v0
    v_add_u32 v233, s9, v232
    v_add_u32 v233, 589568, v233
    v_add_u32 v232, s8, v232
    v_add_u32 v232, 655360, v232
    v_add_u32 v234, 163648, v232
    v_cmp_eq_u32 vcc, 3, v0
    s_nop 1
    v_cndmask_b32 v232, v232, v234, vcc
    v_cmp_lt_u32 vcc, 3, v0
    s_nop 1
    v_cndmask_b32 v232, v232, v233, vcc
    s_mov_b64 exec, 0xff
    buffer_load_dword v233, v232, s[48:51], 0 offen sc1
    s_mov_b64 exec, -1
Lft_93:
    s_waitcnt lgkmcnt(0)
    s_barrier
    ds_read_b128 v[116:119], v1 offset:0
    ds_read_b64_tr_b16 v[148:149], v3 offset:0
    ds_read_b64_tr_b16 v[150:151], v3 offset:2048
    ds_read_b128 v[120:123], v1 offset:2048
    ds_read_b64_tr_b16 v[152:153], v4 offset:0
    ds_read_b64_tr_b16 v[154:155], v4 offset:2048
    ds_read_b128 v[124:127], v1 offset:4096
    ds_read_b128 v[128:131], v1 offset:6144
    ds_read_b64_tr_b16 v[156:157], v5 offset:0
    ds_read_b64_tr_b16 v[158:159], v5 offset:2048
    ds_read_b64_tr_b16 v[160:161], v6 offset:0
    ds_read_b64_tr_b16 v[162:163], v6 offset:2048
    s_cmp_eq_u32 s83, 0
    s_cbranch_scc1 Lnorp_94
    s_lshl_b32 s8, s3, 12
    s_add_u32 s8, s8, 143360
    s_add_u32 m0, s8, 0
    s_add_u32 s9, s84, 0
    buffer_load_dwordx4 v209, s[52:55], s9 offen lds
    s_add_u32 m0, s8, 1024
    s_add_u32 s9, s84, 10240
    buffer_load_dwordx4 v209, s[52:55], s9 offen lds
    s_add_u32 m0, s8, 2048
    s_add_u32 s9, s85, 0
    buffer_load_dwordx4 v209, s[52:55], s9 offen lds
    s_add_u32 m0, s8, 3072
    s_add_u32 s9, s85, 10240
    buffer_load_dwordx4 v209, s[52:55], s9 offen lds
Lnorp_94:
    s_mov_b32 s81, 148
L_loop_h4:
    s_waitcnt lgkmcnt(0)
    v_mfma_f32_16x16x32_bf16 v[16:19], v[148:151], v[116:119], v[16:19]
    ds_read_b128 v[132:135], v2 offset:0
    ds_read_b64_tr_b16 v[168:169], v3 offset:8192
    v_mfma_f32_16x16x32_bf16 v[20:23], v[152:155], v[116:119], v[20:23]
    ds_read_b64_tr_b16 v[170:171], v3 offset:10240
    ds_read_b128 v[136:139], v2 offset:2048
    v_mfma_f32_16x16x32_bf16 v[24:27], v[156:159], v[116:119], v[24:27]
    ds_read_b64_tr_b16 v[172:173], v4 offset:8192
    ds_read_b64_tr_b16 v[174:175], v4 offset:10240
    v_mfma_f32_16x16x32_bf16 v[28:31], v[160:163], v[116:119], v[28:31]
    ds_read_b128 v[140:143], v2 offset:4096
    ds_read_b128 v[144:147], v2 offset:6144
    v_mfma_f32_16x16x32_bf16 v[32:35], v[148:151], v[120:123], v[32:35]
    ds_read_b64_tr_b16 v[176:177], v5 offset:8192
    ds_read_b64_tr_b16 v[178:179], v5 offset:10240
    v_mfma_f32_16x16x32_bf16 v[36:39], v[152:155], v[120:123], v[36:39]
    ds_read_b64_tr_b16 v[180:181], v6 offset:8192
    ds_read_b64_tr_b16 v[182:183], v6 offset:10240
    v_mfma_f32_16x16x32_bf16 v[40:43], v[156:159], v[120:123], v[40:43]
    s_add_u32 s75, s75, 1
    s_cmp_eq_u32 s75, 3
    s_cselect_b32 s74, -2, 1
    s_cselect_b32 s75, 0, s75
    s_mul_i32 s74, s74, 43008
    v_add_u32 v1, s74, v1
    v_mfma_f32_16x16x32_bf16 v[44:47], v[160:163], v[120:123], v[44:47]
    v_add_u32 v2, s74, v2
    v_add_u32 v3, s74, v3
    v_mfma_f32_16x16x32_bf16 v[48:51], v[148:151], v[124:127], v[48:51]
    v_add_u32 v4, s74, v4
    v_add_u32 v5, s74, v5
    v_mfma_f32_16x16x32_bf16 v[52:55], v[152:155], v[124:127], v[52:55]
    v_add_u32 v6, s74, v6
    v_mfma_f32_16x16x32_bf16 v[56:59], v[156:159], v[124:127], v[56:59]
    v_mfma_f32_16x16x32_bf16 v[60:63], v[160:163], v[124:127], v[60:63]
    v_mfma_f32_16x16x32_bf16 v[64:67], v[148:151], v[128:131], v[64:67]
    v_mfma_f32_16x16x32_bf16 v[68:71], v[152:155], v[128:131], v[68:71]
    v_mfma_f32_16x16x32_bf16 v[72:75], v[156:159], v[128:131], v[72:75]
    v_mfma_f32_16x16x32_bf16 v[76:79], v[160:163], v[128:131], v[76:79]
    s_cmp_eq_u32 s7, 0
    s_cbranch_scc0 Lcs_95
    v_mfma_f32_16x16x32_bf16 v[96:99], v[148:151], v[244:247], v[96:99]
    v_mfma_f32_16x16x32_bf16 v[100:103], v[152:155], v[244:247], v[100:103]
    v_mfma_f32_16x16x32_bf16 v[104:107], v[156:159], v[244:247], v[104:107]
    v_mfma_f32_16x16x32_bf16 v[108:111], v[160:163], v[244:247], v[108:111]
Lcs_95:
    s_waitcnt lgkmcnt(0)
    s_cmp_eq_u32 s68, 9
    s_cbranch_scc1 Lnb_96
    s_barrier
Lnb_96:
    s_bitcmp1_b32 s81, s68
    s_cbranch_scc1 L_x_h4
L_r_h4:
    v_mfma_f32_16x16x32_bf16 v[16:19], v[168:171], v[132:135], v[16:19]
    ds_read_b128 v[116:119], v1 offset:0
    v_mfma_f32_16x16x32_bf16 v[20:23], v[172:175], v[132:135], v[20:23]
    ds_read_b64_tr_b16 v[148:149], v3 offset:0
    v_mfma_f32_16x16x32_bf16 v[24:27], v[176:179], v[132:135], v[24:27]
    ds_read_b64_tr_b16 v[150:151], v3 offset:2048
    v_mfma_f32_16x16x32_bf16 v[28:31], v[180:183], v[132:135], v[28:31]
    ds_read_b128 v[120:123], v1 offset:2048
    v_mfma_f32_16x16x32_bf16 v[32:35], v[168:171], v[136:139], v[32:35]
    ds_read_b64_tr_b16 v[152:153], v4 offset:0
    v_mfma_f32_16x16x32_bf16 v[36:39], v[172:175], v[136:139], v[36:39]
    ds_read_b64_tr_b16 v[154:155], v4 offset:2048
    v_mfma_f32_16x16x32_bf16 v[40:43], v[176:179], v[136:139], v[40:43]
    ds_read_b128 v[124:127], v1 offset:4096
    v_mfma_f32_16x16x32_bf16 v[44:47], v[180:183], v[136:139], v[44:47]
    ds_read_b128 v[128:131], v1 offset:6144
    v_mfma_f32_16x16x32_bf16 v[48:51], v[168:171], v[140:143], v[48:51]
    ds_read_b64_tr_b16 v[156:157], v5 offset:0
    v_mfma_f32_16x16x32_bf16 v[52:55], v[172:175], v[140:143], v[52:55]
    ds_read_b64_tr_b16 v[158:159], v5 offset:2048
    v_mfma_f32_16x16x32_bf16 v[56:59], v[176:179], v[140:143], v[56:59]
    ds_read_b64_tr_b16 v[160:161], v6 offset:0
    v_mfma_f32_16x16x32_bf16 v[60:63], v[180:183], v[140:143], v[60:63]
    ds_read_b64_tr_b16 v[162:163], v6 offset:2048
    v_mfma_f32_16x16x32_bf16 v[64:67], v[168:171], v[144:147], v[64:67]
    v_mfma_f32_16x16x32_bf16 v[68:71], v[172:175], v[144:147], v[68:71]
    v_mfma_f32_16x16x32_bf16 v[72:75], v[176:179], v[144:147], v[72:75]
    v_mfma_f32_16x16x32_bf16 v[76:79], v[180:183], v[144:147], v[76:79]
    s_cmp_eq_u32 s7, 1
    s_cbranch_scc0 Lcs_97
    v_mfma_f32_16x16x32_bf16 v[96:99], v[168:171], v[244:247], v[96:99]
    v_mfma_f32_16x16x32_bf16 v[100:103], v[172:175], v[244:247], v[100:103]
    v_mfma_f32_16x16x32_bf16 v[104:107], v[176:179], v[244:247], v[104:107]
    v_mfma_f32_16x16x32_bf16 v[108:111], v[180:183], v[244:247], v[108:111]
Lcs_97:
    s_add_u32 s68, s68, 1
    s_cmp_lt_u32 s68, 10
    s_cbranch_scc1 L_loop_h4
    s_waitcnt lgkmcnt(0)
    s_mul_i32 s8, s3, 320
    s_add_u32 s8, s8, 160768
    v_add_u32 v14, s8, v0
    s_mov_b32 exec_lo, 0x00010001
    s_mov_b32 exec_hi, 0x00010001
    ds_write_b128 v14, v[96:99] offset:0
    ds_write_b128 v14, v[100:103] offset:64
    ds_write_b128 v14, v[104:107] offset:128
    ds_write_b128 v14, v[108:111] offset:192
    s_mov_b64 exec, -1
    s_mov_b32 s8, 0
    s_branch Lstc_99
Lst_98:
    buffer_load_dwordx2 v[228:229], v230, s[48:51], 0 offen sc1
Lstc_99:
    s_waitcnt vmcnt(0)
    s_add_u32 s8, s8, 1
    s_cmp_ge_u32 s8, 100000
    s_cbranch_scc1 Lstd_100
    v_cmp_ne_u32 vcc, s77, v229
    s_cbranch_vccnz Lst_98
Lstd_100:
    v_and_b32 v117, 0xffff0000, v228
    v_rcp_f32 v117, v117
    v_lshlrev_b32 v116, 16, v228
    v_and_b32 v118, 31, v0
    v_lshrrev_b32 v119, 5, v0
    v_lshl_add_u32 v118, v119, 7, v118
    s_lshl_b32 s8, s3, 7
    s_add_u32 s8, s8, 159744
    v_cmp_gt_u32 vcc, 32, v0
    v_mul_f32 v116, -v116, v117
    v_lshl_add_u32 v118, v118, 2, s8
    v_cndmask_b32 v116, v116, v117, vcc
    ds_write_b32 v118, v116
    s_waitcnt lgkmcnt(0)
    s_barrier
    s_xor_b32 s8, s3, 1
    s_mul_i32 s8, s8, 320
    s_add_u32 s8, s8, 160768
    v_and_b32 v14, 48, v0
    v_add_u32 v14, s8, v14
    ds_read_b128 v[116:119], v14 offset:0
    ds_read_b128 v[120:123], v14 offset:64
    ds_read_b128 v[124:127], v14 offset:128
    ds_read_b128 v[128:131], v14 offset:192
    s_lshl_b32 s8, s7, 8
    s_add_u32 s8, s8, 159744
    v_and_b32 v15, 15, v0
    v_lshl_add_u32 v15, v15, 2, s8
    ds_read2_b32 v[132:133], v15 offset0:0 offset1:128
    ds_read2_b32 v[134:135], v15 offset0:16 offset1:144
    ds_read2_b32 v[136:137], v15 offset0:32 offset1:160
    ds_read2_b32 v[138:139], v15 offset0:48 offset1:176
    s_lshr_b32 s8, s5, 1
    s_mul_i32 s9, s8, 17
    s_and_b32 s8, s5, 1
    s_lshl_b32 s8, s8, 2
    s_add_u32 s9, s9, s8
    s_lshl_b32 s10, s6, 1
    s_add_u32 s10, s10, s7
    s_mul_i32 s11, s10, 768
    s_lshl_b32 s12, s9, 2
    s_add_u32 s11, s11, s12
    s_add_u32 s71, s11, 655360
    s_mul_i32 s10, s10, 68
    s_add_u32 s10, s10, s9
    s_lshl_b32 s10, s10, 12
    s_add_u32 s70, s10, 1048576
    v_lshlrev_b32 v140, 16, v194
    v_and_b32 v141, 0xffff0000, v194
    v_lshlrev_b32 v142, 16, v195
    v_and_b32 v143, 0xffff0000, v195
    v_lshlrev_b32 v144, 16, v196
    v_and_b32 v145, 0xffff0000, v196
    v_lshlrev_b32 v146, 16, v197
    v_and_b32 v147, 0xffff0000, v197
    v_lshlrev_b32 v148, 16, v198
    v_and_b32 v149, 0xffff0000, v198
    v_lshlrev_b32 v150, 16, v199
    v_and_b32 v151, 0xffff0000, v199
    v_lshlrev_b32 v152, 16, v200
    v_and_b32 v153, 0xffff0000, v200
    v_lshlrev_b32 v154, 16, v201
    v_and_b32 v155, 0xffff0000, v201
    v_pk_mul_f32 v[140:141], v[140:141], s[100:101] op_sel_hi:[1,0]
    v_pk_mul_f32 v[142:143], v[142:143], s[100:101] op_sel_hi:[1,0]
    v_pk_mul_f32 v[144:145], v[144:145], s[100:101] op_sel_hi:[1,0]
    v_pk_mul_f32 v[146:147], v[146:147], s[100:101] op_sel_hi:[1,0]
    v_pk_mul_f32 v[148:149], v[148:149], s[100:101] op_sel_hi:[1,0]
    v_pk_mul_f32 v[150:151], v[150:151], s[100:101] op_sel_hi:[1,0]
    v_pk_mul_f32 v[152:153], v[152:153], s[100:101] op_sel_hi:[1,0]
    v_pk_mul_f32 v[154:155], v[154:155], s[100:101] op_sel_hi:[1,0]
    s_waitcnt lgkmcnt(0)
    v_pk_add_f32 v[96:97], v[96:97], v[116:117]
    v_pk_add_f32 v[98:99], v[98:99], v[118:119]
    v_pk_add_f32 v[100:101], v[100:101], v[120:121]
    v_pk_add_f32 v[102:103], v[102:103], v[122:123]
    v_pk_add_f32 v[104:105], v[104:105], v[124:125]
    v_pk_add_f32 v[106:107], v[106:107], v[126:127]
    v_pk_add_f32 v[108:109], v[108:109], v[128:129]
    v_pk_add_f32 v[110:111], v[110:111], v[130:131]
    v_mul_f32 v132, s100, v132
    v_mul_f32 v134, s100, v134
    v_mul_f32 v136, s100, v136
    v_mul_f32 v138, s100, v138
    v_pk_mul_f32 v[96:97], v[96:97], s[100:101] op_sel_hi:[1,0]
    v_pk_mul_f32 v[98:99], v[98:99], s[100:101] op_sel_hi:[1,0]
    v_pk_mul_f32 v[100:101], v[100:101], s[100:101] op_sel_hi:[1,0]
    v_pk_mul_f32 v[102:103], v[102:103], s[100:101] op_sel_hi:[1,0]
    v_pk_mul_f32 v[104:105], v[104:105], s[100:101] op_sel_hi:[1,0]
    v_pk_mul_f32 v[106:107], v[106:107], s[100:101] op_sel_hi:[1,0]
    v_pk_mul_f32 v[108:109], v[108:109], s[100:101] op_sel_hi:[1,0]
    v_pk_mul_f32 v[110:111], v[110:111], s[100:101] op_sel_hi:[1,0]
    v_pk_fma_f32 v[80:81], v[132:133], v[96:97], v[140:141] op_sel:[1,0,0]
    v_pk_fma_f32 v[82:83], v[132:133], v[98:99], v[142:143] op_sel:[1,0,0]
    v_pk_fma_f32 v[84:85], v[132:133], v[100:101], v[144:145] op_sel:[1,0,0]
    v_pk_fma_f32 v[86:87], v[132:133], v[102:103], v[146:147] op_sel:[1,0,0]
    v_pk_fma_f32 v[80:81], v[16:17], v[132:133], v[80:81] op_sel_hi:[1,0,1]
    v_pk_fma_f32 v[82:83], v[18:19], v[132:133], v[82:83] op_sel_hi:[1,0,1]
    v_pk_fma_f32 v[84:85], v[20:21], v[132:133], v[84:85] op_sel_hi:[1,0,1]
    v_pk_fma_f32 v[86:87], v[22:23], v[132:133], v[86:87] op_sel_hi:[1,0,1]
    v_exp_f32 v88, v80
    v_exp_f32 v89, v81
    v_exp_f32 v90, v82
    v_exp_f32 v91, v83
    v_exp_f32 v92, v84
    v_exp_f32 v93, v85
    v_exp_f32 v94, v86
    v_exp_f32 v95, v87
    v_pk_add_f32 v[156:157], v[88:89], 2.0 op_sel_hi:[1,0]
    v_pk_add_f32 v[158:159], v[90:91], 2.0 op_sel_hi:[1,0]
    v_pk_add_f32 v[160:161], v[92:93], 2.0 op_sel_hi:[1,0]
    v_pk_add_f32 v[162:163], v[94:95], 2.0 op_sel_hi:[1,0]
    v_pk_fma_f32 v[156:157], v[88:89], v[156:157], 2.0 op_sel_hi:[1,1,0]
    v_pk_fma_f32 v[158:159], v[90:91], v[158:159], 2.0 op_sel_hi:[1,1,0]
    v_pk_fma_f32 v[160:161], v[92:93], v[160:161], 2.0 op_sel_hi:[1,1,0]
    v_pk_fma_f32 v[162:163], v[94:95], v[162:163], 2.0 op_sel_hi:[1,1,0]
    v_rcp_f32 v156, v156
    v_rcp_f32 v157, v157
    v_rcp_f32 v158, v158
    v_rcp_f32 v159, v159
    v_rcp_f32 v160, v160
    v_rcp_f32 v161, v161
    v_rcp_f32 v162, v162
    v_rcp_f32 v163, v163
    v_pk_fma_f32 v[156:157], v[156:157], s[98:99], s[98:99] op_sel:[0,0,1] op_sel_hi:[1,0,1]
    v_pk_fma_f32 v[158:159], v[158:159], s[98:99], s[98:99] op_sel:[0,0,1] op_sel_hi:[1,0,1]
    v_pk_fma_f32 v[160:161], v[160:161], s[98:99], s[98:99] op_sel:[0,0,1] op_sel_hi:[1,0,1]
    v_pk_fma_f32 v[162:163], v[162:163], s[98:99], s[98:99] op_sel:[0,0,1] op_sel_hi:[1,0,1]
    v_pk_mul_f32 v[80:81], v[80:81], v[156:157]
    v_pk_mul_f32 v[82:83], v[82:83], v[158:159]
    v_pk_mul_f32 v[84:85], v[84:85], v[160:161]
    v_pk_mul_f32 v[86:87], v[86:87], v[162:163]
    v_cvt_pk_bf16_f32 v164, v80, v81
    v_cvt_pk_bf16_f32 v165, v82, v83
    v_cvt_pk_bf16_f32 v166, v84, v85
    v_cvt_pk_bf16_f32 v167, v86, v87
    buffer_store_dwordx4 v[164:167], v8, s[48:51], s70 offen offset:0 sc1
    v_pk_fma_f32 v[80:81], v[134:135], v[96:97], v[140:141] op_sel:[1,0,0]
    v_pk_fma_f32 v[82:83], v[134:135], v[98:99], v[142:143] op_sel:[1,0,0]
    v_pk_fma_f32 v[84:85], v[134:135], v[100:101], v[144:145] op_sel:[1,0,0]
    v_pk_fma_f32 v[86:87], v[134:135], v[102:103], v[146:147] op_sel:[1,0,0]
    v_pk_fma_f32 v[80:81], v[32:33], v[134:135], v[80:81] op_sel_hi:[1,0,1]
    v_pk_fma_f32 v[82:83], v[34:35], v[134:135], v[82:83] op_sel_hi:[1,0,1]
    v_pk_fma_f32 v[84:85], v[36:37], v[134:135], v[84:85] op_sel_hi:[1,0,1]
    v_pk_fma_f32 v[86:87], v[38:39], v[134:135], v[86:87] op_sel_hi:[1,0,1]
    v_exp_f32 v88, v80
    v_exp_f32 v89, v81
    v_exp_f32 v90, v82
    v_exp_f32 v91, v83
    v_exp_f32 v92, v84
    v_exp_f32 v93, v85
    v_exp_f32 v94, v86
    v_exp_f32 v95, v87
    v_pk_add_f32 v[156:157], v[88:89], 2.0 op_sel_hi:[1,0]
    v_pk_add_f32 v[158:159], v[90:91], 2.0 op_sel_hi:[1,0]
    v_pk_add_f32 v[160:161], v[92:93], 2.0 op_sel_hi:[1,0]
    v_pk_add_f32 v[162:163], v[94:95], 2.0 op_sel_hi:[1,0]
    v_pk_fma_f32 v[156:157], v[88:89], v[156:157], 2.0 op_sel_hi:[1,1,0]
    v_pk_fma_f32 v[158:159], v[90:91], v[158:159], 2.0 op_sel_hi:[1,1,0]
    v_pk_fma_f32 v[160:161], v[92:93], v[160:161], 2.0 op_sel_hi:[1,1,0]
    v_pk_fma_f32 v[162:163], v[94:95], v[162:163], 2.0 op_sel_hi:[1,1,0]
    v_rcp_f32 v156, v156
    v_rcp_f32 v157, v157
    v_rcp_f32 v158, v158
    v_rcp_f32 v159, v159
    v_rcp_f32 v160, v160
    v_rcp_f32 v161, v161
    v_rcp_f32 v162, v162
    v_rcp_f32 v163, v163
    v_pk_fma_f32 v[156:157], v[156:157], s[98:99], s[98:99] op_sel:[0,0,1] op_sel_hi:[1,0,1]
    v_pk_fma_f32 v[158:159], v[158:159], s[98:99], s[98:99] op_sel:[0,0,1] op_sel_hi:[1,0,1]
    v_pk_fma_f32 v[160:161], v[160:161], s[98:99], s[98:99] op_sel:[0,0,1] op_sel_hi:[1,0,1]
    v_pk_fma_f32 v[162:163], v[162:163], s[98:99], s[98:99] op_sel:[0,0,1] op_sel_hi:[1,0,1]
    v_pk_mul_f32 v[80:81], v[80:81], v[156:157]
    v_pk_mul_f32 v[82:83], v[82:83], v[158:159]
    v_pk_mul_f32 v[84:85], v[84:85], v[160:161]
    v_pk_mul_f32 v[86:87], v[86:87], v[162:163]
    v_cvt_pk_bf16_f32 v168, v80, v81
    v_cvt_pk_bf16_f32 v169, v82, v83
    v_cvt_pk_bf16_f32 v170, v84, v85
    v_cvt_pk_bf16_f32 v171, v86, v87
    buffer_store_dwordx4 v[168:171], v8, s[48:51], s70 offen offset:1024 sc1
    v_pk_fma_f32 v[80:81], v[136:137], v[96:97], v[140:141] op_sel:[1,0,0]
    v_pk_fma_f32 v[82:83], v[136:137], v[98:99], v[142:143] op_sel:[1,0,0]
    v_pk_fma_f32 v[84:85], v[136:137], v[100:101], v[144:145] op_sel:[1,0,0]
    v_pk_fma_f32 v[86:87], v[136:137], v[102:103], v[146:147] op_sel:[1,0,0]
    v_pk_fma_f32 v[80:81], v[48:49], v[136:137], v[80:81] op_sel_hi:[1,0,1]
    v_pk_fma_f32 v[82:83], v[50:51], v[136:137], v[82:83] op_sel_hi:[1,0,1]
    v_pk_fma_f32 v[84:85], v[52:53], v[136:137], v[84:85] op_sel_hi:[1,0,1]
    v_pk_fma_f32 v[86:87], v[54:55], v[136:137], v[86:87] op_sel_hi:[1,0,1]
    v_exp_f32 v88, v80
    v_exp_f32 v89, v81
    v_exp_f32 v90, v82
    v_exp_f32 v91, v83
    v_exp_f32 v92, v84
    v_exp_f32 v93, v85
    v_exp_f32 v94, v86
    v_exp_f32 v95, v87
    v_pk_add_f32 v[156:157], v[88:89], 2.0 op_sel_hi:[1,0]
    v_pk_add_f32 v[158:159], v[90:91], 2.0 op_sel_hi:[1,0]
    v_pk_add_f32 v[160:161], v[92:93], 2.0 op_sel_hi:[1,0]
    v_pk_add_f32 v[162:163], v[94:95], 2.0 op_sel_hi:[1,0]
    v_pk_fma_f32 v[156:157], v[88:89], v[156:157], 2.0 op_sel_hi:[1,1,0]
    v_pk_fma_f32 v[158:159], v[90:91], v[158:159], 2.0 op_sel_hi:[1,1,0]
    v_pk_fma_f32 v[160:161], v[92:93], v[160:161], 2.0 op_sel_hi:[1,1,0]
    v_pk_fma_f32 v[162:163], v[94:95], v[162:163], 2.0 op_sel_hi:[1,1,0]
    v_rcp_f32 v156, v156
    v_rcp_f32 v157, v157
    v_rcp_f32 v158, v158
    v_rcp_f32 v159, v159
    v_rcp_f32 v160, v160
    v_rcp_f32 v161, v161
    v_rcp_f32 v162, v162
    v_rcp_f32 v163, v163
    v_pk_fma_f32 v[156:157], v[156:157], s[98:99], s[98:99] op_sel:[0,0,1] op_sel_hi:[1,0,1]
    v_pk_fma_f32 v[158:159], v[158:159], s[98:99], s[98:99] op_sel:[0,0,1] op_sel_hi:[1,0,1]
    v_pk_fma_f32 v[160:161], v[160:161], s[98:99], s[98:99] op_sel:[0,0,1] op_sel_hi:[1,0,1]
    v_pk_fma_f32 v[162:163], v[162:163], s[98:99], s[98:99] op_sel:[0,0,1] op_sel_hi:[1,0,1]
    v_pk_mul_f32 v[80:81], v[80:81], v[156:157]
    v_pk_mul_f32 v[82:83], v[82:83], v[158:159]
    v_pk_mul_f32 v[84:85], v[84:85], v[160:161]
    v_pk_mul_f32 v[86:87], v[86:87], v[162:163]
    v_cvt_pk_bf16_f32 v164, v80, v81
    v_cvt_pk_bf16_f32 v165, v82, v83
    v_cvt_pk_bf16_f32 v166, v84, v85
    v_cvt_pk_bf16_f32 v167, v86, v87
    buffer_store_dwordx4 v[164:167], v8, s[48:51], s70 offen offset:2048 sc1
    v_pk_fma_f32 v[80:81], v[138:139], v[96:97], v[140:141] op_sel:[1,0,0]
    v_pk_fma_f32 v[82:83], v[138:139], v[98:99], v[142:143] op_sel:[1,0,0]
    v_pk_fma_f32 v[84:85], v[138:139], v[100:101], v[144:145] op_sel:[1,0,0]
    v_pk_fma_f32 v[86:87], v[138:139], v[102:103], v[146:147] op_sel:[1,0,0]
    v_pk_fma_f32 v[80:81], v[64:65], v[138:139], v[80:81] op_sel_hi:[1,0,1]
    v_pk_fma_f32 v[82:83], v[66:67], v[138:139], v[82:83] op_sel_hi:[1,0,1]
    v_pk_fma_f32 v[84:85], v[68:69], v[138:139], v[84:85] op_sel_hi:[1,0,1]
    v_pk_fma_f32 v[86:87], v[70:71], v[138:139], v[86:87] op_sel_hi:[1,0,1]
    v_exp_f32 v88, v80
    v_exp_f32 v89, v81
    v_exp_f32 v90, v82
    v_exp_f32 v91, v83
    v_exp_f32 v92, v84
    v_exp_f32 v93, v85
    v_exp_f32 v94, v86
    v_exp_f32 v95, v87
    v_pk_add_f32 v[156:157], v[88:89], 2.0 op_sel_hi:[1,0]
    v_pk_add_f32 v[158:159], v[90:91], 2.0 op_sel_hi:[1,0]
    v_pk_add_f32 v[160:161], v[92:93], 2.0 op_sel_hi:[1,0]
    v_pk_add_f32 v[162:163], v[94:95], 2.0 op_sel_hi:[1,0]
    v_pk_fma_f32 v[156:157], v[88:89], v[156:157], 2.0 op_sel_hi:[1,1,0]
    v_pk_fma_f32 v[158:159], v[90:91], v[158:159], 2.0 op_sel_hi:[1,1,0]
    v_pk_fma_f32 v[160:161], v[92:93], v[160:161], 2.0 op_sel_hi:[1,1,0]
    v_pk_fma_f32 v[162:163], v[94:95], v[162:163], 2.0 op_sel_hi:[1,1,0]
    v_rcp_f32 v156, v156
    v_rcp_f32 v157, v157
    v_rcp_f32 v158, v158
    v_rcp_f32 v159, v159
    v_rcp_f32 v160, v160
    v_rcp_f32 v161, v161
    v_rcp_f32 v162, v162
    v_rcp_f32 v163, v163
    v_pk_fma_f32 v[156:157], v[156:157], s[98:99], s[98:99] op_sel:[0,0,1] op_sel_hi:[1,0,1]
    v_pk_fma_f32 v[158:159], v[158:159], s[98:99], s[98:99] op_sel:[0,0,1] op_sel_hi:[1,0,1]
    v_pk_fma_f32 v[160:161], v[160:161], s[98:99], s[98:99] op_sel:[0,0,1] op_sel_hi:[1,0,1]
    v_pk_fma_f32 v[162:163], v[162:163], s[98:99], s[98:99] op_sel:[0,0,1] op_sel_hi:[1,0,1]
    v_pk_mul_f32 v[80:81], v[80:81], v[156:157]
    v_pk_mul_f32 v[82:83], v[82:83], v[158:159]
    v_pk_mul_f32 v[84:85], v[84:85], v[160:161]
    v_pk_mul_f32 v[86:87], v[86:87], v[162:163]
    v_cvt_pk_bf16_f32 v168, v80, v81
    v_cvt_pk_bf16_f32 v169, v82, v83
    v_cvt_pk_bf16_f32 v170, v84, v85
    v_cvt_pk_bf16_f32 v171, v86, v87
    buffer_store_dwordx4 v[168:171], v8, s[48:51], s70 offen offset:3072 sc1
    s_add_u32 s70, s70, 4096
    v_pk_fma_f32 v[80:81], v[132:133], v[104:105], v[148:149] op_sel:[1,0,0]
    v_pk_fma_f32 v[82:83], v[132:133], v[106:107], v[150:151] op_sel:[1,0,0]
    v_pk_fma_f32 v[84:85], v[132:133], v[108:109], v[152:153] op_sel:[1,0,0]
    v_pk_fma_f32 v[86:87], v[132:133], v[110:111], v[154:155] op_sel:[1,0,0]
    v_pk_fma_f32 v[80:81], v[24:25], v[132:133], v[80:81] op_sel_hi:[1,0,1]
    v_pk_fma_f32 v[82:83], v[26:27], v[132:133], v[82:83] op_sel_hi:[1,0,1]
    v_pk_fma_f32 v[84:85], v[28:29], v[132:133], v[84:85] op_sel_hi:[1,0,1]
    v_pk_fma_f32 v[86:87], v[30:31], v[132:133], v[86:87] op_sel_hi:[1,0,1]
    v_exp_f32 v88, v80
    v_exp_f32 v89, v81
    v_exp_f32 v90, v82
    v_exp_f32 v91, v83
    v_exp_f32 v92, v84
    v_exp_f32 v93, v85
    v_exp_f32 v94, v86
    v_exp_f32 v95, v87
    v_pk_add_f32 v[156:157], v[88:89], 2.0 op_sel_hi:[1,0]
    v_pk_add_f32 v[158:159], v[90:91], 2.0 op_sel_hi:[1,0]
    v_pk_add_f32 v[160:161], v[92:93], 2.0 op_sel_hi:[1,0]
    v_pk_add_f32 v[162:163], v[94:95], 2.0 op_sel_hi:[1,0]
    v_pk_fma_f32 v[156:157], v[88:89], v[156:157], 2.0 op_sel_hi:[1,1,0]
    v_pk_fma_f32 v[158:159], v[90:91], v[158:159], 2.0 op_sel_hi:[1,1,0]
    v_pk_fma_f32 v[160:161], v[92:93], v[160:161], 2.0 op_sel_hi:[1,1,0]
    v_pk_fma_f32 v[162:163], v[94:95], v[162:163], 2.0 op_sel_hi:[1,1,0]
    v_rcp_f32 v156, v156
    v_rcp_f32 v157, v157
    v_rcp_f32 v158, v158
    v_rcp_f32 v159, v159
    v_rcp_f32 v160, v160
    v_rcp_f32 v161, v161
    v_rcp_f32 v162, v162
    v_rcp_f32 v163, v163
    v_pk_fma_f32 v[156:157], v[156:157], s[98:99], s[98:99] op_sel:[0,0,1] op_sel_hi:[1,0,1]
    v_pk_fma_f32 v[158:159], v[158:159], s[98:99], s[98:99] op_sel:[0,0,1] op_sel_hi:[1,0,1]
    v_pk_fma_f32 v[160:161], v[160:161], s[98:99], s[98:99] op_sel:[0,0,1] op_sel_hi:[1,0,1]
    v_pk_fma_f32 v[162:163], v[162:163], s[98:99], s[98:99] op_sel:[0,0,1] op_sel_hi:[1,0,1]
    v_pk_mul_f32 v[80:81], v[80:81], v[156:157]
    v_pk_mul_f32 v[82:83], v[82:83], v[158:159]
    v_pk_mul_f32 v[84:85], v[84:85], v[160:161]
    v_pk_mul_f32 v[86:87], v[86:87], v[162:163]
    v_cvt_pk_bf16_f32 v164, v80, v81
    v_cvt_pk_bf16_f32 v165, v82, v83
    v_cvt_pk_bf16_f32 v166, v84, v85
    v_cvt_pk_bf16_f32 v167, v86, v87
    buffer_store_dwordx4 v[164:167], v8, s[48:51], s70 offen offset:0 sc1
    v_pk_fma_f32 v[80:81], v[134:135], v[104:105], v[148:149] op_sel:[1,0,0]
    v_pk_fma_f32 v[82:83], v[134:135], v[106:107], v[150:151] op_sel:[1,0,0]
    v_pk_fma_f32 v[84:85], v[134:135], v[108:109], v[152:153] op_sel:[1,0,0]
    v_pk_fma_f32 v[86:87], v[134:135], v[110:111], v[154:155] op_sel:[1,0,0]
    v_pk_fma_f32 v[80:81], v[40:41], v[134:135], v[80:81] op_sel_hi:[1,0,1]
    v_pk_fma_f32 v[82:83], v[42:43], v[134:135], v[82:83] op_sel_hi:[1,0,1]
    v_pk_fma_f32 v[84:85], v[44:45], v[134:135], v[84:85] op_sel_hi:[1,0,1]
    v_pk_fma_f32 v[86:87], v[46:47], v[134:135], v[86:87] op_sel_hi:[1,0,1]
    v_exp_f32 v88, v80
    v_exp_f32 v89, v81
    v_exp_f32 v90, v82
    v_exp_f32 v91, v83
    v_exp_f32 v92, v84
    v_exp_f32 v93, v85
    v_exp_f32 v94, v86
    v_exp_f32 v95, v87
    v_pk_add_f32 v[156:157], v[88:89], 2.0 op_sel_hi:[1,0]
    v_pk_add_f32 v[158:159], v[90:91], 2.0 op_sel_hi:[1,0]
    v_pk_add_f32 v[160:161], v[92:93], 2.0 op_sel_hi:[1,0]
    v_pk_add_f32 v[162:163], v[94:95], 2.0 op_sel_hi:[1,0]
    v_pk_fma_f32 v[156:157], v[88:89], v[156:157], 2.0 op_sel_hi:[1,1,0]
    v_pk_fma_f32 v[158:159], v[90:91], v[158:159], 2.0 op_sel_hi:[1,1,0]
    v_pk_fma_f32 v[160:161], v[92:93], v[160:161], 2.0 op_sel_hi:[1,1,0]
    v_pk_fma_f32 v[162:163], v[94:95], v[162:163], 2.0 op_sel_hi:[1,1,0]
    v_rcp_f32 v156, v156
    v_rcp_f32 v157, v157
    v_rcp_f32 v158, v158
    v_rcp_f32 v159, v159
    v_rcp_f32 v160, v160
    v_rcp_f32 v161, v161
    v_rcp_f32 v162, v162
    v_rcp_f32 v163, v163
    v_pk_fma_f32 v[156:157], v[156:157], s[98:99], s[98:99] op_sel:[0,0,1] op_sel_hi:[1,0,1]
    v_pk_fma_f32 v[158:159], v[158:159], s[98:99], s[98:99] op_sel:[0,0,1] op_sel_hi:[1,0,1]
    v_pk_fma_f32 v[160:161], v[160:161], s[98:99], s[98:99] op_sel:[0,0,1] op_sel_hi:[1,0,1]
    v_pk_fma_f32 v[162:163], v[162:163], s[98:99], s[98:99] op_sel:[0,0,1] op_sel_hi:[1,0,1]
    v_pk_mul_f32 v[80:81], v[80:81], v[156:157]
    v_pk_mul_f32 v[82:83], v[82:83], v[158:159]
    v_pk_mul_f32 v[84:85], v[84:85], v[160:161]
    v_pk_mul_f32 v[86:87], v[86:87], v[162:163]
    v_cvt_pk_bf16_f32 v168, v80, v81
    v_cvt_pk_bf16_f32 v169, v82, v83
    v_cvt_pk_bf16_f32 v170, v84, v85
    v_cvt_pk_bf16_f32 v171, v86, v87
    buffer_store_dwordx4 v[168:171], v8, s[48:51], s70 offen offset:1024 sc1
    v_pk_fma_f32 v[80:81], v[136:137], v[104:105], v[148:149] op_sel:[1,0,0]
    v_pk_fma_f32 v[82:83], v[136:137], v[106:107], v[150:151] op_sel:[1,0,0]
    v_pk_fma_f32 v[84:85], v[136:137], v[108:109], v[152:153] op_sel:[1,0,0]
    v_pk_fma_f32 v[86:87], v[136:137], v[110:111], v[154:155] op_sel:[1,0,0]
    v_pk_fma_f32 v[80:81], v[56:57], v[136:137], v[80:81] op_sel_hi:[1,0,1]
    v_pk_fma_f32 v[82:83], v[58:59], v[136:137], v[82:83] op_sel_hi:[1,0,1]
    v_pk_fma_f32 v[84:85], v[60:61], v[136:137], v[84:85] op_sel_hi:[1,0,1]
    v_pk_fma_f32 v[86:87], v[62:63], v[136:137], v[86:87] op_sel_hi:[1,0,1]
    v_exp_f32 v88, v80
    v_exp_f32 v89, v81
    v_exp_f32 v90, v82
    v_exp_f32 v91, v83
    v_exp_f32 v92, v84
    v_exp_f32 v93, v85
    v_exp_f32 v94, v86
    v_exp_f32 v95, v87
    v_pk_add_f32 v[156:157], v[88:89], 2.0 op_sel_hi:[1,0]
    v_pk_add_f32 v[158:159], v[90:91], 2.0 op_sel_hi:[1,0]
    v_pk_add_f32 v[160:161], v[92:93], 2.0 op_sel_hi:[1,0]
    v_pk_add_f32 v[162:163], v[94:95], 2.0 op_sel_hi:[1,0]
    v_pk_fma_f32 v[156:157], v[88:89], v[156:157], 2.0 op_sel_hi:[1,1,0]
    v_pk_fma_f32 v[158:159], v[90:91], v[158:159], 2.0 op_sel_hi:[1,1,0]
    v_pk_fma_f32 v[160:161], v[92:93], v[160:161], 2.0 op_sel_hi:[1,1,0]
    v_pk_fma_f32 v[162:163], v[94:95], v[162:163], 2.0 op_sel_hi:[1,1,0]
    v_rcp_f32 v156, v156
    v_rcp_f32 v157, v157
    v_rcp_f32 v158, v158
    v_rcp_f32 v159, v159
    v_rcp_f32 v160, v160
    v_rcp_f32 v161, v161
    v_rcp_f32 v162, v162
    v_rcp_f32 v163, v163
    v_pk_fma_f32 v[156:157], v[156:157], s[98:99], s[98:99] op_sel:[0,0,1] op_sel_hi:[1,0,1]
    v_pk_fma_f32 v[158:159], v[158:159], s[98:99], s[98:99] op_sel:[0,0,1] op_sel_hi:[1,0,1]
    v_pk_fma_f32 v[160:161], v[160:161], s[98:99], s[98:99] op_sel:[0,0,1] op_sel_hi:[1,0,1]
    v_pk_fma_f32 v[162:163], v[162:163], s[98:99], s[98:99] op_sel:[0,0,1] op_sel_hi:[1,0,1]
    v_pk_mul_f32 v[80:81], v[80:81], v[156:157]
    v_pk_mul_f32 v[82:83], v[82:83], v[158:159]
    v_pk_mul_f32 v[84:85], v[84:85], v[160:161]
    v_pk_mul_f32 v[86:87], v[86:87], v[162:163]
    v_cvt_pk_bf16_f32 v164, v80, v81
    v_cvt_pk_bf16_f32 v165, v82, v83
    v_cvt_pk_bf16_f32 v166, v84, v85
    v_cvt_pk_bf16_f32 v167, v86, v87
    buffer_store_dwordx4 v[164:167], v8, s[48:51], s70 offen offset:2048 sc1
    v_pk_fma_f32 v[80:81], v[138:139], v[104:105], v[148:149] op_sel:[1,0,0]
    v_pk_fma_f32 v[82:83], v[138:139], v[106:107], v[150:151] op_sel:[1,0,0]
    v_pk_fma_f32 v[84:85], v[138:139], v[108:109], v[152:153] op_sel:[1,0,0]
    v_pk_fma_f32 v[86:87], v[138:139], v[110:111], v[154:155] op_sel:[1,0,0]
    v_pk_fma_f32 v[80:81], v[72:73], v[138:139], v[80:81] op_sel_hi:[1,0,1]
    v_pk_fma_f32 v[82:83], v[74:75], v[138:139], v[82:83] op_sel_hi:[1,0,1]
    v_pk_fma_f32 v[84:85], v[76:77], v[138:139], v[84:85] op_sel_hi:[1,0,1]
    v_pk_fma_f32 v[86:87], v[78:79], v[138:139], v[86:87] op_sel_hi:[1,0,1]
    v_exp_f32 v88, v80
    v_exp_f32 v89, v81
    v_exp_f32 v90, v82
    v_exp_f32 v91, v83
    v_exp_f32 v92, v84
    v_exp_f32 v93, v85
    v_exp_f32 v94, v86
    v_exp_f32 v95, v87
    v_pk_add_f32 v[156:157], v[88:89], 2.0 op_sel_hi:[1,0]
    v_pk_add_f32 v[158:159], v[90:91], 2.0 op_sel_hi:[1,0]
    v_pk_add_f32 v[160:161], v[92:93], 2.0 op_sel_hi:[1,0]
    v_pk_add_f32 v[162:163], v[94:95], 2.0 op_sel_hi:[1,0]
    v_pk_fma_f32 v[156:157], v[88:89], v[156:157], 2.0 op_sel_hi:[1,1,0]
    v_pk_fma_f32 v[158:159], v[90:91], v[158:159], 2.0 op_sel_hi:[1,1,0]
    v_pk_fma_f32 v[160:161], v[92:93], v[160:161], 2.0 op_sel_hi:[1,1,0]
    v_pk_fma_f32 v[162:163], v[94:95], v[162:163], 2.0 op_sel_hi:[1,1,0]
    v_rcp_f32 v156, v156
    v_rcp_f32 v157, v157
    v_rcp_f32 v158, v158
    v_rcp_f32 v159, v159
    v_rcp_f32 v160, v160
    v_rcp_f32 v161, v161
    v_rcp_f32 v162, v162
    v_rcp_f32 v163, v163
    v_pk_fma_f32 v[156:157], v[156:157], s[98:99], s[98:99] op_sel:[0,0,1] op_sel_hi:[1,0,1]
    v_pk_fma_f32 v[158:159], v[158:159], s[98:99], s[98:99] op_sel:[0,0,1] op_sel_hi:[1,0,1]
    v_pk_fma_f32 v[160:161], v[160:161], s[98:99], s[98:99] op_sel:[0,0,1] op_sel_hi:[1,0,1]
    v_pk_fma_f32 v[162:163], v[162:163], s[98:99], s[98:99] op_sel:[0,0,1] op_sel_hi:[1,0,1]
    v_pk_mul_f32 v[80:81], v[80:81], v[156:157]
    v_pk_mul_f32 v[82:83], v[82:83], v[158:159]
    v_pk_mul_f32 v[84:85], v[84:85], v[160:161]
    v_pk_mul_f32 v[86:87], v[86:87], v[162:163]
    v_cvt_pk_bf16_f32 v168, v80, v81
    v_cvt_pk_bf16_f32 v169, v82, v83
    v_cvt_pk_bf16_f32 v170, v84, v85
    v_cvt_pk_bf16_f32 v171, v86, v87
    buffer_store_dwordx4 v[168:171], v8, s[48:51], s70 offen offset:3072 sc1
    s_waitcnt vmcnt(0)
    v_lshlrev_b32 v14, 2, v0
    v_mov_b32 v15, s77
    s_mov_b64 exec, 3
    buffer_store_dword v15, v14, s[48:51], s71 offen offset:0 sc1
    s_mov_b64 exec, -1
    v_mov_b32 v14, 163352
    v_mov_b32 v15, 1
    s_mov_b64 exec, 1
    ds_add_u32 v14, v15
    s_mov_b64 exec, -1
    s_lshl_b32 s8, s7, 2
    s_add_u32 s8, s8, 163364
    v_mov_b32 v4, s8
    s_lshl_b32 s8, s7, 13
    s_add_u32 s8, s8, 143360
    v_add_u32 v3, s8, v8
    s_mov_b32 s8, 0
Ls_pq_101:
    ds_read_b32 v15, v4
    s_add_u32 s8, s8, 1
    s_cmp_ge_u32 s8, 100000
    s_cbranch_scc1 Lsd_pq_102
    s_waitcnt lgkmcnt(0)
    v_cmp_eq_u32 vcc, 0, v15
    s_cbranch_vccnz Ls_pq_101
Lsd_pq_102:
    s_waitcnt lgkmcnt(0)
    ds_read_b128 v[16:19], v3 offset:0
    ds_read_b128 v[20:23], v3 offset:1024
    ds_read_b128 v[24:27], v3 offset:2048
    ds_read_b128 v[28:31], v3 offset:3072
    ds_read_b128 v[32:35], v3 offset:4096
    ds_read_b128 v[36:39], v3 offset:5120
    v_mov_b32 v40, 0
    v_mov_b32 v41, 0
    v_mov_b32 v42, 0
    v_mov_b32 v43, 0
    s_waitcnt lgkmcnt(0)
    ds_write_b128 v3, v[40:43] offset:0
    ds_write_b128 v3, v[40:43] offset:1024
    ds_write_b128 v3, v[40:43] offset:2048
    ds_write_b128 v3, v[40:43] offset:3072
    ds_write_b128 v3, v[40:43] offset:4096
    ds_write_b128 v3, v[40:43] offset:5120
    ds_write_b128 v3, v[40:43] offset:6144
    ds_write_b128 v3, v[40:43] offset:7168
    v_mov_b32 v3, 163372
    v_mov_b32 v4, 1
    s_waitcnt lgkmcnt(0)
    s_mov_b64 exec, 1
    ds_add_u32 v3, v4
    s_mov_b64 exec, -1
L_kvg:
    s_lshl_b32 s9, s4, 1
    s_sub_u32 s9, 8, s9
    v_mov_b32 v14, 163352
    s_mov_b32 s8, 0
Ls_pub_103:
    ds_read_b32 v15, v14
    s_add_u32 s8, s8, 1
    s_cmp_ge_u32 s8, 100000
    s_cbranch_scc1 Lsd_pub_104
    s_waitcnt lgkmcnt(0)
    v_cmp_gt_u32 vcc, s9, v15
    s_cbranch_vccnz Ls_pub_103
Lsd_pub_104:
    s_waitcnt lgkmcnt(0)
    s_mov_b32 s8, 0
    s_branch Lchk_rpl_106
Lpoll_rpl_105:
    buffer_load_dword v13, v12, s[48:51], 0 offen sc1
    s_waitcnt vmcnt(0)
Lchk_rpl_106:
    s_add_u32 s8, s8, 1
    s_cmp_ge_u32 s8, 100000
    s_cbranch_scc1 Ldone_rpl_107
    v_cmp_ne_u32 vcc, s77, v13
    s_cbranch_vccnz Lpoll_rpl_105
Ldone_rpl_107:
    s_mul_i32 s8, s79, 68
    s_add_u32 s8, s8, s91
    s_mul_i32 s8, s8, 5120
    s_add_u32 s83, s8, 10485760
    buffer_load_dwordx4 v[156:159], v8, s[48:51], s83 offen offset:0 sc1
    buffer_load_dwordx4 v[160:163], v8, s[48:51], s83 offen offset:1024 sc1
    buffer_load_dwordx4 v[164:167], v8, s[48:51], s83 offen offset:2048 sc1
    buffer_load_dwordx4 v[168:171], v8, s[48:51], s83 offen offset:3072 sc1
    buffer_load_dwordx4 v[172:175], v9, s[48:51], s83 offen offset:0 sc1
    s_add_u32 s83, s83, 5120
    buffer_load_dwordx4 v[176:179], v8, s[48:51], s83 offen offset:0 sc1
    buffer_load_dwordx4 v[180:183], v8, s[48:51], s83 offen offset:1024 sc1
    buffer_load_dwordx4 v[184:187], v8, s[48:51], s83 offen offset:2048 sc1
    buffer_load_dwordx4 v[188:191], v8, s[48:51], s83 offen offset:3072 sc1
    buffer_load_dwordx4 v[192:195], v9, s[48:51], s83 offen offset:0 sc1
    s_add_u32 s83, s83, 5120
    s_mul_i32 s8, s5, 768
    s_add_u32 s8, s8, 589824
    v_lshl_add_u32 v12, v0, 2, s8
    s_lshl_b32 s8, s3, 7
    v_lshl_add_u32 v127, v0, 1, s8
    v_add_u32 v128, 1, v127
    v_mul_u32_u24 v116, 2622, v127
    v_lshrrev_b32 v116, 16, v116
    v_mul_u32_u24 v117, 25, v116
    v_sub_u32 v117, v127, v117
    v_mul_u32_u24 v118, 205, v116
    v_lshrrev_b32 v118, 10, v118
    v_lshrrev_b32 v119, 3, v116
    v_mul_u32_u24 v120, 20, v118
    v_add_u32 v120, v120, v117
    v_lshrrev_b32 v121, 4, v120
    v_and_b32 v120, 15, v120
    v_lshl_add_u32 v122, v121, 1, v119
    v_cmp_le_u32 vcc, 3, v121
    s_nop 1
    v_subbrev_co_u32 v122, vcc, 0, v122, vcc
    v_mul_u32_u24 v123, 5, v118
    v_add_u32 v123, v123, v117
    v_subrev_u32 v123, 20, v123
    v_lshrrev_b32 v124, 2, v123
    v_and_b32 v123, 3, v123
    v_lshlrev_b32 v123, 2, v123
    v_and_b32 v125, 3, v124
    v_add_u32 v123, v123, v125
    v_lshrrev_b32 v124, 2, v124
    v_lshl_add_u32 v124, v124, 1, v119
    v_add_u32 v124, 10, v124
    v_cmp_le_u32 vcc, 20, v117
    s_nop 1
    v_cndmask_b32 v122, v122, v124, vcc
    v_cndmask_b32 v120, v120, v123, vcc
    v_and_b32 v123, 3, v116
    v_lshl_add_u32 v120, v123, 4, v120
    v_lshl_add_u32 v120, v122, 6, v120
    v_bfe_u32 v123, v116, 2, 1
    v_lshl_add_u32 v120, v120, 1, v123
    v_lshlrev_b32 v120, 3, v120
    v_add_u32 v120, 143360, v120
    v_mov_b32 v123, 163392
    v_cmp_gt_u32 vcc, 500, v127
    s_nop 1
    v_cndmask_b32 v152, v123, v120, vcc
    v_mul_u32_u24 v116, 2622, v128
    v_lshrrev_b32 v116, 16, v116
    v_mul_u32_u24 v117, 25, v116
    v_sub_u32 v117, v128, v117
    v_mul_u32_u24 v118, 205, v116
    v_lshrrev_b32 v118, 10, v118
    v_lshrrev_b32 v119, 3, v116
    v_mul_u32_u24 v120, 20, v118
    v_add_u32 v120, v120, v117
    v_lshrrev_b32 v121, 4, v120
    v_and_b32 v120, 15, v120
    v_lshl_add_u32 v122, v121, 1, v119
    v_cmp_le_u32 vcc, 3, v121
    s_nop 1
    v_subbrev_co_u32 v122, vcc, 0, v122, vcc
    v_mul_u32_u24 v123, 5, v118
    v_add_u32 v123, v123, v117
    v_subrev_u32 v123, 20, v123
    v_lshrrev_b32 v124, 2, v123
    v_and_b32 v123, 3, v123
    v_lshlrev_b32 v123, 2, v123
    v_and_b32 v125, 3, v124
    v_add_u32 v123, v123, v125
    v_lshrrev_b32 v124, 2, v124
    v_lshl_add_u32 v124, v124, 1, v119
    v_add_u32 v124, 10, v124
    v_cmp_le_u32 vcc, 20, v117
    s_nop 1
    v_cndmask_b32 v122, v122, v124, vcc
    v_cndmask_b32 v120, v120, v123, vcc
    v_and_b32 v123, 3, v116
    v_lshl_add_u32 v120, v123, 4, v120
    v_lshl_add_u32 v120, v122, 6, v120
    v_bfe_u32 v123, v116, 2, 1
    v_lshl_add_u32 v120, v120, 1, v123
    v_lshlrev_b32 v120, 3, v120
    v_add_u32 v120, 143360, v120
    v_mov_b32 v123, 163392
    v_cmp_gt_u32 vcc, 500, v128
    s_nop 1
    v_cndmask_b32 v153, v123, v120, vcc
    s_lshr_b32 s8, s5, 1
    s_mul_i32 s9, s8, 17
    s_and_b32 s13, s5, 1
    s_lshl_b32 s8, s13, 1
    s_add_u32 s9, s9, s8
    s_add_u32 s9, s9, 12
    s_lshl_b32 s10, s6, 1
    s_add_u32 s10, s10, s7
    s_mul_i32 s11, s10, 768
    s_lshl_b32 s12, s9, 2
    s_add_u32 s11, s11, s12
    s_add_u32 s71, s11, 655360
    s_mul_i32 s10, s10, 68
    s_add_u32 s10, s10, s9
    s_lshl_b32 s10, s10, 12
    s_add_u32 s70, s10, 1048576
    s_lshl_b32 s8, s80, 11
    s_add_u32 s70, s70, s8
    s_mul_i32 s8, s13, 4294959616
    s_add_u32 s72, s70, s8
    s_add_u32 s72, s72, 16384
    s_lshl_b32 s8, s6, 1
    s_add_u32 s8, s8, s7
    s_mul_i32 s8, s8, 768
    s_lshl_b32 s9, s5, 1
    s_add_u32 s9, s9, s80
    s_lshl_b32 s9, s9, 2
    s_add_u32 s8, s8, s9
    s_add_u32 s71, s8, 819200
    v_mov_b32 v3, 163372
    s_mov_b32 s8, 0
Ls_zf_108:
    ds_read_b32 v15, v3
    s_add_u32 s8, s8, 1
    s_cmp_ge_u32 s8, 100000
    s_cbranch_scc1 Lsd_zf_109
    s_waitcnt lgkmcnt(0)
    v_cmp_gt_u32 vcc, 2, v15
    s_cbranch_vccnz Ls_zf_108
Lsd_zf_109:
    s_waitcnt lgkmcnt(0)
    s_setprio 3
    v_mov_b32 v4, 163344
    s_cmp_eq_u32 s3, 0
    s_cbranch_scc0 Lokv_110
    s_mov_b32 s8, 0
Lpoll_kv_112:
    buffer_load_dword v13, v12, s[48:51], 0 offen sc1
    s_waitcnt vmcnt(0)
Lchk_kv_113:
    s_add_u32 s8, s8, 1
    s_cmp_ge_u32 s8, 100000
    s_cbranch_scc1 Ldone_kv_114
    v_cmp_ne_u32 vcc, s77, v13
    s_cbranch_vccnz Lpoll_kv_112
Ldone_kv_114:
    ds_write_b32 v4, v11
    s_branch Lokv_111
Lokv_110:
    s_mov_b32 s8, 0
Ls_kvp_115:
    ds_read_b32 v15, v4
    s_add_u32 s8, s8, 1
    s_cmp_ge_u32 s8, 100000
    s_cbranch_scc1 Lsd_kvp_116
    s_waitcnt lgkmcnt(0)
    v_cmp_eq_u32 vcc, 0, v15
    s_cbranch_vccnz Ls_kvp_115
Lsd_kvp_116:
    s_waitcnt lgkmcnt(0)
Lokv_111:
    s_lshl_b32 s8, s3, 10
    v_add_u32 v3, s8, v8
    s_lshl_b32 s9, s5, 16
    s_add_u32 s9, s9, 65536
    buffer_load_dwordx4 v[40:43], v3, s[48:51], s9 offen sc1
    s_add_u32 s9, s9, 4096
    buffer_load_dwordx4 v[44:47], v3, s[48:51], s9 offen sc1
    s_add_u32 s9, s9, 4096
    buffer_load_dwordx4 v[48:51], v3, s[48:51], s9 offen sc1
    s_add_u32 s9, s9, 4096
    buffer_load_dwordx4 v[52:55], v3, s[48:51], s9 offen sc1
    s_add_u32 s9, s9, 4096
    buffer_load_dwordx4 v[56:59], v3, s[48:51], s9 offen sc1
    s_add_u32 s9, s9, 4096
    buffer_load_dwordx4 v[60:63], v3, s[48:51], s9 offen sc1
    s_add_u32 s9, s9, 4096
    buffer_load_dwordx4 v[64:67], v3, s[48:51], s9 offen sc1
    s_add_u32 s9, s9, 4096
    buffer_load_dwordx4 v[68:71], v3, s[48:51], s9 offen sc1
    s_add_u32 s9, s9, 4096
    buffer_load_dwordx4 v[72:75], v3, s[48:51], s9 offen sc1
    s_add_u32 s9, s9, 4096
    buffer_load_dwordx4 v[76:79], v3, s[48:51], s9 offen sc1
    s_add_u32 s9, s9, 4096
    buffer_load_dwordx4 v[80:83], v3, s[48:51], s9 offen sc1
    s_add_u32 s9, s9, 4096
    buffer_load_dwordx4 v[84:87], v3, s[48:51], s9 offen sc1
    s_add_u32 s9, s9, 4096
    buffer_load_dwordx4 v[88:91], v3, s[48:51], s9 offen sc1
    s_add_u32 s9, s9, 4096
    buffer_load_dwordx4 v[92:95], v3, s[48:51], s9 offen sc1
    s_add_u32 s9, s9, 4096
    buffer_load_dwordx4 v[96:99], v3, s[48:51], s9 offen sc1
    s_add_u32 s9, s9, 4096
    buffer_load_dwordx4 v[100:103], v3, s[48:51], s9 offen sc1
    v_mov_b32 v3, 163388
    v_mov_b32 v4, 1
    s_mov_b64 exec, 1
    ds_add_u32 v3, v4
    s_mov_b64 exec, -1
    s_mov_b32 s10, 0x00003f80
    s_mov_b32 s11, 0x3f800000
    v_mov_b32 v104, 0
    v_mov_b32 v105, 0
    v_mov_b32 v106, 0
    v_mov_b32 v107, 0
    v_mov_b32 v108, 0
    v_mov_b32 v109, 0
    v_mov_b32 v110, 0
    v_mov_b32 v111, 0
    s_waitcnt vmcnt(15)
    v_dot2c_f32_bf16 v104, s10, v40
    v_dot2c_f32_bf16 v106, s10, v41
    v_dot2c_f32_bf16 v108, s10, v42
    v_dot2c_f32_bf16 v110, s10, v43
    v_dot2c_f32_bf16 v105, s11, v40
    v_dot2c_f32_bf16 v107, s11, v41
    v_dot2c_f32_bf16 v109, s11, v42
    v_dot2c_f32_bf16 v111, s11, v43
    s_waitcnt vmcnt(14)
    v_dot2c_f32_bf16 v104, s10, v44
    v_dot2c_f32_bf16 v106, s10, v45
    v_dot2c_f32_bf16 v108, s10, v46
    v_dot2c_f32_bf16 v110, s10, v47
    v_dot2c_f32_bf16 v105, s11, v44
    v_dot2c_f32_bf16 v107, s11, v45
    v_dot2c_f32_bf16 v109, s11, v46
    v_dot2c_f32_bf16 v111, s11, v47
    s_waitcnt vmcnt(13)
    v_dot2c_f32_bf16 v104, s10, v48
    v_dot2c_f32_bf16 v106, s10, v49
    v_dot2c_f32_bf16 v108, s10, v50
    v_dot2c_f32_bf16 v110, s10, v51
    v_dot2c_f32_bf16 v105, s11, v48
    v_dot2c_f32_bf16 v107, s11, v49
    v_dot2c_f32_bf16 v109, s11, v50
    v_dot2c_f32_bf16 v111, s11, v51
    s_waitcnt vmcnt(12)
    v_dot2c_f32_bf16 v104, s10, v52
    v_dot2c_f32_bf16 v106, s10, v53
    v_dot2c_f32_bf16 v108, s10, v54
    v_dot2c_f32_bf16 v110, s10, v55
    v_dot2c_f32_bf16 v105, s11, v52
    v_dot2c_f32_bf16 v107, s11, v53
    v_dot2c_f32_bf16 v109, s11, v54
    v_dot2c_f32_bf16 v111, s11, v55
    s_waitcnt vmcnt(11)
    v_dot2c_f32_bf16 v104, s10, v56
    v_dot2c_f32_bf16 v106, s10, v57
    v_dot2c_f32_bf16 v108, s10, v58
    v_dot2c_f32_bf16 v110, s10, v59
    v_dot2c_f32_bf16 v105, s11, v56
    v_dot2c_f32_bf16 v107, s11, v57
    v_dot2c_f32_bf16 v109, s11, v58
    v_dot2c_f32_bf16 v111, s11, v59
    s_waitcnt vmcnt(10)
    v_dot2c_f32_bf16 v104, s10, v60
    v_dot2c_f32_bf16 v106, s10, v61
    v_dot2c_f32_bf16 v108, s10, v62
    v_dot2c_f32_bf16 v110, s10, v63
    v_dot2c_f32_bf16 v105, s11, v60
    v_dot2c_f32_bf16 v107, s11, v61
    v_dot2c_f32_bf16 v109, s11, v62
    v_dot2c_f32_bf16 v111, s11, v63
    s_waitcnt vmcnt(9)
    v_dot2c_f32_bf16 v104, s10, v64
    v_dot2c_f32_bf16 v106, s10, v65
    v_dot2c_f32_bf16 v108, s10, v66
    v_dot2c_f32_bf16 v110, s10, v67
    v_dot2c_f32_bf16 v105, s11, v64
    v_dot2c_f32_bf16 v107, s11, v65
    v_dot2c_f32_bf16 v109, s11, v66
    v_dot2c_f32_bf16 v111, s11, v67
    s_waitcnt vmcnt(8)
    v_dot2c_f32_bf16 v104, s10, v68
    v_dot2c_f32_bf16 v106, s10, v69
    v_dot2c_f32_bf16 v108, s10, v70
    v_dot2c_f32_bf16 v110, s10, v71
    v_dot2c_f32_bf16 v105, s11, v68
    v_dot2c_f32_bf16 v107, s11, v69
    v_dot2c_f32_bf16 v109, s11, v70
    v_dot2c_f32_bf16 v111, s11, v71
    s_waitcnt vmcnt(7)
    v_dot2c_f32_bf16 v104, s10, v72
    v_dot2c_f32_bf16 v106, s10, v73
    v_dot2c_f32_bf16 v108, s10, v74
    v_dot2c_f32_bf16 v110, s10, v75
    v_dot2c_f32_bf16 v105, s11, v72
    v_dot2c_f32_bf16 v107, s11, v73
    v_dot2c_f32_bf16 v109, s11, v74
    v_dot2c_f32_bf16 v111, s11, v75
    s_waitcnt vmcnt(6)
    v_dot2c_f32_bf16 v104, s10, v76
    v_dot2c_f32_bf16 v106, s10, v77
    v_dot2c_f32_bf16 v108, s10, v78
    v_dot2c_f32_bf16 v110, s10, v79
    v_dot2c_f32_bf16 v105, s11, v76
    v_dot2c_f32_bf16 v107, s11, v77
    v_dot2c_f32_bf16 v109, s11, v78
    v_dot2c_f32_bf16 v111, s11, v79
    s_waitcnt vmcnt(5)
    v_dot2c_f32_bf16 v104, s10, v80
    v_dot2c_f32_bf16 v106, s10, v81
    v_dot2c_f32_bf16 v108, s10, v82
    v_dot2c_f32_bf16 v110, s10, v83
    v_dot2c_f32_bf16 v105, s11, v80
    v_dot2c_f32_bf16 v107, s11, v81
    v_dot2c_f32_bf16 v109, s11, v82
    v_dot2c_f32_bf16 v111, s11, v83
    s_waitcnt vmcnt(4)
    v_dot2c_f32_bf16 v104, s10, v84
    v_dot2c_f32_bf16 v106, s10, v85
    v_dot2c_f32_bf16 v108, s10, v86
    v_dot2c_f32_bf16 v110, s10, v87
    v_dot2c_f32_bf16 v105, s11, v84
    v_dot2c_f32_bf16 v107, s11, v85
    v_dot2c_f32_bf16 v109, s11, v86
    v_dot2c_f32_bf16 v111, s11, v87
    s_waitcnt vmcnt(3)
    v_dot2c_f32_bf16 v104, s10, v88
    v_dot2c_f32_bf16 v106, s10, v89
    v_dot2c_f32_bf16 v108, s10, v90
    v_dot2c_f32_bf16 v110, s10, v91
    v_dot2c_f32_bf16 v105, s11, v88
    v_dot2c_f32_bf16 v107, s11, v89
    v_dot2c_f32_bf16 v109, s11, v90
    v_dot2c_f32_bf16 v111, s11, v91
    s_waitcnt vmcnt(2)
    v_dot2c_f32_bf16 v104, s10, v92
    v_dot2c_f32_bf16 v106, s10, v93
    v_dot2c_f32_bf16 v108, s10, v94
    v_dot2c_f32_bf16 v110, s10, v95
    v_dot2c_f32_bf16 v105, s11, v92
    v_dot2c_f32_bf16 v107, s11, v93
    v_dot2c_f32_bf16 v109, s11, v94
    v_dot2c_f32_bf16 v111, s11, v95
    s_waitcnt vmcnt(1)
    v_dot2c_f32_bf16 v104, s10, v96
    v_dot2c_f32_bf16 v106, s10, v97
    v_dot2c_f32_bf16 v108, s10, v98
    v_dot2c_f32_bf16 v110, s10, v99
    v_dot2c_f32_bf16 v105, s11, v96
    v_dot2c_f32_bf16 v107, s11, v97
    v_dot2c_f32_bf16 v109, s11, v98
    v_dot2c_f32_bf16 v111, s11, v99
    s_waitcnt vmcnt(0)
    v_dot2c_f32_bf16 v104, s10, v100
    v_dot2c_f32_bf16 v106, s10, v101
    v_dot2c_f32_bf16 v108, s10, v102
    v_dot2c_f32_bf16 v110, s10, v103
    v_dot2c_f32_bf16 v105, s11, v100
    v_dot2c_f32_bf16 v107, s11, v101
    v_dot2c_f32_bf16 v109, s11, v102
    v_dot2c_f32_bf16 v111, s11, v103
    v_cvt_pk_bf16_f32 v40, v104, v105
    v_cvt_pk_bf16_f32 v41, v106, v107
    v_cvt_pk_bf16_f32 v42, v108, v109
    v_cvt_pk_bf16_f32 v43, v110, v111
    ds_write_b64 v152, v[40:41]
    ds_write_b64 v153, v[42:43]
    v_mov_b32 v3, 163360
    v_mov_b32 v4, 1
    s_waitcnt lgkmcnt(0)
    s_mov_b64 exec, 1
    ds_add_u32 v3, v4
    s_mov_b64 exec, -1
    v_add_u32 v4, 143360, v8
    v_lshlrev_b32 v5, 3, v0
    s_mov_b32 s8, 0
Ls_kvf_117:
    ds_read_b32 v15, v3
    s_add_u32 s8, s8, 1
    s_cmp_ge_u32 s8, 100000
    s_cbranch_scc1 Lsd_kvf_118
    s_waitcnt lgkmcnt(0)
    v_cmp_gt_u32 vcc, 4, v15
    s_cbranch_vccnz Ls_kvf_117
Lsd_kvf_118:
    s_waitcnt lgkmcnt(0)
    ds_read_b128 v[40:43], v4 offset:10240
    ds_read_b128 v[44:47], v4 offset:11264
    ds_read_b128 v[48:51], v4 offset:12288
    ds_read_b128 v[52:55], v4 offset:13312
    ds_read_b128 v[56:59], v4 offset:14336
    ds_read_b128 v[60:63], v4 offset:0
    ds_read_b128 v[64:67], v4 offset:2048
    ds_read_b128 v[68:71], v4 offset:3072
    ds_read_b128 v[72:75], v4 offset:4096
    ds_read_b128 v[76:79], v4 offset:5120
    ds_read_b128 v[80:83], v4 offset:6144
    ds_read_b128 v[84:87], v4 offset:7168
    ds_read_b128 v[88:91], v4 offset:8192
    ds_read_b128 v[92:95], v4 offset:9216
    s_waitcnt lgkmcnt(13)
    v_mfma_f32_16x16x32_bf16 v[116:119], v[40:43], v[16:19], 0
    s_waitcnt lgkmcnt(12)
    v_mfma_f32_16x16x32_bf16 v[116:119], v[44:47], v[20:23], v[116:119]
    s_waitcnt lgkmcnt(11)
    v_mfma_f32_16x16x32_bf16 v[116:119], v[48:51], v[24:27], v[116:119]
    s_waitcnt lgkmcnt(10)
    v_mfma_f32_16x16x32_bf16 v[120:123], v[52:55], v[20:23], 0
    s_waitcnt lgkmcnt(9)
    v_mfma_f32_16x16x32_bf16 v[120:123], v[56:59], v[24:27], v[120:123]
    s_waitcnt lgkmcnt(8)
    v_mfma_f32_16x16x32_bf16 v[96:99], v[60:63], v[16:19], 0
    s_waitcnt lgkmcnt(7)
    v_mfma_f32_16x16x32_bf16 v[100:103], v[64:67], v[16:19], 0
    s_waitcnt lgkmcnt(6)
    v_mfma_f32_16x16x32_bf16 v[100:103], v[68:71], v[20:23], v[100:103]
    s_waitcnt lgkmcnt(5)
    v_mfma_f32_16x16x32_bf16 v[104:107], v[72:75], v[16:19], 0
    s_waitcnt lgkmcnt(4)
    v_mfma_f32_16x16x32_bf16 v[104:107], v[76:79], v[20:23], v[104:107]
    s_waitcnt lgkmcnt(3)
    v_mfma_f32_16x16x32_bf16 v[108:111], v[80:83], v[20:23], 0
    s_waitcnt lgkmcnt(2)
    v_mfma_f32_16x16x32_bf16 v[108:111], v[84:87], v[24:27], v[108:111]
    s_waitcnt lgkmcnt(1)
    v_mfma_f32_16x16x32_bf16 v[112:115], v[88:91], v[20:23], 0
    s_waitcnt lgkmcnt(0)
    v_mfma_f32_16x16x32_bf16 v[112:115], v[92:95], v[24:27], v[112:115]
    v_mfma_f32_16x16x32_bf16 v[144:147], v[40:43], v[28:31], 0
    v_mfma_f32_16x16x32_bf16 v[144:147], v[44:47], v[32:35], v[144:147]
    v_mfma_f32_16x16x32_bf16 v[144:147], v[48:51], v[36:39], v[144:147]
    v_mfma_f32_16x16x32_bf16 v[148:151], v[52:55], v[32:35], 0
    v_mfma_f32_16x16x32_bf16 v[148:151], v[56:59], v[36:39], v[148:151]
    v_mfma_f32_16x16x32_bf16 v[124:127], v[60:63], v[28:31], 0
    v_add_f32 v116, s101, v116
    v_add_f32 v117, s101, v117
    v_add_f32 v118, s101, v118
    v_mfma_f32_16x16x32_bf16 v[128:131], v[64:67], v[28:31], 0
    v_add_f32 v119, s101, v119
    v_add_f32 v120, s101, v120
    v_rcp_f32 v116, v116
    v_mfma_f32_16x16x32_bf16 v[128:131], v[68:71], v[32:35], v[128:131]
    v_rcp_f32 v117, v117
    v_rcp_f32 v118, v118
    v_rcp_f32 v119, v119
    v_mfma_f32_16x16x32_bf16 v[132:135], v[72:75], v[28:31], 0
    v_rcp_f32 v120, v120
    v_pk_mul_f32 v[96:97], v[96:97], v[116:117] op_sel_hi:[1,0]
    v_pk_mul_f32 v[98:99], v[98:99], v[116:117] op_sel_hi:[1,0]
    v_mfma_f32_16x16x32_bf16 v[132:135], v[76:79], v[32:35], v[132:135]
    v_cvt_pk_bf16_f32 v96, v96, v97
    v_cvt_pk_bf16_f32 v97, v98, v99
    v_pk_mul_f32 v[100:101], v[100:101], v[116:117] op_sel:[0,1]
    v_mfma_f32_16x16x32_bf16 v[136:139], v[80:83], v[32:35], 0
    v_pk_mul_f32 v[102:103], v[102:103], v[116:117] op_sel:[0,1]
    v_cvt_pk_bf16_f32 v98, v100, v101
    v_cvt_pk_bf16_f32 v99, v102, v103
    v_mfma_f32_16x16x32_bf16 v[136:139], v[84:87], v[36:39], v[136:139]
    buffer_store_dwordx4 v[96:99], v8, s[48:51], s70 offen offset:0 sc1
    v_pk_mul_f32 v[104:105], v[104:105], v[118:119] op_sel_hi:[1,0]
    v_pk_mul_f32 v[106:107], v[106:107], v[118:119] op_sel_hi:[1,0]
    v_mfma_f32_16x16x32_bf16 v[140:143], v[88:91], v[32:35], 0
    v_cvt_pk_bf16_f32 v104, v104, v105
    v_cvt_pk_bf16_f32 v105, v106, v107
    v_pk_mul_f32 v[108:109], v[108:109], v[118:119] op_sel:[0,1]
    v_mfma_f32_16x16x32_bf16 v[140:143], v[92:95], v[36:39], v[140:143]
    v_pk_mul_f32 v[110:111], v[110:111], v[118:119] op_sel:[0,1]
    v_cvt_pk_bf16_f32 v106, v108, v109
    v_cvt_pk_bf16_f32 v107, v110, v111
    buffer_store_dwordx4 v[104:107], v9, s[48:51], s70 offen offset:0 sc1
    v_pk_mul_f32 v[112:113], v[112:113], v[120:121] op_sel_hi:[1,0]
    v_pk_mul_f32 v[114:115], v[114:115], v[120:121] op_sel_hi:[1,0]
    v_cvt_pk_bf16_f32 v112, v112, v113
    v_cvt_pk_bf16_f32 v113, v114, v115
    buffer_store_dwordx2 v[112:113], v5, s[48:51], s72 offen offset:0 sc1
    v_add_f32 v144, s101, v144
    v_add_f32 v145, s101, v145
    v_add_f32 v146, s101, v146
    v_add_f32 v147, s101, v147
    v_add_f32 v148, s101, v148
    v_rcp_f32 v144, v144
    v_rcp_f32 v145, v145
    v_rcp_f32 v146, v146
    v_rcp_f32 v147, v147
    v_rcp_f32 v148, v148
    v_pk_mul_f32 v[124:125], v[124:125], v[144:145] op_sel_hi:[1,0]
    v_pk_mul_f32 v[126:127], v[126:127], v[144:145] op_sel_hi:[1,0]
    v_cvt_pk_bf16_f32 v124, v124, v125
    v_cvt_pk_bf16_f32 v125, v126, v127
    v_pk_mul_f32 v[128:129], v[128:129], v[144:145] op_sel:[0,1]
    v_pk_mul_f32 v[130:131], v[130:131], v[144:145] op_sel:[0,1]
    v_cvt_pk_bf16_f32 v126, v128, v129
    v_cvt_pk_bf16_f32 v127, v130, v131
    buffer_store_dwordx4 v[124:127], v8, s[48:51], s70 offen offset:1024 sc1
    v_pk_mul_f32 v[132:133], v[132:133], v[146:147] op_sel_hi:[1,0]
    v_pk_mul_f32 v[134:135], v[134:135], v[146:147] op_sel_hi:[1,0]
    v_cvt_pk_bf16_f32 v132, v132, v133
    v_cvt_pk_bf16_f32 v133, v134, v135
    v_pk_mul_f32 v[136:137], v[136:137], v[146:147] op_sel:[0,1]
    v_pk_mul_f32 v[138:139], v[138:139], v[146:147] op_sel:[0,1]
    v_cvt_pk_bf16_f32 v134, v136, v137
    v_cvt_pk_bf16_f32 v135, v138, v139
    buffer_store_dwordx4 v[132:135], v9, s[48:51], s70 offen offset:1024 sc1
    v_pk_mul_f32 v[140:141], v[140:141], v[148:149] op_sel_hi:[1,0]
    v_pk_mul_f32 v[142:143], v[142:143], v[148:149] op_sel_hi:[1,0]
    v_cvt_pk_bf16_f32 v140, v140, v141
    v_cvt_pk_bf16_f32 v141, v142, v143
    buffer_store_dwordx2 v[140:141], v5, s[48:51], s72 offen offset:1024 sc1
    v_mov_b32 v4, 1
    s_mov_b64 exec, 1
    ds_add_u32 v3, v4
    s_mov_b64 exec, -1
    s_waitcnt vmcnt(0)
    v_lshlrev_b32 v14, 2, v0
    v_mov_b32 v15, s77
    s_mov_b64 exec, 1
    buffer_store_dword v15, v14, s[48:51], s71 offen offset:0 sc1
    s_mov_b64 exec, -1
    s_setprio 0
L_p2late:
    s_mov_b32 s56, s30
    s_mov_b32 s57, s31
    s_mov_b32 s58, 2621440
    s_mov_b32 s59, 0x20000
    s_add_u32 s82, s3, s79
    s_and_b32 s82, s82, 3
    s_mul_i32 s8, s78, 81920
    s_mul_i32 s9, s79, 160
    s_add_u32 s8, s8, s9
    s_mul_i32 s9, s82, 20480
    s_add_u32 s70, s8, s9
    v_and_b32 v14, 15, v0
    v_mul_u32_u24 v14, 1280, v14
    v_bfe_u32 v15, v0, 4, 1
    v_lshl_add_u32 v3, v15, 5, v14
    v_lshrrev_b32 v15, 5, v0
    v_lshl_add_u32 v3, v15, 4, v3
    v_lshrrev_b32 v15, 4, v0
    v_lshl_add_u32 v4, v15, 3, v14
    s_mul_i32 s8, s78, 768
    s_lshl_b32 s9, s3, 4
    s_add_u32 s8, s8, s9
    s_add_u32 s8, s8, 819200
    v_and_b32 v14, 15, v0
    v_lshl_add_u32 v12, v14, 2, s8
    s_mul_i32 s8, s78, 68
    s_add_u32 s8, s8, s91
    s_lshl_b32 s8, s8, 12
    s_add_u32 s92, s8, 1048576
    s_add_u32 s8, s82, 1
    s_and_b32 s8, s8, 3
    s_lshl_b32 s8, s8, 10
    s_add_u32 s87, s92, s8
    s_add_u32 s8, s82, 2
    s_and_b32 s8, s8, 3
    s_lshl_b32 s8, s8, 10
    s_add_u32 s88, s92, s8
    s_add_u32 s8, s82, 3
    s_and_b32 s8, s8, 3
    s_lshl_b32 s8, s8, 10
    s_add_u32 s89, s92, s8
    s_add_u32 s8, s82, 4
    s_and_b32 s8, s8, 3
    s_lshl_b32 s8, s8, 10
    s_add_u32 s90, s92, s8
    s_mul_i32 s8, s82, 20480
    s_add_u32 s8, s8, 61440
    v_add_u32 v5, s8, v8
    s_mul_i32 s73, s3, 5120
    v_add_u32 v6, s73, v8
    v_lshlrev_b32 v1, 3, v0
    v_add_u32 v2, 0x2000, v8
    v_add_u32 v7, 0x3000, v8
    v_add_u32 v1, 0x4000, v1
    v_mov_b32 v14, 163380
    s_cmp_eq_u32 s3, 0
    s_cbranch_scc0 Loo_119
    s_mov_b32 s8, 0
Ls_go_121:
    ds_read_b32 v15, v14
    s_add_u32 s8, s8, 1
    s_cmp_ge_u32 s8, 100000
    s_cbranch_scc1 Lsd_go_122
    s_waitcnt lgkmcnt(0)
    v_cmp_eq_u32 vcc, 0, v15
    s_cbranch_vccnz Ls_go_121
Lsd_go_122:
    s_waitcnt lgkmcnt(0)
    s_mov_b32 s8, 0
Lpoll_o_123:
    buffer_load_dword v13, v12, s[48:51], 0 offen sc1
    s_waitcnt vmcnt(0)
Lchk_o_124:
    s_add_u32 s8, s8, 1
    s_cmp_ge_u32 s8, 100000
    s_cbranch_scc1 Ldone_o_125
    v_cmp_ne_u32 vcc, s77, v13
    s_cbranch_vccnz Lpoll_o_123
Ldone_o_125:
    v_mov_b32 v14, 163356
    ds_write_b32 v14, v11
    s_cmp_eq_u32 s4, 0
    s_cbranch_scc1 Llb3_126
    buffer_load_dwordx4 v[196:199], v8, s[48:51], s83 offen offset:0 sc1
    buffer_load_dwordx4 v[200:203], v8, s[48:51], s83 offen offset:1024 sc1
    buffer_load_dwordx4 v[204:207], v8, s[48:51], s83 offen offset:2048 sc1
    buffer_load_dwordx4 v[208:211], v8, s[48:51], s83 offen offset:3072 sc1
    buffer_load_dwordx4 v[212:215], v9, s[48:51], s83 offen offset:0 sc1
    s_add_u32 s83, s83, 5120
    buffer_load_dwordx4 v[216:219], v8, s[48:51], s83 offen offset:0 sc1
    buffer_load_dwordx4 v[220:223], v8, s[48:51], s83 offen offset:1024 sc1
    buffer_load_dwordx4 v[224:227], v8, s[48:51], s83 offen offset:2048 sc1
    buffer_load_dwordx4 v[228:231], v8, s[48:51], s83 offen offset:3072 sc1
    buffer_load_dwordx4 v[232:235], v9, s[48:51], s83 offen offset:0 sc1
    s_add_u32 s83, s83, 5120
    buffer_load_dwordx4 v[236:239], v8, s[48:51], s83 offen offset:0 sc1
    buffer_load_dwordx4 v[240:243], v8, s[48:51], s83 offen offset:1024 sc1
    buffer_load_dwordx4 v[244:247], v8, s[48:51], s83 offen offset:2048 sc1
    buffer_load_dwordx4 v[248:251], v8, s[48:51], s83 offen offset:3072 sc1
    buffer_load_dwordx4 v[252:255], v9, s[48:51], s83 offen offset:0 sc1
Llb3_126:
    s_branch Loo_120
Loo_119:
    s_mov_b32 s8, 0
Ls_go_127:
    ds_read_b32 v15, v14
    s_add_u32 s8, s8, 1
    s_cmp_ge_u32 s8, 100000
    s_cbranch_scc1 Lsd_go_128
    s_waitcnt lgkmcnt(0)
    v_cmp_eq_u32 vcc, 0, v15
    s_cbranch_vccnz Ls_go_127
Lsd_go_128:
    s_waitcnt lgkmcnt(0)
    s_cmp_eq_u32 s4, 0
    s_cbranch_scc1 Llb3_129
    buffer_load_dwordx4 v[196:199], v8, s[48:51], s83 offen offset:0 sc1
    buffer_load_dwordx4 v[200:203], v8, s[48:51], s83 offen offset:1024 sc1
    buffer_load_dwordx4 v[204:207], v8, s[48:51], s83 offen offset:2048 sc1
    buffer_load_dwordx4 v[208:211], v8, s[48:51], s83 offen offset:3072 sc1
    buffer_load_dwordx4 v[212:215], v9, s[48:51], s83 offen offset:0 sc1
    s_add_u32 s83, s83, 5120
    buffer_load_dwordx4 v[216:219], v8, s[48:51], s83 offen offset:0 sc1
    buffer_load_dwordx4 v[220:223], v8, s[48:51], s83 offen offset:1024 sc1
    buffer_load_dwordx4 v[224:227], v8, s[48:51], s83 offen offset:2048 sc1
    buffer_load_dwordx4 v[228:231], v8, s[48:51], s83 offen offset:3072 sc1
    buffer_load_dwordx4 v[232:235], v9, s[48:51], s83 offen offset:0 sc1
    s_add_u32 s83, s83, 5120
    buffer_load_dwordx4 v[236:239], v8, s[48:51], s83 offen offset:0 sc1
    buffer_load_dwordx4 v[240:243], v8, s[48:51], s83 offen offset:1024 sc1
    buffer_load_dwordx4 v[244:247], v8, s[48:51], s83 offen offset:2048 sc1
    buffer_load_dwordx4 v[248:251], v8, s[48:51], s83 offen offset:3072 sc1
    buffer_load_dwordx4 v[252:255], v9, s[48:51], s83 offen offset:0 sc1
Llb3_129:
    v_mov_b32 v14, 163356
    s_mov_b32 s8, 0
Ls_op_130:
    ds_read_b32 v15, v14
    s_add_u32 s8, s8, 1
    s_cmp_ge_u32 s8, 100000
    s_cbranch_scc1 Lsd_op_131
    s_waitcnt lgkmcnt(0)
    v_cmp_eq_u32 vcc, 0, v15
    s_cbranch_vccnz Ls_op_130
Lsd_op_131:
    s_waitcnt lgkmcnt(0)
Loo_120:
    buffer_load_dwordx4 v[96:99], v8, s[48:51], s87 offen sc1
    buffer_load_dwordx4 v[100:103], v9, s[48:51], s87 offen sc1
    buffer_load_dwordx4 v[104:107], v2, s[48:51], s87 offen sc1
    buffer_load_dwordx4 v[108:111], v7, s[48:51], s87 offen sc1
    buffer_load_dwordx2 v[112:113], v1, s[48:51], s87 offen offset:0 sc1
    buffer_load_dwordx2 v[114:115], v1, s[48:51], s87 offen offset:512 sc1
    buffer_load_dwordx4 v[116:119], v8, s[48:51], s88 offen sc1
    buffer_load_dwordx4 v[120:123], v9, s[48:51], s88 offen sc1
    buffer_load_dwordx4 v[124:127], v2, s[48:51], s88 offen sc1
    buffer_load_dwordx4 v[128:131], v7, s[48:51], s88 offen sc1
    buffer_load_dwordx2 v[132:133], v1, s[48:51], s88 offen offset:0 sc1
    buffer_load_dwordx2 v[134:135], v1, s[48:51], s88 offen offset:512 sc1
    s_add_u32 s8, s82, 1
    s_and_b32 s8, s8, 3
    s_mul_i32 s8, s8, 20480
    s_add_u32 s8, s8, 61440
    v_add_u32 v16, s8, v8
    s_add_u32 s8, s82, 2
    s_and_b32 s8, s8, 3
    s_mul_i32 s8, s8, 20480
    s_add_u32 s8, s8, 66560
    v_add_u32 v36, s8, v8
    s_add_u32 s8, s82, 3
    s_and_b32 s8, s8, 3
    s_mul_i32 s8, s8, 20480
    s_add_u32 s8, s8, 71680
    v_add_u32 v56, s8, v8
    s_add_u32 s8, s82, 4
    s_and_b32 s8, s8, 3
    s_mul_i32 s8, s8, 20480
    s_add_u32 s8, s8, 76800
    v_add_u32 v76, s8, v8
    s_sub_u32 s8, s3, 1
    s_and_b32 s8, s8, 3
    s_mul_i32 s8, s8, 5120
    s_add_u32 s8, s8, 0
    v_add_u32 v14, s8, v8
    s_sub_u32 s8, s3, 2
    s_and_b32 s8, s8, 3
    s_mul_i32 s8, s8, 5120
    s_add_u32 s8, s8, 20480
    v_add_u32 v15, s8, v8
    s_sub_u32 s8, s3, 3
    s_and_b32 s8, s8, 3
    s_mul_i32 s8, s8, 5120
    s_add_u32 s8, s8, 40960
    v_add_u32 v12, s8, v8
    s_waitcnt lgkmcnt(0)
    s_barrier
    ds_read_b128 v[20:23], v16 offset:1024
    ds_read_b128 v[24:27], v16 offset:2048
    ds_read_b128 v[28:31], v16 offset:3072
    ds_read_b128 v[32:35], v16 offset:4096
    ds_read_b128 v[16:19], v16 offset:0
    ds_read_b128 v[40:43], v36 offset:1024
    ds_read_b128 v[44:47], v36 offset:2048
    ds_read_b128 v[48:51], v36 offset:3072
    ds_read_b128 v[52:55], v36 offset:4096
    ds_read_b128 v[36:39], v36 offset:0
    s_waitcnt lgkmcnt(5)
    s_waitcnt vmcnt(11)
    v_mfma_f32_16x16x32_bf16 v[20:23], v[160:163], v[96:99], v[20:23]
    buffer_load_dwordx4 v[136:139], v8, s[48:51], s89 offen sc1
    v_mfma_f32_16x16x32_bf16 v[24:27], v[164:167], v[96:99], v[24:27]
    buffer_load_dwordx4 v[140:143], v9, s[48:51], s89 offen sc1
    v_mfma_f32_16x16x32_bf16 v[28:31], v[168:171], v[96:99], v[28:31]
    buffer_load_dwordx4 v[144:147], v2, s[48:51], s89 offen sc1
    v_mfma_f32_16x16x32_bf16 v[32:35], v[172:175], v[96:99], v[32:35]
    buffer_load_dwordx4 v[148:151], v7, s[48:51], s89 offen sc1
    v_mfma_f32_16x16x32_bf16 v[16:19], v[156:159], v[96:99], v[16:19]
    buffer_load_dwordx2 v[152:153], v1, s[48:51], s89 offen offset:0 sc1
    s_waitcnt vmcnt(15)
    v_mfma_f32_16x16x32_bf16 v[20:23], v[180:183], v[100:103], v[20:23]
    buffer_load_dwordx2 v[154:155], v1, s[48:51], s89 offen offset:512 sc1
    v_mfma_f32_16x16x32_bf16 v[24:27], v[184:187], v[100:103], v[24:27]
    ds_read_b128 v[60:63], v56 offset:1024
    v_mfma_f32_16x16x32_bf16 v[28:31], v[188:191], v[100:103], v[28:31]
    ds_read_b128 v[64:67], v56 offset:2048
    v_mfma_f32_16x16x32_bf16 v[32:35], v[192:195], v[100:103], v[32:35]
    ds_read_b128 v[68:71], v56 offset:3072
    v_mfma_f32_16x16x32_bf16 v[16:19], v[176:179], v[100:103], v[16:19]
    ds_read_b128 v[72:75], v56 offset:4096
    s_waitcnt vmcnt(15)
    v_mfma_f32_16x16x32_bf16 v[20:23], v[200:203], v[104:107], v[20:23]
    ds_read_b128 v[56:59], v56 offset:0
    v_mfma_f32_16x16x32_bf16 v[24:27], v[204:207], v[104:107], v[24:27]
    ds_read_b128 v[80:83], v76 offset:1024
    v_mfma_f32_16x16x32_bf16 v[28:31], v[208:211], v[104:107], v[28:31]
    ds_read_b128 v[84:87], v76 offset:2048
    v_mfma_f32_16x16x32_bf16 v[32:35], v[212:215], v[104:107], v[32:35]
    ds_read_b128 v[88:91], v76 offset:3072
    v_mfma_f32_16x16x32_bf16 v[16:19], v[196:199], v[104:107], v[16:19]
    ds_read_b128 v[92:95], v76 offset:4096
    s_waitcnt vmcnt(14)
    v_mfma_f32_16x16x32_bf16 v[20:23], v[220:223], v[108:111], v[20:23]
    ds_read_b128 v[76:79], v76 offset:0
    v_mfma_f32_16x16x32_bf16 v[24:27], v[224:227], v[108:111], v[24:27]
    v_mfma_f32_16x16x32_bf16 v[28:31], v[228:231], v[108:111], v[28:31]
    v_mfma_f32_16x16x32_bf16 v[32:35], v[232:235], v[108:111], v[32:35]
    v_mfma_f32_16x16x32_bf16 v[16:19], v[216:219], v[108:111], v[16:19]
    s_waitcnt vmcnt(12)
    v_mfma_f32_16x16x32_bf16 v[20:23], v[240:243], v[112:115], v[20:23]
    v_mfma_f32_16x16x32_bf16 v[24:27], v[244:247], v[112:115], v[24:27]
    v_mfma_f32_16x16x32_bf16 v[28:31], v[248:251], v[112:115], v[28:31]
    v_mfma_f32_16x16x32_bf16 v[32:35], v[252:255], v[112:115], v[32:35]
    v_mfma_f32_16x16x32_bf16 v[16:19], v[236:239], v[112:115], v[16:19]
    s_waitcnt vmcnt(6) lgkmcnt(0)
    v_mfma_f32_16x16x32_bf16 v[40:43], v[160:163], v[116:119], v[40:43]
    buffer_load_dwordx4 v[96:99], v8, s[48:51], s90 offen sc1
    v_mfma_f32_16x16x32_bf16 v[44:47], v[164:167], v[116:119], v[44:47]
    buffer_load_dwordx4 v[100:103], v9, s[48:51], s90 offen sc1
    v_mfma_f32_16x16x32_bf16 v[48:51], v[168:171], v[116:119], v[48:51]
    buffer_load_dwordx4 v[104:107], v2, s[48:51], s90 offen sc1
    v_mfma_f32_16x16x32_bf16 v[52:55], v[172:175], v[116:119], v[52:55]
    buffer_load_dwordx4 v[108:111], v7, s[48:51], s90 offen sc1
    v_mfma_f32_16x16x32_bf16 v[36:39], v[156:159], v[116:119], v[36:39]
    buffer_load_dwordx2 v[112:113], v1, s[48:51], s90 offen offset:0 sc1
    v_mfma_f32_16x16x32_bf16 v[40:43], v[180:183], v[120:123], v[40:43]
    buffer_load_dwordx2 v[114:115], v1, s[48:51], s90 offen offset:512 sc1
    v_mfma_f32_16x16x32_bf16 v[44:47], v[184:187], v[120:123], v[44:47]
    ds_write_b128 v6, v[16:19] offset:0
    v_mfma_f32_16x16x32_bf16 v[48:51], v[188:191], v[120:123], v[48:51]
    ds_write_b128 v6, v[20:23] offset:1024
    v_mfma_f32_16x16x32_bf16 v[52:55], v[192:195], v[120:123], v[52:55]
    ds_write_b128 v6, v[24:27] offset:2048
    v_mfma_f32_16x16x32_bf16 v[36:39], v[176:179], v[120:123], v[36:39]
    ds_write_b128 v6, v[28:31] offset:3072
    v_mfma_f32_16x16x32_bf16 v[40:43], v[200:203], v[124:127], v[40:43]
    ds_write_b128 v6, v[32:35] offset:4096
    v_mfma_f32_16x16x32_bf16 v[44:47], v[204:207], v[124:127], v[44:47]
    v_mfma_f32_16x16x32_bf16 v[48:51], v[208:211], v[124:127], v[48:51]
    v_mfma_f32_16x16x32_bf16 v[52:55], v[212:215], v[124:127], v[52:55]
    v_mfma_f32_16x16x32_bf16 v[36:39], v[196:199], v[124:127], v[36:39]
    v_mfma_f32_16x16x32_bf16 v[40:43], v[220:223], v[128:131], v[40:43]
    v_mfma_f32_16x16x32_bf16 v[44:47], v[224:227], v[128:131], v[44:47]
    v_mfma_f32_16x16x32_bf16 v[48:51], v[228:231], v[128:131], v[48:51]
    v_mfma_f32_16x16x32_bf16 v[52:55], v[232:235], v[128:131], v[52:55]
    v_mfma_f32_16x16x32_bf16 v[36:39], v[216:219], v[128:131], v[36:39]
    v_mfma_f32_16x16x32_bf16 v[40:43], v[240:243], v[132:135], v[40:43]
    v_mfma_f32_16x16x32_bf16 v[44:47], v[244:247], v[132:135], v[44:47]
    v_mfma_f32_16x16x32_bf16 v[48:51], v[248:251], v[132:135], v[48:51]
    v_mfma_f32_16x16x32_bf16 v[52:55], v[252:255], v[132:135], v[52:55]
    v_mfma_f32_16x16x32_bf16 v[36:39], v[236:239], v[132:135], v[36:39]
    s_waitcnt vmcnt(6)
    v_mfma_f32_16x16x32_bf16 v[60:63], v[160:163], v[136:139], v[60:63]
    v_mfma_f32_16x16x32_bf16 v[64:67], v[164:167], v[136:139], v[64:67]
    v_mfma_f32_16x16x32_bf16 v[68:71], v[168:171], v[136:139], v[68:71]
    v_mfma_f32_16x16x32_bf16 v[72:75], v[172:175], v[136:139], v[72:75]
    v_mfma_f32_16x16x32_bf16 v[56:59], v[156:159], v[136:139], v[56:59]
    v_mfma_f32_16x16x32_bf16 v[60:63], v[180:183], v[140:143], v[60:63]
    v_mfma_f32_16x16x32_bf16 v[64:67], v[184:187], v[140:143], v[64:67]
    v_mfma_f32_16x16x32_bf16 v[68:71], v[188:191], v[140:143], v[68:71]
    ds_write_b128 v6, v[36:39] offset:20480
    v_mfma_f32_16x16x32_bf16 v[72:75], v[192:195], v[140:143], v[72:75]
    ds_write_b128 v6, v[40:43] offset:21504
    v_mfma_f32_16x16x32_bf16 v[56:59], v[176:179], v[140:143], v[56:59]
    ds_write_b128 v6, v[44:47] offset:22528
    v_mfma_f32_16x16x32_bf16 v[60:63], v[200:203], v[144:147], v[60:63]
    ds_write_b128 v6, v[48:51] offset:23552
    v_mfma_f32_16x16x32_bf16 v[64:67], v[204:207], v[144:147], v[64:67]
    ds_write_b128 v6, v[52:55] offset:24576
    v_mfma_f32_16x16x32_bf16 v[68:71], v[208:211], v[144:147], v[68:71]
    v_mfma_f32_16x16x32_bf16 v[72:75], v[212:215], v[144:147], v[72:75]
    v_mfma_f32_16x16x32_bf16 v[56:59], v[196:199], v[144:147], v[56:59]
    v_mfma_f32_16x16x32_bf16 v[60:63], v[220:223], v[148:151], v[60:63]
    v_mfma_f32_16x16x32_bf16 v[64:67], v[224:227], v[148:151], v[64:67]
    v_mfma_f32_16x16x32_bf16 v[68:71], v[228:231], v[148:151], v[68:71]
    v_mfma_f32_16x16x32_bf16 v[72:75], v[232:235], v[148:151], v[72:75]
    v_mfma_f32_16x16x32_bf16 v[56:59], v[216:219], v[148:151], v[56:59]
    v_mfma_f32_16x16x32_bf16 v[60:63], v[240:243], v[152:155], v[60:63]
    v_mfma_f32_16x16x32_bf16 v[64:67], v[244:247], v[152:155], v[64:67]
    v_mfma_f32_16x16x32_bf16 v[68:71], v[248:251], v[152:155], v[68:71]
    v_mfma_f32_16x16x32_bf16 v[72:75], v[252:255], v[152:155], v[72:75]
    v_mfma_f32_16x16x32_bf16 v[56:59], v[236:239], v[152:155], v[56:59]
    s_waitcnt vmcnt(0)
    v_mfma_f32_16x16x32_bf16 v[80:83], v[160:163], v[96:99], v[80:83]
    v_mfma_f32_16x16x32_bf16 v[84:87], v[164:167], v[96:99], v[84:87]
    v_mfma_f32_16x16x32_bf16 v[88:91], v[168:171], v[96:99], v[88:91]
    v_mfma_f32_16x16x32_bf16 v[92:95], v[172:175], v[96:99], v[92:95]
    v_mfma_f32_16x16x32_bf16 v[76:79], v[156:159], v[96:99], v[76:79]
    v_mfma_f32_16x16x32_bf16 v[80:83], v[180:183], v[100:103], v[80:83]
    v_mfma_f32_16x16x32_bf16 v[84:87], v[184:187], v[100:103], v[84:87]
    v_mfma_f32_16x16x32_bf16 v[88:91], v[188:191], v[100:103], v[88:91]
    ds_write_b128 v6, v[56:59] offset:40960
    v_mfma_f32_16x16x32_bf16 v[92:95], v[192:195], v[100:103], v[92:95]
    ds_write_b128 v6, v[60:63] offset:41984
    v_mfma_f32_16x16x32_bf16 v[76:79], v[176:179], v[100:103], v[76:79]
    ds_write_b128 v6, v[64:67] offset:43008
    v_mfma_f32_16x16x32_bf16 v[80:83], v[200:203], v[104:107], v[80:83]
    ds_write_b128 v6, v[68:71] offset:44032
    v_mfma_f32_16x16x32_bf16 v[84:87], v[204:207], v[104:107], v[84:87]
    ds_write_b128 v6, v[72:75] offset:45056
    s_waitcnt lgkmcnt(0)
    s_barrier
    ds_read_b128 v[16:19], v14 offset:0
    ds_read_b128 v[20:23], v14 offset:1024
    ds_read_b128 v[24:27], v14 offset:2048
    ds_read_b128 v[28:31], v14 offset:3072
    ds_read_b128 v[32:35], v14 offset:4096
    ds_read_b128 v[36:39], v15 offset:0
    ds_read_b128 v[40:43], v15 offset:1024
    ds_read_b128 v[44:47], v15 offset:2048
    ds_read_b128 v[48:51], v15 offset:3072
    ds_read_b128 v[52:55], v15 offset:4096
    ds_read_b128 v[116:119], v12 offset:0
    ds_read_b128 v[120:123], v12 offset:1024
    ds_read_b128 v[124:127], v12 offset:2048
    ds_read_b128 v[128:131], v12 offset:3072
    ds_read_b128 v[132:135], v12 offset:4096
    v_mfma_f32_16x16x32_bf16 v[88:91], v[208:211], v[104:107], v[88:91]
    v_mfma_f32_16x16x32_bf16 v[92:95], v[212:215], v[104:107], v[92:95]
    v_mfma_f32_16x16x32_bf16 v[76:79], v[196:199], v[104:107], v[76:79]
    v_mfma_f32_16x16x32_bf16 v[80:83], v[220:223], v[108:111], v[80:83]
    s_waitcnt lgkmcnt(9)
    v_add_f32 v16, v16, v36
    v_add_f32 v17, v17, v37
    v_add_f32 v18, v18, v38
    v_add_f32 v19, v19, v39
    v_mfma_f32_16x16x32_bf16 v[84:87], v[224:227], v[108:111], v[84:87]
    s_waitcnt lgkmcnt(8)
    v_add_f32 v20, v20, v40
    v_add_f32 v21, v21, v41
    v_add_f32 v22, v22, v42
    v_add_f32 v23, v23, v43
    v_mfma_f32_16x16x32_bf16 v[88:91], v[228:231], v[108:111], v[88:91]
    s_waitcnt lgkmcnt(7)
    v_add_f32 v24, v24, v44
    v_add_f32 v25, v25, v45
    v_add_f32 v26, v26, v46
    v_add_f32 v27, v27, v47
    v_mfma_f32_16x16x32_bf16 v[92:95], v[232:235], v[108:111], v[92:95]
    s_waitcnt lgkmcnt(6)
    v_add_f32 v28, v28, v48
    v_add_f32 v29, v29, v49
    v_add_f32 v30, v30, v50
    v_add_f32 v31, v31, v51
    v_mfma_f32_16x16x32_bf16 v[76:79], v[216:219], v[108:111], v[76:79]
    s_waitcnt lgkmcnt(5)
    v_add_f32 v32, v32, v52
    v_add_f32 v33, v33, v53
    v_add_f32 v34, v34, v54
    v_add_f32 v35, v35, v55
    v_mfma_f32_16x16x32_bf16 v[80:83], v[240:243], v[112:115], v[80:83]
    s_waitcnt lgkmcnt(4)
    v_add_f32 v16, v16, v116
    v_add_f32 v17, v17, v117
    v_add_f32 v18, v18, v118
    v_add_f32 v19, v19, v119
    v_mfma_f32_16x16x32_bf16 v[84:87], v[244:247], v[112:115], v[84:87]
    s_waitcnt lgkmcnt(3)
    v_add_f32 v20, v20, v120
    v_add_f32 v21, v21, v121
    v_add_f32 v22, v22, v122
    v_add_f32 v23, v23, v123
    v_mfma_f32_16x16x32_bf16 v[88:91], v[248:251], v[112:115], v[88:91]
    s_waitcnt lgkmcnt(2)
    v_add_f32 v24, v24, v124
    v_add_f32 v25, v25, v125
    v_add_f32 v26, v26, v126
    v_add_f32 v27, v27, v127
    v_mfma_f32_16x16x32_bf16 v[92:95], v[252:255], v[112:115], v[92:95]
    s_waitcnt lgkmcnt(1)
    v_add_f32 v28, v28, v128
    v_add_f32 v29, v29, v129
    v_add_f32 v30, v30, v130
    v_add_f32 v31, v31, v131
    v_mfma_f32_16x16x32_bf16 v[76:79], v[236:239], v[112:115], v[76:79]
    s_waitcnt lgkmcnt(0)
    v_add_f32 v32, v32, v132
    v_add_f32 v33, v33, v133
    v_add_f32 v34, v34, v134
    v_add_f32 v35, v35, v135
    s_nop 2
    v_pk_add_f32 v[76:77], v[76:77], v[16:17]
    v_pk_add_f32 v[78:79], v[78:79], v[18:19]
    v_cvt_pk_bf16_f32 v136, v76, v77
    v_cvt_pk_bf16_f32 v137, v78, v79
    v_pk_add_f32 v[80:81], v[80:81], v[20:21]
    v_pk_add_f32 v[82:83], v[82:83], v[22:23]
    v_cvt_pk_bf16_f32 v138, v80, v81
    v_cvt_pk_bf16_f32 v139, v82, v83
    s_nop 0
    v_permlane16_swap_b32 v136, v138
    v_permlane16_swap_b32 v137, v139
    buffer_store_dwordx4 v[136:139], v3, s[56:59], s70 offen offset:0
    v_pk_add_f32 v[84:85], v[84:85], v[24:25]
    v_pk_add_f32 v[86:87], v[86:87], v[26:27]
    v_cvt_pk_bf16_f32 v140, v84, v85
    v_cvt_pk_bf16_f32 v141, v86, v87
    v_pk_add_f32 v[88:89], v[88:89], v[28:29]
    v_pk_add_f32 v[90:91], v[90:91], v[30:31]
    v_cvt_pk_bf16_f32 v142, v88, v89
    v_cvt_pk_bf16_f32 v143, v90, v91
    s_nop 0
    v_permlane16_swap_b32 v140, v142
    v_permlane16_swap_b32 v141, v143
    buffer_store_dwordx4 v[140:143], v3, s[56:59], s70 offen offset:64
    v_pk_add_f32 v[92:93], v[92:93], v[32:33]
    v_pk_add_f32 v[94:95], v[94:95], v[34:35]
    v_cvt_pk_bf16_f32 v144, v92, v93
    v_cvt_pk_bf16_f32 v145, v94, v95
    buffer_store_dwordx2 v[144:145], v4, s[56:59], s70 offen offset:128
    s_lshl_b32 s8, s2, 3
    s_add_u32 s8, s8, s3
    s_cmp_eq_u32 s8, 0
    s_cbranch_scc0 L_fin
    s_mov_b32 s8, 0
    v_lshlrev_b32 v14, 2, v0
    v_mov_b32 v15, s77
    s_mov_b64 exec, 1
    buffer_store_dword v15, v14, s[48:51], s8 offen offset:0 sc1
    s_mov_b64 exec, -1
L_fin:
L_end:
    s_endpgm
L_x_h4:
    s_cmp_eq_u32 s68, 7
    s_cbranch_scc0 Lj3_134
    buffer_load_dwordx2 v[228:229], v230, s[48:51], 0 offen sc1
    buffer_load_dword v13, v12, s[48:51], 0 offen sc1
    s_branch L_r_h4
Lj3_134:
    s_cmp_eq_u32 s83, 0
    s_cbranch_scc1 L_r_h4
    s_cmp_eq_u32 s68, 2
    s_waitcnt vmcnt(0)
    s_cbranch_scc0 Lj2_133
    ds_read_b64_tr_b16 v[212:213], v210 offset:0
    ds_read_b64_tr_b16 v[214:215], v210 offset:2048
    ds_read_b64_tr_b16 v[216:217], v210 offset:32
    ds_read_b64_tr_b16 v[218:219], v210 offset:2080
    ds_read_b64_tr_b16 v[220:221], v210 offset:64
    ds_read_b64_tr_b16 v[222:223], v210 offset:2112
    ds_read_b64_tr_b16 v[224:225], v210 offset:96
    ds_read_b64_tr_b16 v[226:227], v210 offset:2144
    s_waitcnt lgkmcnt(6)
    buffer_store_dwordx4 v[212:215], v8, s[48:51], s87 offen sc1
    s_waitcnt lgkmcnt(4)
    buffer_store_dwordx4 v[216:219], v8, s[48:51], s88 offen sc1
    s_waitcnt lgkmcnt(2)
    buffer_store_dwordx4 v[220:223], v8, s[48:51], s89 offen sc1
    s_waitcnt lgkmcnt(0)
    buffer_store_dwordx4 v[224:227], v8, s[48:51], s90 offen sc1
    s_branch L_r_h4
Lj2_133:
    v_lshlrev_b32 v14, 2, v0
    v_mov_b32 v15, s77
    s_mov_b64 exec, 1
    buffer_store_dword v15, v14, s[48:51], s86 offen offset:0 sc1
    s_mov_b64 exec, -1
    s_branch L_r_h4
L_code_end:

.section .rodata,"a"
.p2align 6
.amdhsa_kernel parallel_sum__linear_attn_block__dense_activation_mish__prompt_kernel
  .amdhsa_next_free_vgpr 256
  .amdhsa_next_free_sgpr 102
  .amdhsa_accum_offset 256
  .amdhsa_group_segment_fixed_size 0
  .amdhsa_kernarg_size 80
  .amdhsa_user_sgpr_count 2
  .amdhsa_user_sgpr_kernarg_segment_ptr 1
  .amdhsa_system_sgpr_workgroup_id_x 1
  .amdhsa_float_denorm_mode_32 3
.end_amdhsa_kernel
```
